```python
import torch

def _softmax(x, axis=-1):
    return torch.softmax(x, dim=axis)
def _gelu(x):
    return torch.nn.functional.gelu(x, approximate="tanh")
def _silu(x):
    return torch.nn.functional.silu(x)
def _sigmoid(x):
    return torch.sigmoid(x)
def _layernorm(x, axis=-1, eps=1e-5):
    m = x.mean(dim=axis, keepdim=True)
    v = x.var(dim=axis, keepdim=True, unbiased=False)
    return (x - m) / torch.sqrt(v + eps)
def _scatter_add(tgt, idx, src, axis=0):
    return tgt.clone().index_add_(axis, idx, src)
def _segment_sum(src, seg, n):
    out = torch.zeros((n,) + src.shape[1:], dtype=src.dtype)
    return out.index_add_(0, seg, src)
def _pad(x, pw):
    flat = tuple(v for pair in reversed(pw) for v in pair)
    return torch.nn.functional.pad(x, flat)

kernel_name = 'interleave_layers__spectral_gfnet__dense_activation_silu__prompt'

def setup_inputs():

    _w = (lambda a: (lambda t: t.to(torch.bfloat16) if t.is_floating_point() else t)(torch.as_tensor(a)))
    def _A_setup():
        B, S, D = 1, 2048, 640
        Df = D // 2 + 1
        return {
            "x": _w((lambda *s: torch.randn(*s, dtype=torch.bfloat16) * 0.05)(B, S, D)),
            "w_r": _w((lambda *s: torch.randn(*s, dtype=torch.bfloat16) * 0.4)(S, Df) * 0.02),
            "w_i": _w((lambda *s: torch.randn(*s, dtype=torch.bfloat16) * 0.4)(S, Df) * 0.02),
        }
    _A_in = _A_setup()

    def _B_setup():
        B, S, D, F = 1, 2048, 640, 1536
        return {
            "x": _w((lambda *s: torch.randn(*s, dtype=torch.bfloat16) * 0.05)(B, S, D)),
            "w1": _w((lambda *s: torch.randn(*s, dtype=torch.bfloat16) * 0.4)(D, F) * (D ** -0.5)),
            "w2": _w((lambda *s: torch.randn(*s, dtype=torch.bfloat16) * 0.1)(F, D) * (F ** -0.5)),
        }
    _B_in = _B_setup()

    return {
        "A_x": _A_in["x"],
        "A_w_r": _A_in["w_r"],
        "A_w_i": _A_in["w_i"],
        "B_x": _B_in["x"],
        "B_w1": _B_in["w1"],
        "B_w2": _B_in["w2"],
    }

def reference(A_x, A_w_r, A_w_i, B_x, B_w1, B_w2):
    def _A_ref(x, w_r, w_i):
        B, S, D = x.shape
        X = (lambda x, axes=(-2,-1): torch.fft.rfft2(x.float(), dim=axes))(x, axes=(-2, -1))
        W = w_r + 1j * w_i
        X = X * W
        y = (lambda x, s, axes=(-2,-1): torch.fft.irfft2(x, s=s, dim=axes).to(torch.bfloat16))(X, (S, D), axes=(-2, -1))
        return y

    def _B_ref(x, w1, w2):
        h = torch.einsum("bsd,df->bsf", x, w1)
        h = _silu(h)
        out = torch.einsum("bsf,fd->bsd", h, w2)
        return out

    x = A_x
    x = x + _A_ref(_layernorm(x, axis=-1), A_w_r, A_w_i)
    x = x + _B_ref(_layernorm(x, axis=-1), B_w1, B_w2)
    x = x + _A_ref(_layernorm(x, axis=-1), A_w_r, A_w_i)
    x = x + _B_ref(_layernorm(x, axis=-1), B_w1, B_w2)
    return x
```

```asm
; @launch kernel=a1_kernel grid=(480,1,1) block=(512,1,1) lds=33856
; @launch kernel=b_kernel grid=(321,1,1) block=(256,1,1) lds=20992
; @launch kernel=f1_kernel grid=(256,1,1) block=(256,1,1) lds=155648
; @launch kernel=a2_kernel grid=(256,1,1) block=(512,1,1) lds=20608
; @launch kernel=b_kernel grid=(321,1,1) block=(256,1,1) lds=20992
; @launch kernel=f2_kernel grid=(256,1,1) block=(256,1,1) lds=155648
.amdgcn_target "amdgcn-amd-amdhsa--gfx950"
.text
.globl a1_kernel
.p2align 8
.type a1_kernel,@function
a1_kernel:
    s_load_dwordx2 s[6:7], s[0:1], 64
    s_load_dwordx2 s[4:5], s[0:1], 0
    s_cmp_ge_u32 s2, 256
    s_cbranch_scc1 L_prepW
    s_branch L_A_main
.globl a2_kernel
.p2align 8
.type a2_kernel,@function
a2_kernel:
    s_load_dwordx2 s[6:7], s[0:1], 64
    s_cmp_ge_u32 s2, 256
    s_cbranch_scc1 L_A_end
    s_waitcnt lgkmcnt(0)
    s_add_u32 s4, s6, 0x1200000
    s_addc_u32 s5, s7, 0
L_A_main:
    v_lshrrev_b32 v1, 6, v0
    v_and_b32 v2, 63, v0
    v_readfirstlane_b32 s10, v1
    v_and_b32 v3, 15, v2
    v_lshrrev_b32 v4, 4, v2
    v_lshlrev_b32 v6, 4, v2
    s_getpc_b64 s[8:9]
.Lpc_A:
    s_add_u32 s8, s8, cdna_tbl-.Lpc_A+0
    s_addc_u32 s9, s9, 0
    s_lshl_b32 s14, s10, 10
    s_add_u32 s8, s8, s14
    s_addc_u32 s9, s9, 0
    s_add_u32 s15, s14, 10368
    s_mov_b32 m0, s15
    s_lshr_b32 s11, s2, 5
    global_load_lds_dwordx4 v6, s[8:9]
    s_cmp_ge_u32 s10, 2
    s_cbranch_scc1 L_A_nodma2
    s_add_u32 s8, s8, 8192
    s_addc_u32 s9, s9, 0
    s_add_u32 s15, s15, 8192
    s_mov_b32 m0, s15
    s_nop 0
    global_load_lds_dwordx4 v6, s[8:9]
L_A_nodma2:
    s_and_b32 s12, s2, 7
    s_lshl_b32 s12, s12, 2
    s_bfe_u32 s13, s2, 0x20003
    s_add_u32 s12, s12, s13
    s_lshl_b32 s13, s11, 8
    s_lshl_b32 s14, s10, 5
    s_add_u32 s13, s13, s14
    s_add_u32 s13, s13, s12
    s_mul_i32 s13, s13, 1280
    v_mul_u32_u24 v5, 320, v4
    v_lshl_add_u32 v5, v3, 2, v5
    s_waitcnt lgkmcnt(0)
    s_add_u32 s4, s4, s13
    s_addc_u32 s5, s5, 0
    global_load_dword v8, v5, s[4:5] offset:0
    global_load_dword v9, v5, s[4:5] offset:64
    global_load_dword v10, v5, s[4:5] offset:128
    global_load_dword v11, v5, s[4:5] offset:192
    global_load_dword v12, v5, s[4:5] offset:256
    s_cmp_lg_u32 s10, 7
    s_cbranch_scc1 L_A_noZ
    s_lshl_b32 s24, s2, 8
    s_add_u32 s24, s24, 0x1c10000
    v_lshl_add_u32 v48, v2, 4, s24
    v_mov_b32 v52, 0
    v_mov_b32 v53, 0
    v_mov_b32 v54, 0
    v_mov_b32 v55, 0
    s_mov_b64 exec, 0xffff
    global_store_dwordx4 v48, v[52:55], s[6:7]
    s_mov_b64 exec, -1
L_A_noZ:
    s_mov_b32 s16, 0xffff0000
    s_mov_b32 s17, 0xbc003c00
    s_lshr_b32 s18, s10, 2
    s_mul_i32 s18, s18, 5136
    s_and_b32 s19, s10, 3
    s_lshl_b32 s19, s19, 2
    s_add_u32 s18, s18, s19
    v_mul_u32_u24 v7, 80, v4
    v_add_u32 v7, v7, v3
    v_lshl_add_u32 v44, v7, 4, s18
    v_sub_u32 v7, 260, v7
    v_lshl_add_u32 v45, v7, 4, s18
    v_mov_b32 v91, 0
    v_mov_b32 v95, 0
    v_lshrrev_b32 v7, 1, v0
    v_and_b32 v13, 1, v0
    v_mul_u32_u24 v46, 5136, v13
    v_lshl_add_u32 v46, v7, 4, v46
    v_lshlrev_b32 v47, 13, v7
    v_lshl_add_u32 v47, v13, 4, v47
    s_lshl_b32 s13, s11, 10
    s_lshl_b32 s14, s12, 5
    s_add_u32 s13, s13, s14
    s_add_u32 s13, s13, 0x0
    s_add_u32 s6, s6, s13
    s_addc_u32 s7, s7, 0
    s_add_u32 s22, s6, 0x200000
    s_addc_u32 s23, s7, 0
    s_waitcnt vmcnt(0)
    s_barrier
    ds_read_b128 v[48:51], v6 offset:10368
    ds_read_b128 v[52:55], v6 offset:11392
    ds_read_b128 v[56:59], v6 offset:12416
    ds_read_b128 v[60:63], v6 offset:13440
    ds_read_b128 v[64:67], v6 offset:14464
    ds_read_b128 v[68:71], v6 offset:15488
    ds_read_b128 v[72:75], v6 offset:16512
    ds_read_b128 v[76:79], v6 offset:17536
    ds_read_b128 v[80:83], v6 offset:18560
    ds_read_b128 v[84:87], v6 offset:19584
    v_lshlrev_b32 v14, 16, v8
    v_and_b32 v15, s16, v8
    v_lshlrev_b32 v16, 16, v9
    v_and_b32 v17, s16, v9
    v_lshlrev_b32 v18, 16, v10
    v_and_b32 v19, s16, v10
    v_lshlrev_b32 v20, 16, v11
    v_and_b32 v21, s16, v11
    v_lshlrev_b32 v22, 16, v12
    v_and_b32 v23, s16, v12
    v_pk_add_f32 v[30:31], v[14:15], v[16:17]
    v_pk_add_f32 v[32:33], v[18:19], v[20:21]
    v_pk_add_f32 v[30:31], v[30:31], v[22:23]
    v_pk_add_f32 v[30:31], v[30:31], v[32:33]
    v_add_f32 v30, v30, v31
    s_nop 1
    v_add_f32 v30, v30, v30 quad_perm:[1,0,3,2] row_mask:0xf bank_mask:0xf
    s_nop 1
    v_add_f32 v30, v30, v30 quad_perm:[2,3,0,1] row_mask:0xf bank_mask:0xf
    s_nop 1
    v_add_f32 v30, v30, v30 row_half_mirror row_mask:0xf bank_mask:0xf
    s_nop 1
    v_add_f32 v30, v30, v30 row_mirror row_mask:0xf bank_mask:0xf
    s_nop 1
    v_add_f32 v30, v30, v30 row_bcast:15 row_mask:0xa bank_mask:0xf
    s_nop 1
    v_add_f32 v30, v30, v30 row_bcast:31 row_mask:0xc bank_mask:0xf
    s_nop 0
    v_readlane_b32 s20, v30, 63
    v_mov_b32 v31, 0x3acccccd
    s_nop 0
    v_mul_f32 v42, s20, v31
    v_pk_add_f32 v[32:33], v[14:15], v[42:43] op_sel_hi:[1,0] neg_lo:[0,1] neg_hi:[0,1]
    v_pk_add_f32 v[34:35], v[16:17], v[42:43] op_sel_hi:[1,0] neg_lo:[0,1] neg_hi:[0,1]
    v_pk_add_f32 v[36:37], v[18:19], v[42:43] op_sel_hi:[1,0] neg_lo:[0,1] neg_hi:[0,1]
    v_pk_add_f32 v[38:39], v[20:21], v[42:43] op_sel_hi:[1,0] neg_lo:[0,1] neg_hi:[0,1]
    v_pk_add_f32 v[40:41], v[22:23], v[42:43] op_sel_hi:[1,0] neg_lo:[0,1] neg_hi:[0,1]
    v_pk_mul_f32 v[24:25], v[32:33], v[32:33]
    v_pk_fma_f32 v[24:25], v[34:35], v[34:35], v[24:25]
    v_pk_fma_f32 v[24:25], v[36:37], v[36:37], v[24:25]
    v_pk_fma_f32 v[24:25], v[38:39], v[38:39], v[24:25]
    v_pk_fma_f32 v[24:25], v[40:41], v[40:41], v[24:25]
    v_add_f32 v30, v24, v25
    s_nop 1
    v_add_f32 v30, v30, v30 quad_perm:[1,0,3,2] row_mask:0xf bank_mask:0xf
    s_nop 1
    v_add_f32 v30, v30, v30 quad_perm:[2,3,0,1] row_mask:0xf bank_mask:0xf
    s_nop 1
    v_add_f32 v30, v30, v30 row_half_mirror row_mask:0xf bank_mask:0xf
    s_nop 1
    v_add_f32 v30, v30, v30 row_mirror row_mask:0xf bank_mask:0xf
    s_nop 1
    v_add_f32 v30, v30, v30 row_bcast:15 row_mask:0xa bank_mask:0xf
    s_nop 1
    v_add_f32 v30, v30, v30 row_bcast:31 row_mask:0xc bank_mask:0xf
    s_nop 0
    v_readlane_b32 s21, v30, 63
    v_cvt_pk_bf16_f32 v42, v42, v42
    s_nop 0
    v_mul_f32 v30, s21, v31
    v_and_b32 v42, s16, v42
    v_cvt_pk_bf16_f32 v30, v30, v30
    v_and_b32 v30, s16, v30
    v_add_f32 v30, 0x3727c5ac, v30
    v_cvt_pk_bf16_f32 v30, v30, v30
    v_and_b32 v30, s16, v30
    v_sqrt_f32 v30, v30
    v_pk_add_f32 v[32:33], v[14:15], v[42:43] op_sel_hi:[1,0] neg_lo:[0,1] neg_hi:[0,1]
    v_pk_add_f32 v[34:35], v[16:17], v[42:43] op_sel_hi:[1,0] neg_lo:[0,1] neg_hi:[0,1]
    v_pk_add_f32 v[36:37], v[18:19], v[42:43] op_sel_hi:[1,0] neg_lo:[0,1] neg_hi:[0,1]
    v_pk_add_f32 v[38:39], v[20:21], v[42:43] op_sel_hi:[1,0] neg_lo:[0,1] neg_hi:[0,1]
    v_pk_add_f32 v[40:41], v[22:23], v[42:43] op_sel_hi:[1,0] neg_lo:[0,1] neg_hi:[0,1]
    v_cvt_pk_bf16_f32 v30, v30, v30
    v_and_b32 v30, s16, v30
    v_rcp_f32 v30, v30
    v_cvt_pk_bf16_f32 v24, v32, v33
    v_cvt_pk_bf16_f32 v25, v34, v35
    v_cvt_pk_bf16_f32 v26, v36, v37
    v_cvt_pk_bf16_f32 v27, v38, v39
    v_cvt_pk_bf16_f32 v28, v40, v41
    v_lshlrev_b32 v32, 16, v24
    v_and_b32 v33, s16, v24
    v_lshlrev_b32 v34, 16, v25
    v_and_b32 v35, s16, v25
    v_lshlrev_b32 v36, 16, v26
    v_and_b32 v37, s16, v26
    v_lshlrev_b32 v38, 16, v27
    v_and_b32 v39, s16, v27
    v_lshlrev_b32 v40, 16, v28
    v_and_b32 v41, s16, v28
    v_pk_mul_f32 v[32:33], v[32:33], v[30:31] op_sel_hi:[1,0]
    v_pk_mul_f32 v[34:35], v[34:35], v[30:31] op_sel_hi:[1,0]
    v_pk_mul_f32 v[36:37], v[36:37], v[30:31] op_sel_hi:[1,0]
    v_pk_mul_f32 v[38:39], v[38:39], v[30:31] op_sel_hi:[1,0]
    v_pk_mul_f32 v[40:41], v[40:41], v[30:31] op_sel_hi:[1,0]
    v_cvt_pk_bf16_f32 v24, v32, v33
    v_cvt_pk_bf16_f32 v25, v34, v35
    v_cvt_pk_bf16_f32 v26, v36, v37
    v_cvt_pk_bf16_f32 v27, v38, v39
    v_cvt_pk_bf16_f32 v28, v40, v41
    v_lshlrev_b32 v14, 16, v24
    v_and_b32 v15, s16, v24
    v_lshlrev_b32 v16, 16, v25
    v_and_b32 v17, s16, v25
    v_lshlrev_b32 v18, 16, v26
    v_and_b32 v19, s16, v26
    v_lshlrev_b32 v20, 16, v27
    v_and_b32 v21, s16, v27
    v_lshlrev_b32 v22, 16, v28
    v_and_b32 v23, s16, v28
    v_cvt_pk_f16_f32 v88, v14, v16
    v_cvt_pk_f16_f32 v89, v18, v20
    v_cvt_pk_f16_f32 v90, v22, 0
    v_cvt_pk_f16_f32 v92, v15, v17
    v_cvt_pk_f16_f32 v93, v19, v21
    v_cvt_pk_f16_f32 v94, v23, 0
    s_waitcnt lgkmcnt(0)
    v_mfma_f32_16x16x32_f16 v[96:99], v[88:91], v[48:51], 0
    v_mfma_f32_16x16x32_f16 v[104:107], v[88:91], v[52:55], 0
    v_mfma_f32_16x16x32_f16 v[100:103], v[92:95], v[48:51], 0
    v_mfma_f32_16x16x32_f16 v[108:111], v[92:95], v[52:55], 0
    s_nop 5
    v_mul_f32 v14, v104, v57
    v_mul_f32 v15, v104, v56
    v_mul_f32 v16, v105, v59
    v_mul_f32 v17, v105, v58
    v_mul_f32 v18, v106, v61
    v_mul_f32 v19, v106, v60
    v_mul_f32 v20, v107, v63
    v_mul_f32 v21, v107, v62
    v_mul_f32 v22, v108, v65
    v_mul_f32 v23, v108, v64
    v_mul_f32 v24, v109, v67
    v_mul_f32 v25, v109, v66
    v_mul_f32 v26, v110, v69
    v_mul_f32 v27, v110, v68
    v_mul_f32 v28, v111, v71
    v_mul_f32 v29, v111, v70
    v_fma_mixlo_f16 v112, v96, v56, -v14
    v_fma_mixlo_f16 v113, v97, v58, -v16
    v_fma_mixlo_f16 v114, v98, v60, -v18
    v_fma_mixlo_f16 v115, v99, v62, -v20
    v_fma_mixlo_f16 v116, v100, v64, -v22
    v_fma_mixlo_f16 v117, v101, v66, -v24
    v_fma_mixlo_f16 v118, v102, v68, -v26
    v_fma_mixlo_f16 v119, v103, v70, -v28
    v_fma_mixhi_f16 v112, v96, v57, v15
    v_fma_mixhi_f16 v113, v97, v59, v17
    v_fma_mixhi_f16 v114, v98, v61, v19
    v_fma_mixhi_f16 v115, v99, v63, v21
    v_fma_mixhi_f16 v116, v100, v65, v23
    v_fma_mixhi_f16 v117, v101, v67, v25
    v_fma_mixhi_f16 v118, v102, v69, v27
    v_fma_mixhi_f16 v119, v103, v71, v29
    v_pk_mul_f16 v120, v112, s17 op_sel:[1,0] op_sel_hi:[0,1]
    v_pk_mul_f16 v121, v113, s17 op_sel:[1,0] op_sel_hi:[0,1]
    v_pk_mul_f16 v122, v114, s17 op_sel:[1,0] op_sel_hi:[0,1]
    v_pk_mul_f16 v123, v115, s17 op_sel:[1,0] op_sel_hi:[0,1]
    v_pk_mul_f16 v124, v116, s17 op_sel:[1,0] op_sel_hi:[0,1]
    v_pk_mul_f16 v125, v117, s17 op_sel:[1,0] op_sel_hi:[0,1]
    v_pk_mul_f16 v126, v118, s17 op_sel:[1,0] op_sel_hi:[0,1]
    v_pk_mul_f16 v127, v119, s17 op_sel:[1,0] op_sel_hi:[0,1]
    v_mfma_f32_16x16x32_f16 v[96:99], v[72:75], v[112:115], 0
    v_mfma_f32_16x16x32_f16 v[104:107], v[72:75], v[120:123], 0
    v_mfma_f32_16x16x32_f16 v[100:103], v[80:83], v[112:115], 0
    v_mfma_f32_16x16x32_f16 v[108:111], v[80:83], v[120:123], 0
    v_mfma_f32_16x16x32_f16 v[96:99], v[76:79], v[116:119], v[96:99]
    v_mfma_f32_16x16x32_f16 v[104:107], v[76:79], v[124:127], v[104:107]
    v_mfma_f32_16x16x32_f16 v[100:103], v[84:87], v[116:119], v[100:103]
    v_mfma_f32_16x16x32_f16 v[108:111], v[84:87], v[124:127], v[108:111]
    s_nop 5
    v_cvt_pk_f16_f32 v88, v96, v104
    v_cvt_pk_f16_f32 v89, v97, v105
    v_cvt_pk_f16_f32 v90, v98, v106
    v_cvt_pk_f16_f32 v91, v99, v107
    v_cvt_pk_f16_f32 v92, v100, -v108
    v_cvt_pk_f16_f32 v93, v101, -v109
    v_cvt_pk_f16_f32 v94, v102, -v110
    v_cvt_pk_f16_f32 v95, v103, -v111
    s_mov_b32 exec_lo, 0x07ff07ff
    s_mov_b32 exec_hi, 0x07ff07ff
    ds_write_b32 v44, v88 offset:0
    ds_write_b32 v44, v89 offset:320
    ds_write_b32 v44, v90 offset:640
    ds_write_b32 v44, v91 offset:960
    s_mov_b32 exec_lo, 0x03fe03ff
    s_mov_b32 exec_hi, 0x03fe03fe
    ds_write_b32 v45, v92 offset:960
    s_mov_b32 exec_lo, 0x03fe03fe
    ds_write_b32 v45, v93 offset:640
    ds_write_b32 v45, v94 offset:320
    ds_write_b32 v45, v95 offset:0
    s_mov_b64 exec, -1
    v_cmp_gt_u32 vcc, 130, v0
    s_waitcnt lgkmcnt(0)
    s_barrier
    ds_read_b128 v[12:15], v46
    s_cmp_ge_u32 s10, 3
    s_cbranch_scc1 L_A_st1
    s_and_saveexec_b64 s[24:25], vcc
    ds_read_b128 v[16:19], v46 offset:4096
    s_waitcnt lgkmcnt(0)
    global_store_dwordx4 v47, v[16:19], s[22:23]
    s_mov_b64 exec, s[24:25]
L_A_st1:
    s_waitcnt lgkmcnt(0)
    global_store_dwordx4 v47, v[12:15], s[6:7]
L_A_end:
    s_endpgm
L_prepW:
    s_cmp_ge_u32 s2, 352
    s_cbranch_scc1 L_prepF
    s_load_dwordx2 s[8:9], s[0:1], 8
    s_load_dwordx2 s[10:11], s[0:1], 16
    v_lshrrev_b32 v1, 6, v0
    v_and_b32 v2, 63, v0
    s_nop 0
    v_readfirstlane_b32 s12, v1
    s_sub_u32 s33, s2, 256
    s_lshl_b32 s13, s33, 3
    s_add_u32 s13, s13, s12
    v_mov_b32 v20, 0
    s_mov_b32 s24, 0x7fff7fff
    s_waitcnt lgkmcnt(0)
    s_add_u32 s28, s8, 657408
    s_addc_u32 s29, s9, 0
    s_add_u32 s30, s10, 657408
    s_addc_u32 s31, s11, 0
    s_add_u32 s14, s6, 0x1500000
    s_addc_u32 s15, s7, 0
    s_lshr_b32 s16, s33, 4
    s_bfe_u32 s17, s33, 0x20002
    s_and_b32 s18, s33, 3
    s_lshl_b32 s19, s18, 8
    s_lshl_b32 s20, s17, 4
    s_add_u32 s19, s19, s20
    s_lshl_b32 s20, s12, 1
    s_add_u32 s19, s19, s20
    s_mul_i32 s19, s19, 642
    s_lshl_b32 s20, s16, 7
    s_add_u32 s19, s19, s20
    v_lshl_add_u32 v3, v2, 1, s19
    v_add_u32 v4, 0xa080, v3
    v_add_u32 v5, 0x14100, v3
    v_add_u32 v6, 0x1e180, v3
    s_lshl_b32 s20, s16, 6
    v_add_u32 v13, s20, v2
    v_cmp_gt_u32 vcc, 321, v13
    v_mov_b32 v24, 0
    v_mov_b32 v25, 0
    v_mov_b32 v26, 0
    v_mov_b32 v27, 0
    v_mov_b32 v28, 0
    v_mov_b32 v29, 0
    v_mov_b32 v30, 0
    v_mov_b32 v31, 0
    v_mov_b32 v32, 0
    v_mov_b32 v33, 0
    v_mov_b32 v34, 0
    v_mov_b32 v35, 0
    v_mov_b32 v36, 0
    v_mov_b32 v37, 0
    v_mov_b32 v38, 0
    v_mov_b32 v39, 0
    v_mov_b32 v40, 0
    v_mov_b32 v41, 0
    v_mov_b32 v42, 0
    v_mov_b32 v43, 0
    v_mov_b32 v44, 0
    v_mov_b32 v45, 0
    v_mov_b32 v46, 0
    v_mov_b32 v47, 0
    v_mov_b32 v48, 0
    v_mov_b32 v49, 0
    v_mov_b32 v50, 0
    v_mov_b32 v51, 0
    v_mov_b32 v52, 0
    v_mov_b32 v53, 0
    v_mov_b32 v54, 0
    v_mov_b32 v55, 0
    s_and_saveexec_b64 s[34:35], vcc
    global_load_ushort v24, v3, s[8:9] offset:0
    global_load_ushort v40, v3, s[10:11] offset:0
    global_load_ushort v25, v4, s[8:9] offset:0
    global_load_ushort v41, v4, s[10:11] offset:0
    global_load_ushort v26, v5, s[8:9] offset:0
    global_load_ushort v42, v5, s[10:11] offset:0
    global_load_ushort v27, v6, s[8:9] offset:0
    global_load_ushort v43, v6, s[10:11] offset:0
    global_load_ushort v28, v3, s[28:29] offset:0
    global_load_ushort v44, v3, s[30:31] offset:0
    global_load_ushort v29, v4, s[28:29] offset:0
    global_load_ushort v45, v4, s[30:31] offset:0
    global_load_ushort v30, v5, s[28:29] offset:0
    global_load_ushort v46, v5, s[30:31] offset:0
    global_load_ushort v31, v6, s[28:29] offset:0
    global_load_ushort v47, v6, s[30:31] offset:0
    global_load_ushort v32, v3, s[8:9] offset:642
    global_load_ushort v48, v3, s[10:11] offset:642
    global_load_ushort v33, v4, s[8:9] offset:642
    global_load_ushort v49, v4, s[10:11] offset:642
    global_load_ushort v34, v5, s[8:9] offset:642
    global_load_ushort v50, v5, s[10:11] offset:642
    global_load_ushort v35, v6, s[8:9] offset:642
    global_load_ushort v51, v6, s[10:11] offset:642
    global_load_ushort v36, v3, s[28:29] offset:642
    global_load_ushort v52, v3, s[30:31] offset:642
    global_load_ushort v37, v4, s[28:29] offset:642
    global_load_ushort v53, v4, s[30:31] offset:642
    global_load_ushort v38, v5, s[28:29] offset:642
    global_load_ushort v54, v5, s[30:31] offset:642
    global_load_ushort v39, v6, s[28:29] offset:642
    global_load_ushort v55, v6, s[30:31] offset:642
    s_mov_b64 exec, s[34:35]
    v_mul_u32_u24 v7, 528, v2
    s_lshl_b32 s20, s12, 6
    s_add_u32 s20, s20, 64
    v_add_u32 v7, s20, v7
    v_lshrrev_b32 v8, 5, v2
    v_and_b32 v9, 31, v2
    s_lshl_b32 s20, s12, 3
    v_add_u32 v8, s20, v8
    v_mul_u32_u24 v10, 528, v8
    v_lshl_add_u32 v10, v9, 4, v10
    s_lshl_b32 s20, s16, 19
    s_lshl_b32 s21, s17, 11
    s_add_u32 s20, s20, s21
    s_lshl_b32 s21, s18, 9
    s_add_u32 s20, s20, s21
    v_lshl_add_u32 v11, v8, 13, s20
    v_lshl_add_u32 v11, v9, 4, v11
    v_add_u32 v12, 0x8000, v11
    s_add_u32 s26, s14, 0x4000
    s_addc_u32 s27, s15, 0
    s_waitcnt vmcnt(0)
    v_lshl_or_b32 v24, v40, 16, v24
    v_lshl_or_b32 v25, v41, 16, v25
    v_lshl_or_b32 v26, v42, 16, v26
    v_lshl_or_b32 v27, v43, 16, v27
    v_lshl_or_b32 v28, v44, 16, v28
    v_lshl_or_b32 v29, v45, 16, v29
    v_lshl_or_b32 v30, v46, 16, v30
    v_lshl_or_b32 v31, v47, 16, v31
    v_lshl_or_b32 v32, v48, 16, v32
    v_lshl_or_b32 v33, v49, 16, v33
    v_lshl_or_b32 v34, v50, 16, v34
    v_lshl_or_b32 v35, v51, 16, v35
    v_lshl_or_b32 v36, v52, 16, v36
    v_lshl_or_b32 v37, v53, 16, v37
    v_lshl_or_b32 v38, v54, 16, v38
    v_lshl_or_b32 v39, v55, 16, v39
    ds_write_b128 v7, v[24:27] offset:0
    ds_write_b128 v7, v[28:31] offset:16
    ds_write_b128 v7, v[32:35] offset:32
    ds_write_b128 v7, v[36:39] offset:48
    v_and_b32 v40, s24, v24
    v_and_b32 v41, s24, v25
    v_and_b32 v42, s24, v26
    v_and_b32 v43, s24, v27
    v_and_b32 v44, s24, v28
    v_and_b32 v45, s24, v29
    v_and_b32 v46, s24, v30
    v_and_b32 v47, s24, v31
    v_and_b32 v48, s24, v32
    v_and_b32 v49, s24, v33
    v_and_b32 v50, s24, v34
    v_and_b32 v51, s24, v35
    v_and_b32 v52, s24, v36
    v_and_b32 v53, s24, v37
    v_and_b32 v54, s24, v38
    v_and_b32 v55, s24, v39
    v_pk_max_u16 v20, v20, v40
    v_pk_max_u16 v20, v20, v41
    v_pk_max_u16 v20, v20, v42
    v_pk_max_u16 v20, v20, v43
    v_pk_max_u16 v20, v20, v44
    v_pk_max_u16 v20, v20, v45
    v_pk_max_u16 v20, v20, v46
    v_pk_max_u16 v20, v20, v47
    v_pk_max_u16 v20, v20, v48
    v_pk_max_u16 v20, v20, v49
    v_pk_max_u16 v20, v20, v50
    v_pk_max_u16 v20, v20, v51
    v_pk_max_u16 v20, v20, v52
    v_pk_max_u16 v20, v20, v53
    v_pk_max_u16 v20, v20, v54
    v_pk_max_u16 v20, v20, v55
    s_waitcnt lgkmcnt(0)
    s_barrier
    ds_read_b128 v[56:59], v10 offset:64
    ds_read_b128 v[60:63], v10 offset:1120
    ds_read_b128 v[64:67], v10 offset:2176
    ds_read_b128 v[68:71], v10 offset:3232
    s_lshl_b32 s20, s16, 6
    v_add_u32 v13, s20, v8
    v_cmp_gt_u32 vcc, 321, v13
    s_waitcnt lgkmcnt(0)
    s_and_saveexec_b64 s[34:35], vcc
    s_cbranch_execz L_pw_st_done
    global_store_dwordx4 v11, v[56:59], s[14:15]
    s_cmp_eq_u32 s16, 5
    s_cbranch_scc1 L_pw_st_done
    global_store_dwordx4 v11, v[60:63], s[26:27]
    global_store_dwordx4 v12, v[64:67], s[14:15]
    global_store_dwordx4 v12, v[68:71], s[26:27]
L_pw_st_done:
    s_mov_b64 exec, s[34:35]
L_pw_fin:
    s_nop 7
    s_nop 3
    v_lshrrev_b32 v21, 16, v20
    v_and_b32 v20, 0xffff, v20
    v_max_u32 v20, v20, v21
    s_nop 1
    v_max_u32 v20, v20, v20 quad_perm:[1,0,3,2] row_mask:0xf bank_mask:0xf
    s_nop 1
    v_max_u32 v20, v20, v20 quad_perm:[2,3,0,1] row_mask:0xf bank_mask:0xf
    s_nop 1
    v_max_u32 v20, v20, v20 row_half_mirror row_mask:0xf bank_mask:0xf
    s_nop 1
    v_max_u32 v20, v20, v20 row_mirror row_mask:0xf bank_mask:0xf
    s_nop 1
    v_max_u32 v20, v20, v20 row_bcast:15 row_mask:0xa bank_mask:0xf
    s_nop 1
    v_max_u32 v20, v20, v20 row_bcast:31 row_mask:0xc bank_mask:0xf
    s_nop 0
    v_readlane_b32 s16, v20, 63
    s_nop 1
    v_mov_b32 v3, s16
    s_lshl_b32 s17, s12, 2
    v_mov_b32 v4, s17
    ds_write_b32 v4, v3
    s_waitcnt lgkmcnt(0)
    s_barrier
    s_cmp_lg_u32 s12, 0
    s_cbranch_scc1 L_A_end
    v_and_b32 v4, 7, v2
    v_lshlrev_b32 v4, 2, v4
    ds_read_b32 v20, v4
    s_waitcnt lgkmcnt(0)
    v_max_u32 v20, v20, v20 quad_perm:[1,0,3,2] row_mask:0xf bank_mask:0xf
    s_nop 1
    v_max_u32 v20, v20, v20 quad_perm:[2,3,0,1] row_mask:0xf bank_mask:0xf
    s_nop 1
    v_max_u32 v20, v20, v20 row_half_mirror row_mask:0xf bank_mask:0xf
    s_nop 1
    v_max_u32 v20, v20, v20 row_mirror row_mask:0xf bank_mask:0xf
    s_nop 1
    v_max_u32 v20, v20, v20 row_bcast:15 row_mask:0xa bank_mask:0xf
    s_nop 1
    v_max_u32 v20, v20, v20 row_bcast:31 row_mask:0xc bank_mask:0xf
    s_nop 0
    v_readlane_b32 s16, v20, 63
    s_add_u32 s14, s6, 0x1c00000
    s_addc_u32 s15, s7, 0
    v_mov_b32 v3, s16
    v_mov_b32 v5, 0
    s_lshl_b32 s17, s33, 2
    v_mov_b32 v4, s17
    s_mov_b64 exec, 1
    global_store_dword v4, v3, s[14:15]
    global_store_dword v4, v5, s[14:15] offset:384
    global_store_dword v4, v5, s[14:15] offset:768
    s_endpgm
L_prepF:
    s_cmp_ge_u32 s2, 472
    s_cbranch_scc1 L_prefetch
    s_load_dwordx2 s[8:9], s[0:1], 32
    s_load_dwordx2 s[10:11], s[0:1], 40
    v_lshrrev_b32 v1, 6, v0
    v_and_b32 v2, 63, v0
    s_nop 0
    v_readfirstlane_b32 s12, v1
    s_sub_u32 s13, s2, 352
    s_lshl_b32 s13, s13, 3
    s_add_u32 s13, s13, s12
    s_mov_b32 s24, 0x05040100
    s_mov_b32 s25, 0x07060302
    s_mul_i32 s14, s13, 5462
    s_lshr_b32 s14, s14, 16
    s_mul_i32 s15, s14, 12
    s_sub_u32 s15, s13, s15
    s_and_b32 s16, s14, 3
    s_lshr_b32 s17, s14, 2
    s_lshl_b32 s18, s17, 5
    s_lshl_b32 s19, s16, 3
    s_add_u32 s18, s18, s19
    s_mul_i32 s18, s18, 3072
    s_lshl_b32 s19, s15, 8
    s_add_u32 s18, s18, s19
    v_lshl_add_u32 v3, v2, 2, s18
    v_add_u32 v4, 12288, v3
    v_add_u32 v5, 6144, v3
    v_add_u32 v6, 18432, v3
    s_waitcnt lgkmcnt(0)
    global_load_dword v8, v3, s[8:9] offset:0
    global_load_dword v9, v3, s[8:9] offset:3072
    global_load_dword v10, v5, s[8:9] offset:0
    global_load_dword v11, v5, s[8:9] offset:3072
    global_load_dword v12, v4, s[8:9] offset:0
    global_load_dword v13, v4, s[8:9] offset:3072
    global_load_dword v14, v6, s[8:9] offset:0
    global_load_dword v15, v6, s[8:9] offset:3072
    s_mul_i32 s26, s13, 13108
    s_lshr_b32 s26, s26, 16
    s_mul_i32 s27, s26, 5
    s_sub_u32 s27, s13, s27
    s_and_b32 s28, s26, 3
    s_lshr_b32 s29, s26, 2
    s_lshl_b32 s30, s29, 5
    s_lshl_b32 s31, s28, 2
    s_add_u32 s30, s30, s31
    s_mul_i32 s30, s30, 1280
    s_lshl_b32 s31, s27, 8
    s_add_u32 s30, s30, s31
    v_lshl_add_u32 v24, v2, 2, s30
    v_add_u32 v25, 20480, v24
    global_load_dword v28, v24, s[10:11] offset:0
    global_load_dword v29, v24, s[10:11] offset:1280
    global_load_dword v30, v24, s[10:11] offset:2560
    global_load_dword v31, v24, s[10:11] offset:3840
    global_load_dword v32, v25, s[10:11] offset:0
    global_load_dword v33, v25, s[10:11] offset:1280
    global_load_dword v34, v25, s[10:11] offset:2560
    global_load_dword v35, v25, s[10:11] offset:3840
    s_lshl_b32 s19, s15, 7
    v_lshl_add_u32 v16, v2, 1, s19
    v_mul_u32_u24 v17, 683, v16
    v_lshrrev_b32 v17, 16, v17
    v_mul_u32_u24 v18, 96, v17
    v_sub_u32 v18, v16, v18
    v_lshrrev_b32 v18, 4, v18
    v_mul_u32_u24 v17, 120, v17
    v_add_u32 v17, v17, v18
    s_mul_i32 s19, s17, 6
    v_add_u32 v17, s19, v17
    v_lshlrev_b32 v17, 10, v17
    v_and_b32 v18, 15, v16
    v_lshl_add_u32 v17, v18, 4, v17
    s_lshl_b32 s19, s16, 8
    s_add_u32 s19, s19, 0x1800000
    v_add_u32 v17, s19, v17
    s_lshl_b32 s19, s27, 7
    v_lshl_add_u32 v36, v2, 1, s19
    v_mul_u32_u24 v37, 820, v36
    v_lshrrev_b32 v37, 16, v37
    v_mul_u32_u24 v38, 80, v37
    v_sub_u32 v38, v36, v38
    v_lshrrev_b32 v38, 4, v38
    v_mul_u32_u24 v37, 240, v37
    v_add_u32 v37, v37, v38
    s_mul_i32 s19, s29, 5
    v_add_u32 v37, s19, v37
    v_lshlrev_b32 v37, 10, v37
    v_and_b32 v38, 15, v36
    v_lshl_add_u32 v37, v38, 4, v37
    s_lshl_b32 s19, s28, 8
    s_add_u32 s19, s19, 0x1a00000
    v_add_u32 v37, s19, v37
    s_waitcnt vmcnt(8)
    v_perm_b32 v40, v9, v8, s24
    v_perm_b32 v44, v9, v8, s25
    v_perm_b32 v41, v11, v10, s24
    v_perm_b32 v45, v11, v10, s25
    v_perm_b32 v42, v13, v12, s24
    v_perm_b32 v46, v13, v12, s25
    v_perm_b32 v43, v15, v14, s24
    v_perm_b32 v47, v15, v14, s25
    global_store_dwordx4 v17, v[40:43], s[6:7]
    global_store_dwordx4 v17, v[44:47], s[6:7] offset:16
    s_waitcnt vmcnt(2)
    v_perm_b32 v48, v29, v28, s24
    v_perm_b32 v52, v29, v28, s25
    v_perm_b32 v49, v31, v30, s24
    v_perm_b32 v53, v31, v30, s25
    v_perm_b32 v50, v33, v32, s24
    v_perm_b32 v54, v33, v32, s25
    v_perm_b32 v51, v35, v34, s24
    v_perm_b32 v55, v35, v34, s25
    global_store_dwordx4 v37, v[48:51], s[6:7]
    global_store_dwordx4 v37, v[52:55], s[6:7] offset:16
    s_endpgm
L_prefetch:
    s_cmp_ge_u32 s2, 480
    s_cbranch_scc1 L_A_end
    s_getpc_b64 s[8:9]
.Lpc_P:
    s_sub_u32 s8, s8, .Lpc_P-a1_kernel
    s_subb_u32 s9, s9, 0
    v_lshlrev_b32 v1, 6, v0
    s_mov_b32 s10, (cdna_tbl_end-a1_kernel+32767)/32768
L_pf_loop:
    v_cmp_gt_u32 vcc, cdna_tbl_end-a1_kernel, v1
    s_nop 0
    s_and_saveexec_b64 s[12:13], vcc
    s_cbranch_execz L_pf_done
    global_load_dword v2, v1, s[8:9]
    s_mov_b64 exec, s[12:13]
    v_add_u32 v1, 0x8000, v1
    s_sub_u32 s10, s10, 1
    s_cmp_lg_u32 s10, 0
    s_cbranch_scc1 L_pf_loop
L_pf_done:
    s_endpgm
.globl b_kernel
.p2align 8
.type b_kernel,@function
b_kernel:
    s_load_dwordx2 s[6:7], s[0:1], 64
    s_cmp_ge_u32 s2, 321
    s_cbranch_scc1 L_B_end
    s_cmp_lt_u32 s2, 256
    s_cbranch_scc1 L_B_noprio
    s_setprio 3
L_B_noprio:
    s_and_b32 s13, s2, 7
    s_lshr_b32 s14, s2, 3
    s_lshl_b32 s13, s13, 1
    s_cmp_ge_u32 s14, 11
    s_cselect_b32 s15, 1, 0
    s_add_u32 s16, s13, s15
    s_mul_i32 s16, s16, 20
    s_mul_i32 s15, s15, 11
    s_sub_u32 s15, s14, s15
    s_add_u32 s16, s16, s15
    s_sub_u32 s17, s14, 22
    s_cmp_ge_u32 s17, 9
    s_cselect_b32 s15, 1, 0
    s_add_u32 s18, s13, s15
    s_mul_i32 s18, s18, 20
    s_mul_i32 s15, s15, 9
    s_sub_u32 s15, s17, s15
    s_add_u32 s18, s18, s15
    s_sub_u32 s18, 319, s18
    s_cmp_lt_u32 s14, 22
    s_cselect_b32 s16, s16, s18
    s_cmp_eq_u32 s2, 320
    s_cselect_b32 s2, 320, s16
    v_lshrrev_b32 v1, 6, v0
    v_and_b32 v2, 63, v0
    v_readfirstlane_b32 s10, v1
    v_and_b32 v3, 15, v2
    v_lshrrev_b32 v4, 4, v2
    v_lshlrev_b32 v6, 4, v2
    v_lshrrev_b32 v7, 1, v4
    v_and_b32 v8, 1, v4
    v_lshlrev_b32 v5, 10, v7
    v_lshl_add_u32 v5, v3, 5, v5
    v_lshl_add_u32 v5, v8, 4, v5
    s_lshl_b32 s11, s2, 13
    s_getpc_b64 s[8:9]
.Lpc_B:
    s_add_u32 s8, s8, cdna_tbl-.Lpc_B+10240
    s_addc_u32 s9, s9, 0
    s_lshl_b32 s14, s10, 12
    s_add_u32 s16, s8, s14
    s_addc_u32 s17, s9, 0
    s_lshl_b32 s14, s10, 10
    s_add_u32 s8, s8, 16384
    s_addc_u32 s9, s9, 0
    s_add_u32 s8, s8, s14
    s_addc_u32 s9, s9, 0
    s_add_u32 s15, s14, 16896
    s_mov_b32 m0, s15
    s_lshl_b32 s14, s10, 11
    global_load_lds_dwordx4 v6, s[8:9]
    s_add_u32 s15, s14, 8704
    s_add_u32 s12, s11, s14
    s_waitcnt lgkmcnt(0)
    s_add_u32 s4, s6, s12
    s_addc_u32 s5, s7, 0
    s_mov_b32 m0, s15
    s_nop 0
    global_load_lds_dwordx4 v6, s[4:5]
    global_load_lds_dwordx4 v6, s[4:5] offset:1024
    global_load_dwordx4 v[64:67], v6, s[16:17] offset:0
    global_load_dwordx4 v[68:71], v6, s[16:17] offset:1024
    global_load_dwordx4 v[72:75], v6, s[16:17] offset:2048
    global_load_dwordx4 v[76:79], v6, s[16:17] offset:3072
    s_add_u32 s18, s6, 0x1c00000
    s_addc_u32 s19, s7, 0
    s_lshl_b32 s14, s10, 11
    s_add_u32 s14, s14, s11
    s_add_u32 s14, s14, 0x1500000
    s_add_u32 s20, s6, s14
    s_addc_u32 s21, s7, 0
    v_lshlrev_b32 v9, 5, v2
    s_mov_b32 s22, 0xffff0000
    s_mov_b32 s23, 0xbc003c00
    global_load_dwordx4 v[120:123], v6, s[18:19]
    global_load_dwordx4 v[112:115], v9, s[20:21]
    global_load_dwordx4 v[116:119], v9, s[20:21] offset:16
    s_mul_i32 s24, s2, 3277
    s_lshr_b32 s24, s24, 16
    s_mul_i32 s25, s24, 20
    s_sub_u32 s25, s2, s25
    s_sub_u32 s26, 640, s2
    s_mul_i32 s27, s26, 3277
    s_lshr_b32 s27, s27, 16
    s_mul_i32 s28, s27, 20
    s_sub_u32 s28, s26, s28
    s_bfe_u32 s29, s24, 0x30001
    s_lshl_b32 s29, s29, 2
    s_bfe_u32 s32, s24, 0x10004
    s_lshl_b32 s32, s32, 1
    s_add_u32 s29, s29, s32
    s_and_b32 s32, s24, 1
    s_add_u32 s29, s29, s32
    s_mul_i32 s29, s29, 12
    s_add_u32 s29, s29, s25
    s_lshl_b32 s30, s29, 4
    s_bfe_u32 s29, s27, 0x30001
    s_lshl_b32 s29, s29, 2
    s_bfe_u32 s32, s27, 0x10004
    s_lshl_b32 s32, s32, 1
    s_add_u32 s29, s29, s32
    s_and_b32 s32, s27, 1
    s_add_u32 s29, s29, s32
    s_mul_i32 s29, s29, 12
    s_add_u32 s29, s29, s28
    s_lshl_b32 s31, s29, 4
    s_lshl_b32 s29, s10, 6
    v_lshl_add_u32 v10, v7, 5, v3
    v_add_u32 v10, s29, v10
    v_mul_u32_u24 v10, 12288, v10
    v_mul_u32_u24 v11, 6144, v8
    v_add_u32 v10, v10, v11
    v_mul_u32_u24 v12, 1088, v4
    v_lshl_add_u32 v12, v3, 2, v12
    v_add_u32 v12, s29, v12
    v_mul_u32_u24 v13, 272, v3
    v_lshl_add_u32 v13, v4, 4, v13
    s_lshl_b32 s29, s10, 4
    v_add_u32 v14, s29, v3
    v_cvt_f32_u32 v14, v14
    v_mul_f32 v14, 0x3a000000, v14
    v_lshlrev_b32 v15, 2, v4
    v_cvt_f32_u32 v15, v15
    v_add_f32 v140, 0x0, v15
    v_add_f32 v141, 1.0, v15
    v_add_f32 v142, 2.0, v15
    v_add_f32 v143, 0x40400000, v15
    v_add_f32 v144, 0x41800000, v15
    v_add_f32 v145, 0x41880000, v15
    v_add_f32 v146, 0x41900000, v15
    v_add_f32 v147, 0x41980000, v15
    v_mul_f32 v140, v140, v14
    v_mul_f32 v141, v141, v14
    v_mul_f32 v142, v142, v14
    v_mul_f32 v143, v143, v14
    v_mul_f32 v144, v144, v14
    v_mul_f32 v145, v145, v14
    v_mul_f32 v146, v146, v14
    v_mul_f32 v147, v147, v14
    v_cos_f32 v96, v140
    v_sin_f32 v97, -v140
    v_cos_f32 v98, v141
    v_sin_f32 v99, -v141
    v_cos_f32 v100, v142
    v_sin_f32 v101, -v142
    v_cos_f32 v102, v143
    v_sin_f32 v103, -v143
    v_cos_f32 v104, v144
    v_sin_f32 v105, -v144
    v_cos_f32 v106, v145
    v_sin_f32 v107, -v145
    v_cos_f32 v108, v146
    v_sin_f32 v109, -v146
    v_cos_f32 v110, v147
    v_sin_f32 v111, -v147
    s_waitcnt vmcnt(7)
    s_barrier
    ds_read_b128 v[16:19], v5 offset:8704
    ds_read_b128 v[32:35], v5 offset:9216
    ds_read_b128 v[20:23], v5 offset:10752
    ds_read_b128 v[36:39], v5 offset:11264
    ds_read_b128 v[24:27], v5 offset:12800
    ds_read_b128 v[40:43], v5 offset:13312
    ds_read_b128 v[28:31], v5 offset:14848
    ds_read_b128 v[44:47], v5 offset:15360
    ds_read_b128 v[80:83], v6 offset:16896
    ds_read_b128 v[84:87], v6 offset:17920
    ds_read_b128 v[88:91], v6 offset:18944
    ds_read_b128 v[92:95], v6 offset:19968
    s_waitcnt vmcnt(3)
    s_waitcnt lgkmcnt(10)
    v_pk_mul_f16 v48, v16, s23 op_sel:[1,0] op_sel_hi:[0,1]
    v_pk_mul_f16 v49, v17, s23 op_sel:[1,0] op_sel_hi:[0,1]
    v_pk_mul_f16 v50, v18, s23 op_sel:[1,0] op_sel_hi:[0,1]
    v_pk_mul_f16 v51, v19, s23 op_sel:[1,0] op_sel_hi:[0,1]
    v_pk_mul_f16 v52, v32, s23 op_sel:[1,0] op_sel_hi:[0,1]
    v_pk_mul_f16 v53, v33, s23 op_sel:[1,0] op_sel_hi:[0,1]
    v_pk_mul_f16 v54, v34, s23 op_sel:[1,0] op_sel_hi:[0,1]
    v_pk_mul_f16 v55, v35, s23 op_sel:[1,0] op_sel_hi:[0,1]
    v_mfma_f32_16x16x32_f16 v[124:127], v[16:19], v[64:67], 0
    v_mfma_f32_16x16x32_f16 v[132:135], v[48:51], v[64:67], 0
    v_mfma_f32_16x16x32_f16 v[128:131], v[32:35], v[64:67], 0
    v_mfma_f32_16x16x32_f16 v[136:139], v[52:55], v[64:67], 0
    s_waitcnt lgkmcnt(8)
    v_pk_mul_f16 v56, v20, s23 op_sel:[1,0] op_sel_hi:[0,1]
    v_pk_mul_f16 v57, v21, s23 op_sel:[1,0] op_sel_hi:[0,1]
    v_pk_mul_f16 v58, v22, s23 op_sel:[1,0] op_sel_hi:[0,1]
    v_pk_mul_f16 v59, v23, s23 op_sel:[1,0] op_sel_hi:[0,1]
    v_pk_mul_f16 v60, v36, s23 op_sel:[1,0] op_sel_hi:[0,1]
    v_pk_mul_f16 v61, v37, s23 op_sel:[1,0] op_sel_hi:[0,1]
    v_pk_mul_f16 v62, v38, s23 op_sel:[1,0] op_sel_hi:[0,1]
    v_pk_mul_f16 v63, v39, s23 op_sel:[1,0] op_sel_hi:[0,1]
    v_mfma_f32_16x16x32_f16 v[124:127], v[20:23], v[68:71], v[124:127]
    v_mfma_f32_16x16x32_f16 v[132:135], v[56:59], v[68:71], v[132:135]
    v_mfma_f32_16x16x32_f16 v[128:131], v[36:39], v[68:71], v[128:131]
    v_mfma_f32_16x16x32_f16 v[136:139], v[60:63], v[68:71], v[136:139]
    s_waitcnt lgkmcnt(6)
    v_pk_mul_f16 v48, v24, s23 op_sel:[1,0] op_sel_hi:[0,1]
    v_pk_mul_f16 v49, v25, s23 op_sel:[1,0] op_sel_hi:[0,1]
    v_pk_mul_f16 v50, v26, s23 op_sel:[1,0] op_sel_hi:[0,1]
    v_pk_mul_f16 v51, v27, s23 op_sel:[1,0] op_sel_hi:[0,1]
    v_pk_mul_f16 v52, v40, s23 op_sel:[1,0] op_sel_hi:[0,1]
    v_pk_mul_f16 v53, v41, s23 op_sel:[1,0] op_sel_hi:[0,1]
    v_pk_mul_f16 v54, v42, s23 op_sel:[1,0] op_sel_hi:[0,1]
    v_pk_mul_f16 v55, v43, s23 op_sel:[1,0] op_sel_hi:[0,1]
    v_mfma_f32_16x16x32_f16 v[124:127], v[24:27], v[72:75], v[124:127]
    v_mfma_f32_16x16x32_f16 v[132:135], v[48:51], v[72:75], v[132:135]
    v_mfma_f32_16x16x32_f16 v[128:131], v[40:43], v[72:75], v[128:131]
    v_mfma_f32_16x16x32_f16 v[136:139], v[52:55], v[72:75], v[136:139]
    s_waitcnt lgkmcnt(4)
    v_pk_mul_f16 v56, v28, s23 op_sel:[1,0] op_sel_hi:[0,1]
    v_pk_mul_f16 v57, v29, s23 op_sel:[1,0] op_sel_hi:[0,1]
    v_pk_mul_f16 v58, v30, s23 op_sel:[1,0] op_sel_hi:[0,1]
    v_pk_mul_f16 v59, v31, s23 op_sel:[1,0] op_sel_hi:[0,1]
    v_pk_mul_f16 v60, v44, s23 op_sel:[1,0] op_sel_hi:[0,1]
    v_pk_mul_f16 v61, v45, s23 op_sel:[1,0] op_sel_hi:[0,1]
    v_pk_mul_f16 v62, v46, s23 op_sel:[1,0] op_sel_hi:[0,1]
    v_pk_mul_f16 v63, v47, s23 op_sel:[1,0] op_sel_hi:[0,1]
    v_mfma_f32_16x16x32_f16 v[124:127], v[28:31], v[76:79], v[124:127]
    v_mfma_f32_16x16x32_f16 v[132:135], v[56:59], v[76:79], v[132:135]
    v_mfma_f32_16x16x32_f16 v[128:131], v[44:47], v[76:79], v[128:131]
    v_mfma_f32_16x16x32_f16 v[136:139], v[60:63], v[76:79], v[136:139]
    s_waitcnt vmcnt(2)
    v_max3_u32 v120, v120, v121, v122
    v_max_u32 v120, v120, v123
    s_nop 1
    v_max_u32 v120, v120, v120 quad_perm:[1,0,3,2] row_mask:0xf bank_mask:0xf
    s_nop 1
    v_max_u32 v120, v120, v120 quad_perm:[2,3,0,1] row_mask:0xf bank_mask:0xf
    s_nop 1
    v_max_u32 v120, v120, v120 row_half_mirror row_mask:0xf bank_mask:0xf
    s_nop 1
    v_max_u32 v120, v120, v120 row_mirror row_mask:0xf bank_mask:0xf
    s_nop 1
    v_max_u32 v120, v120, v120 row_bcast:15 row_mask:0xa bank_mask:0xf
    s_nop 1
    v_max_u32 v120, v120, v120 row_bcast:31 row_mask:0xc bank_mask:0xf
    s_nop 0
    v_readlane_b32 s18, v120, 63
    s_nop 0
    s_lshr_b32 s18, s18, 7
    s_min_u32 s18, s18, 252
    s_max_u32 s18, s18, 3
    s_sub_u32 s19, 253, s18
    s_lshl_b32 s19, s19, 23
    v_mul_f32 v140, v132, v97
    v_mul_f32 v141, v132, v96
    v_mul_f32 v142, v133, v99
    v_mul_f32 v143, v133, v98
    v_mul_f32 v144, v134, v101
    v_mul_f32 v145, v134, v100
    v_mul_f32 v146, v135, v103
    v_mul_f32 v147, v135, v102
    v_mul_f32 v148, v136, v105
    v_mul_f32 v149, v136, v104
    v_mul_f32 v150, v137, v107
    v_mul_f32 v151, v137, v106
    v_mul_f32 v152, v138, v109
    v_mul_f32 v153, v138, v108
    v_mul_f32 v154, v139, v111
    v_mul_f32 v155, v139, v110
    v_fma_mixlo_f16 v156, v124, v96, -v140
    v_fma_mixlo_f16 v157, v125, v98, -v142
    v_fma_mixlo_f16 v158, v126, v100, -v144
    v_fma_mixlo_f16 v159, v127, v102, -v146
    v_fma_mixlo_f16 v160, v128, v104, -v148
    v_fma_mixlo_f16 v161, v129, v106, -v150
    v_fma_mixlo_f16 v162, v130, v108, -v152
    v_fma_mixlo_f16 v163, v131, v110, -v154
    v_fma_mixhi_f16 v156, v124, v97, v141
    v_fma_mixhi_f16 v157, v125, v99, v143
    v_fma_mixhi_f16 v158, v126, v101, v145
    v_fma_mixhi_f16 v159, v127, v103, v147
    v_fma_mixhi_f16 v160, v128, v105, v149
    v_fma_mixhi_f16 v161, v129, v107, v151
    v_fma_mixhi_f16 v162, v130, v109, v153
    v_fma_mixhi_f16 v163, v131, v111, v155
    v_pk_mul_f16 v48, v156, s23 op_sel:[1,0] op_sel_hi:[0,1]
    v_pk_mul_f16 v49, v157, s23 op_sel:[1,0] op_sel_hi:[0,1]
    v_pk_mul_f16 v50, v158, s23 op_sel:[1,0] op_sel_hi:[0,1]
    v_pk_mul_f16 v51, v159, s23 op_sel:[1,0] op_sel_hi:[0,1]
    v_pk_mul_f16 v52, v160, s23 op_sel:[1,0] op_sel_hi:[0,1]
    v_pk_mul_f16 v53, v161, s23 op_sel:[1,0] op_sel_hi:[0,1]
    v_pk_mul_f16 v54, v162, s23 op_sel:[1,0] op_sel_hi:[0,1]
    v_pk_mul_f16 v55, v163, s23 op_sel:[1,0] op_sel_hi:[0,1]
    s_waitcnt lgkmcnt(0)
    v_mfma_f32_16x16x32_f16 v[124:127], v[80:83], v[156:159], 0
    v_mfma_f32_16x16x32_f16 v[132:135], v[80:83], v[48:51], 0
    v_mfma_f32_16x16x32_f16 v[128:131], v[88:91], v[156:159], 0
    v_mfma_f32_16x16x32_f16 v[136:139], v[88:91], v[48:51], 0
    v_mfma_f32_16x16x32_f16 v[124:127], v[84:87], v[160:163], v[124:127]
    v_mfma_f32_16x16x32_f16 v[132:135], v[84:87], v[52:55], v[132:135]
    v_mfma_f32_16x16x32_f16 v[128:131], v[92:95], v[160:163], v[128:131]
    v_mfma_f32_16x16x32_f16 v[136:139], v[92:95], v[52:55], v[136:139]
    s_waitcnt vmcnt(0)
    v_lshlrev_b32 v16, 16, v112
    v_and_b32 v17, s22, v112
    v_lshlrev_b32 v18, 16, v113
    v_and_b32 v19, s22, v113
    v_lshlrev_b32 v20, 16, v114
    v_and_b32 v21, s22, v114
    v_lshlrev_b32 v22, 16, v115
    v_and_b32 v23, s22, v115
    v_lshlrev_b32 v24, 16, v116
    v_and_b32 v25, s22, v116
    v_lshlrev_b32 v26, 16, v117
    v_and_b32 v27, s22, v117
    v_lshlrev_b32 v28, 16, v118
    v_and_b32 v29, s22, v118
    v_lshlrev_b32 v30, 16, v119
    v_and_b32 v31, s22, v119
    s_mov_b32 s32, s19
    s_mov_b32 s33, s19
    v_pk_mul_f32 v[16:17], v[16:17], s[32:33]
    v_pk_mul_f32 v[18:19], v[18:19], s[32:33]
    v_pk_mul_f32 v[20:21], v[20:21], s[32:33]
    v_pk_mul_f32 v[22:23], v[22:23], s[32:33]
    v_pk_mul_f32 v[24:25], v[24:25], s[32:33]
    v_pk_mul_f32 v[26:27], v[26:27], s[32:33]
    v_pk_mul_f32 v[28:29], v[28:29], s[32:33]
    v_pk_mul_f32 v[30:31], v[30:31], s[32:33]
    v_mul_f32 v140, v132, v17
    v_mul_f32 v141, v132, v16
    v_mul_f32 v142, v133, v19
    v_mul_f32 v143, v133, v18
    v_mul_f32 v144, v134, v21
    v_mul_f32 v145, v134, v20
    v_mul_f32 v146, v135, v23
    v_mul_f32 v147, v135, v22
    v_mul_f32 v148, v136, v25
    v_mul_f32 v149, v136, v24
    v_mul_f32 v150, v137, v27
    v_mul_f32 v151, v137, v26
    v_mul_f32 v152, v138, v29
    v_mul_f32 v153, v138, v28
    v_mul_f32 v154, v139, v31
    v_mul_f32 v155, v139, v30
    v_fma_mixlo_f16 v156, v124, v16, -v140
    v_fma_mixlo_f16 v157, v125, v18, -v142
    v_fma_mixlo_f16 v158, v126, v20, -v144
    v_fma_mixlo_f16 v159, v127, v22, -v146
    v_fma_mixlo_f16 v160, v128, v24, -v148
    v_fma_mixlo_f16 v161, v129, v26, -v150
    v_fma_mixlo_f16 v162, v130, v28, -v152
    v_fma_mixlo_f16 v163, v131, v30, -v154
    v_fma_mixhi_f16 v156, -v124, v17, -v141
    v_fma_mixhi_f16 v157, -v125, v19, -v143
    v_fma_mixhi_f16 v158, -v126, v21, -v145
    v_fma_mixhi_f16 v159, -v127, v23, -v147
    v_fma_mixhi_f16 v160, -v128, v25, -v149
    v_fma_mixhi_f16 v161, -v129, v27, -v151
    v_fma_mixhi_f16 v162, -v130, v29, -v153
    v_fma_mixhi_f16 v163, -v131, v31, -v155
    v_pk_mul_f16 v48, v156, s23 op_sel:[1,0] op_sel_hi:[0,1]
    v_pk_mul_f16 v49, v157, s23 op_sel:[1,0] op_sel_hi:[0,1]
    v_pk_mul_f16 v50, v158, s23 op_sel:[1,0] op_sel_hi:[0,1]
    v_pk_mul_f16 v51, v159, s23 op_sel:[1,0] op_sel_hi:[0,1]
    v_pk_mul_f16 v52, v160, s23 op_sel:[1,0] op_sel_hi:[0,1]
    v_pk_mul_f16 v53, v161, s23 op_sel:[1,0] op_sel_hi:[0,1]
    v_pk_mul_f16 v54, v162, s23 op_sel:[1,0] op_sel_hi:[0,1]
    v_pk_mul_f16 v55, v163, s23 op_sel:[1,0] op_sel_hi:[0,1]
    v_mfma_f32_16x16x32_f16 v[124:127], v[80:83], v[156:159], 0
    v_mfma_f32_16x16x32_f16 v[132:135], v[80:83], v[48:51], 0
    v_mfma_f32_16x16x32_f16 v[128:131], v[88:91], v[156:159], 0
    v_mfma_f32_16x16x32_f16 v[136:139], v[88:91], v[48:51], 0
    v_mfma_f32_16x16x32_f16 v[124:127], v[84:87], v[160:163], v[124:127]
    v_mfma_f32_16x16x32_f16 v[132:135], v[84:87], v[52:55], v[132:135]
    v_mfma_f32_16x16x32_f16 v[128:131], v[92:95], v[160:163], v[128:131]
    v_mfma_f32_16x16x32_f16 v[136:139], v[92:95], v[52:55], v[136:139]
    s_or_b32 s29, s2, s10
    s_cmp_lg_u32 s29, 0
    s_cbranch_scc1 L_B_noE
    s_add_u32 s20, s6, 0x1c01000
    s_addc_u32 s21, s7, 0
    v_mov_b32 v14, s18
    v_mov_b32 v15, 0
    s_mov_b64 exec, 1
    global_store_dword v15, v14, s[20:21]
    s_mov_b64 exec, -1
L_B_noE:
    s_nop 7
    s_nop 3
    v_mul_f32 v140, v132, v97
    v_mul_f32 v141, v132, v96
    v_mul_f32 v142, v133, v99
    v_mul_f32 v143, v133, v98
    v_mul_f32 v144, v134, v101
    v_mul_f32 v145, v134, v100
    v_mul_f32 v146, v135, v103
    v_mul_f32 v147, v135, v102
    v_mul_f32 v148, v136, v105
    v_mul_f32 v149, v136, v104
    v_mul_f32 v150, v137, v107
    v_mul_f32 v151, v137, v106
    v_mul_f32 v152, v138, v109
    v_mul_f32 v153, v138, v108
    v_mul_f32 v154, v139, v111
    v_mul_f32 v155, v139, v110
    v_fma_mixlo_f16 v156, v124, v96, -v140
    v_fma_mixlo_f16 v157, v125, v98, -v142
    v_fma_mixlo_f16 v158, v126, v100, -v144
    v_fma_mixlo_f16 v159, v127, v102, -v146
    v_fma_mixlo_f16 v160, v128, v104, -v148
    v_fma_mixlo_f16 v161, v129, v106, -v150
    v_fma_mixlo_f16 v162, v130, v108, -v152
    v_fma_mixlo_f16 v163, v131, v110, -v154
    v_fma_mixhi_f16 v156, v124, v97, v141
    v_fma_mixhi_f16 v157, v125, v99, v143
    v_fma_mixhi_f16 v158, v126, v101, v145
    v_fma_mixhi_f16 v159, v127, v103, v147
    v_fma_mixhi_f16 v160, v128, v105, v149
    v_fma_mixhi_f16 v161, v129, v107, v151
    v_fma_mixhi_f16 v162, v130, v109, v153
    v_fma_mixhi_f16 v163, v131, v111, v155
    ds_write_b32 v12, v156 offset:0
    ds_write_b32 v12, v157 offset:272
    ds_write_b32 v12, v158 offset:544
    ds_write_b32 v12, v159 offset:816
    ds_write_b32 v12, v160 offset:4352
    ds_write_b32 v12, v161 offset:4624
    ds_write_b32 v12, v162 offset:4896
    ds_write_b32 v12, v163 offset:5168
    s_waitcnt lgkmcnt(0)
    s_barrier
    ds_read_b128 v[16:19], v13 offset:0
    ds_read_b128 v[20:23], v13 offset:64
    ds_read_b128 v[24:27], v13 offset:128
    ds_read_b128 v[28:31], v13 offset:192
    ds_read_b128 v[32:35], v13 offset:4352
    ds_read_b128 v[36:39], v13 offset:4416
    ds_read_b128 v[40:43], v13 offset:4480
    ds_read_b128 v[44:47], v13 offset:4544
    s_waitcnt lgkmcnt(4)
    v_pk_mul_f16 v48, v16, s23 op_sel:[1,0] op_sel_hi:[0,1]
    v_pk_mul_f16 v49, v17, s23 op_sel:[1,0] op_sel_hi:[0,1]
    v_pk_mul_f16 v50, v18, s23 op_sel:[1,0] op_sel_hi:[0,1]
    v_pk_mul_f16 v51, v19, s23 op_sel:[1,0] op_sel_hi:[0,1]
    v_pk_mul_f16 v52, v20, s23 op_sel:[1,0] op_sel_hi:[0,1]
    v_pk_mul_f16 v53, v21, s23 op_sel:[1,0] op_sel_hi:[0,1]
    v_pk_mul_f16 v54, v22, s23 op_sel:[1,0] op_sel_hi:[0,1]
    v_pk_mul_f16 v55, v23, s23 op_sel:[1,0] op_sel_hi:[0,1]
    v_pk_mul_f16 v56, v24, s23 op_sel:[1,0] op_sel_hi:[0,1]
    v_pk_mul_f16 v57, v25, s23 op_sel:[1,0] op_sel_hi:[0,1]
    v_pk_mul_f16 v58, v26, s23 op_sel:[1,0] op_sel_hi:[0,1]
    v_pk_mul_f16 v59, v27, s23 op_sel:[1,0] op_sel_hi:[0,1]
    v_pk_mul_f16 v60, v28, s23 op_sel:[1,0] op_sel_hi:[0,1]
    v_pk_mul_f16 v61, v29, s23 op_sel:[1,0] op_sel_hi:[0,1]
    v_pk_mul_f16 v62, v30, s23 op_sel:[1,0] op_sel_hi:[0,1]
    v_pk_mul_f16 v63, v31, s23 op_sel:[1,0] op_sel_hi:[0,1]
    v_mfma_f32_16x16x32_f16 v[124:127], v[64:67], v[16:19], 0
    v_mfma_f32_16x16x32_f16 v[132:135], v[64:67], v[48:51], 0
    v_mfma_f32_16x16x32_f16 v[124:127], v[68:71], v[20:23], v[124:127]
    v_mfma_f32_16x16x32_f16 v[132:135], v[68:71], v[52:55], v[132:135]
    v_mfma_f32_16x16x32_f16 v[124:127], v[72:75], v[24:27], v[124:127]
    v_mfma_f32_16x16x32_f16 v[132:135], v[72:75], v[56:59], v[132:135]
    v_mfma_f32_16x16x32_f16 v[124:127], v[76:79], v[28:31], v[124:127]
    v_mfma_f32_16x16x32_f16 v[132:135], v[76:79], v[60:63], v[132:135]
    s_waitcnt lgkmcnt(0)
    v_pk_mul_f16 v140, v32, s23 op_sel:[1,0] op_sel_hi:[0,1]
    v_pk_mul_f16 v141, v33, s23 op_sel:[1,0] op_sel_hi:[0,1]
    v_pk_mul_f16 v142, v34, s23 op_sel:[1,0] op_sel_hi:[0,1]
    v_pk_mul_f16 v143, v35, s23 op_sel:[1,0] op_sel_hi:[0,1]
    v_pk_mul_f16 v144, v36, s23 op_sel:[1,0] op_sel_hi:[0,1]
    v_pk_mul_f16 v145, v37, s23 op_sel:[1,0] op_sel_hi:[0,1]
    v_pk_mul_f16 v146, v38, s23 op_sel:[1,0] op_sel_hi:[0,1]
    v_pk_mul_f16 v147, v39, s23 op_sel:[1,0] op_sel_hi:[0,1]
    v_pk_mul_f16 v148, v40, s23 op_sel:[1,0] op_sel_hi:[0,1]
    v_pk_mul_f16 v149, v41, s23 op_sel:[1,0] op_sel_hi:[0,1]
    v_pk_mul_f16 v150, v42, s23 op_sel:[1,0] op_sel_hi:[0,1]
    v_pk_mul_f16 v151, v43, s23 op_sel:[1,0] op_sel_hi:[0,1]
    v_pk_mul_f16 v152, v44, s23 op_sel:[1,0] op_sel_hi:[0,1]
    v_pk_mul_f16 v153, v45, s23 op_sel:[1,0] op_sel_hi:[0,1]
    v_pk_mul_f16 v154, v46, s23 op_sel:[1,0] op_sel_hi:[0,1]
    v_pk_mul_f16 v155, v47, s23 op_sel:[1,0] op_sel_hi:[0,1]
    v_mfma_f32_16x16x32_f16 v[128:131], v[64:67], v[32:35], 0
    v_mfma_f32_16x16x32_f16 v[136:139], v[64:67], v[140:143], 0
    v_mfma_f32_16x16x32_f16 v[128:131], v[68:71], v[36:39], v[128:131]
    v_mfma_f32_16x16x32_f16 v[136:139], v[68:71], v[144:147], v[136:139]
    v_mfma_f32_16x16x32_f16 v[128:131], v[72:75], v[40:43], v[128:131]
    v_mfma_f32_16x16x32_f16 v[136:139], v[72:75], v[148:151], v[136:139]
    v_mfma_f32_16x16x32_f16 v[128:131], v[76:79], v[44:47], v[128:131]
    v_mfma_f32_16x16x32_f16 v[136:139], v[76:79], v[152:155], v[136:139]
    s_add_u32 s4, s6, 0x300000
    s_addc_u32 s5, s7, 0
    s_add_u32 s8, s4, 196608
    s_addc_u32 s9, s5, 0
    s_cmp_gt_u32 s25, 10
    s_cbranch_scc1 L_B_mirror
    v_cvt_pk_f16_f32 v156, v124, -v132
    v_cvt_pk_f16_f32 v157, v125, -v133
    v_cvt_pk_f16_f32 v158, v126, -v134
    v_cvt_pk_f16_f32 v159, v127, -v135
    v_cvt_pk_f16_f32 v160, v128, -v136
    v_cvt_pk_f16_f32 v161, v129, -v137
    v_cvt_pk_f16_f32 v162, v130, -v138
    v_cvt_pk_f16_f32 v163, v131, -v139
    v_add_u32 v11, s30, v10
    global_store_dwordx4 v11, v[156:159], s[4:5]
    global_store_dwordx4 v11, v[160:163], s[8:9]
    s_cmp_eq_u32 s2, 0
    s_cbranch_scc1 L_B_fin
    s_cmp_eq_u32 s2, 320
    s_cbranch_scc1 L_B_fin
    s_cmp_eq_u32 s25, 0
    s_cbranch_scc1 L_B_mirror
    s_cmp_lt_u32 s25, 10
    s_cbranch_scc1 L_B_fin
L_B_mirror:
    s_nop 7
    s_nop 3
    v_cvt_pk_f16_f32 v48, v124, v132
    v_cvt_pk_f16_f32 v49, v125, v133
    v_cvt_pk_f16_f32 v50, v126, v134
    v_cvt_pk_f16_f32 v51, v127, v135
    v_cvt_pk_f16_f32 v52, v128, v136
    v_cvt_pk_f16_f32 v53, v129, v137
    v_cvt_pk_f16_f32 v54, v130, v138
    v_cvt_pk_f16_f32 v55, v131, v139
    v_add_u32 v11, s31, v10
    global_store_dwordx4 v11, v[48:51], s[4:5]
    global_store_dwordx4 v11, v[52:55], s[8:9]
L_B_fin:
L_B_end:
    s_endpgm
.globl f1_kernel
.p2align 8
.type f1_kernel,@function
f1_kernel:
    s_load_dwordx2 s[6:7], s[0:1], 64
    s_load_dwordx2 s[40:41], s[0:1], 0
    s_cmp_ge_u32 s2, 256
    s_cbranch_scc1 L_F_end
    s_waitcnt lgkmcnt(0)
    s_add_u32 s4, s6, 0x1200000
    s_addc_u32 s5, s7, 0
    s_mov_b32 s34, 0xc00000
    s_mov_b32 s35, 0x1c10000
    s_branch L_F_main
.globl f2_kernel
.p2align 8
.type f2_kernel,@function
f2_kernel:
    s_load_dwordx2 s[6:7], s[0:1], 64
    s_load_dwordx2 s[4:5], s[0:1], 48
    s_cmp_ge_u32 s2, 256
    s_cbranch_scc1 L_F_end
    s_waitcnt lgkmcnt(0)
    s_add_u32 s40, s6, 0x1200000
    s_addc_u32 s41, s7, 0
    s_mov_b32 s34, 0x2000000
    s_mov_b32 s35, 0x1c18000
L_F_main:
    v_lshrrev_b32 v1, 6, v0
    v_and_b32 v2, 63, v0
    v_readfirstlane_b32 s10, v1
    v_lshlrev_b32 v6, 4, v2
    v_and_b32 v3, 15, v2
    v_lshrrev_b32 v4, 4, v2
    s_add_u32 s28, s6, 0x1c01000
    s_addc_u32 s29, s7, 0
    s_load_dword s42, s[28:29], 0
    s_and_b32 s13, s2, 7
    s_lshr_b32 s14, s2, 3
    s_lshr_b32 s11, s13, 1
    s_lshl_b32 s11, s11, 2
    s_and_b32 s15, s14, 3
    s_add_u32 s11, s11, s15
    s_and_b32 s12, s13, 1
    s_lshl_b32 s12, s12, 3
    s_lshr_b32 s15, s14, 2
    s_add_u32 s12, s12, s15
    s_lshl_b32 s36, s11, 1
    s_and_b32 s13, s12, 1
    s_add_u32 s36, s36, s13
    s_bfe_u32 s37, s12, 0x20001
    s_lshr_b32 s13, s12, 3
    s_lshl_b32 s13, s13, 2
    s_add_u32 s37, s37, s13
    s_lshl_b32 s43, s11, 4
    s_add_u32 s43, s43, s12
    s_mul_i32 s13, s43, 12288
    s_mul_i32 s14, s10, 3072
    s_add_u32 s13, s13, s14
    s_add_u32 s13, s13, 0x300000
    s_add_u32 s26, s6, s13
    s_addc_u32 s27, s7, 0
    s_add_u32 s15, s14, 122880
    s_mov_b32 m0, s15
    s_nop 0
    global_load_lds_dwordx4 v6, s[26:27] offset:0
    global_load_lds_dwordx4 v6, s[26:27] offset:1024
    global_load_lds_dwordx4 v6, s[26:27] offset:2048
    s_getpc_b64 s[8:9]
.Lpc_C:
    s_add_u32 s8, s8, cdna_tbl-.Lpc_C+30720
    s_addc_u32 s9, s9, 0
    s_add_u32 s8, s8, s14
    s_addc_u32 s9, s9, 0
    s_add_u32 s15, s14, 135168
    s_mov_b32 m0, s15
    s_nop 0
    global_load_lds_dwordx4 v6, s[8:9]
    s_cmp_eq_u32 s10, 3
    s_cbranch_scc1 L_F_tab_done
    global_load_lds_dwordx4 v6, s[8:9] offset:1024
    global_load_lds_dwordx4 v6, s[8:9] offset:2048
L_F_tab_done:
    s_lshr_b32 s13, s43, 5
    s_lshl_b32 s13, s13, 8
    s_and_b32 s14, s43, 31
    s_add_u32 s13, s13, s14
    s_mul_i32 s44, s13, 1280
    s_lshl_b32 s14, s10, 6
    s_add_u32 s13, s13, s14
    s_mul_i32 s13, s13, 1280
    s_add_u32 s40, s40, s13
    s_addc_u32 s41, s41, 0
    s_add_u32 s46, s40, 40960
    s_addc_u32 s47, s41, 0
    v_mul_u32_u24 v5, 320, v4
    v_lshl_add_u32 v5, v3, 2, v5
    global_load_dword v16, v5, s[40:41] offset:0
    global_load_dword v17, v5, s[40:41] offset:64
    global_load_dword v18, v5, s[40:41] offset:128
    global_load_dword v19, v5, s[40:41] offset:192
    global_load_dword v20, v5, s[40:41] offset:256
    global_load_dword v108, v5, s[46:47] offset:0
    global_load_dword v109, v5, s[46:47] offset:64
    global_load_dword v110, v5, s[46:47] offset:128
    global_load_dword v111, v5, s[46:47] offset:192
    global_load_dword v112, v5, s[46:47] offset:256
    s_mul_i32 s13, s12, 122880
    s_add_u32 s13, s13, 0x1800000
    s_mul_i32 s14, s10, 30720
    s_add_u32 s13, s13, s14
    s_add_u32 s20, s6, s13
    s_addc_u32 s21, s7, 0
    s_mul_i32 s13, s37, 245760
    s_mul_i32 s16, s10, 61440
    s_add_u32 s13, s13, s16
    s_add_u32 s13, s13, 0x1a00000
    s_add_u32 s38, s6, s13
    s_addc_u32 s39, s7, 0
    s_add_u32 s17, s14, 0
    s_mov_b32 m0, s17
    s_nop 0
    global_load_lds_dwordx4 v6, s[20:21] offset:0
    s_add_u32 s17, s14, 0
    s_mov_b32 m0, s17
    s_nop 0
    global_load_lds_dwordx4 v6, s[20:21] offset:1024
    s_add_u32 s17, s14, 0
    s_mov_b32 m0, s17
    s_nop 0
    global_load_lds_dwordx4 v6, s[20:21] offset:2048
    s_add_u32 s17, s14, 0
    s_mov_b32 m0, s17
    s_nop 0
    global_load_lds_dwordx4 v6, s[20:21] offset:3072
    s_add_u32 s20, s20, 4096
    s_addc_u32 s21, s21, 0
    s_add_u32 s17, s14, 4096
    s_mov_b32 m0, s17
    s_nop 0
    global_load_lds_dwordx4 v6, s[20:21] offset:0
    s_add_u32 s17, s14, 4096
    s_mov_b32 m0, s17
    s_nop 0
    global_load_lds_dwordx4 v6, s[20:21] offset:1024
    s_add_u32 s17, s14, 4096
    s_mov_b32 m0, s17
    s_nop 0
    global_load_lds_dwordx4 v6, s[20:21] offset:2048
    s_add_u32 s17, s14, 4096
    s_mov_b32 m0, s17
    s_nop 0
    global_load_lds_dwordx4 v6, s[20:21] offset:3072
    s_add_u32 s20, s20, 4096
    s_addc_u32 s21, s21, 0
    s_mov_b32 s16, 0xffff0000
    s_mov_b32 s45, 0xbc003c00
    s_lshr_b32 s22, s10, 1
    s_mul_i32 s22, s22, 6144
    s_and_b32 s23, s10, 1
    s_lshl_b32 s23, s23, 3
    s_add_u32 s22, s22, s23
    s_add_u32 s22, s22, 122880
    v_mul_u32_u24 v7, 96, v4
    v_add_u32 v7, v7, v3
    v_lshl_add_u32 v7, v7, 4, s22
    s_mul_i32 s22, s10, 2560
    s_add_u32 s22, s22, 135168
    v_add_u32 v8, s22, v5
    v_mov_b32 v56, 0
    v_mov_b32 v57, 0
    v_mov_b32 v58, 0
    v_mov_b32 v59, 0
    v_mov_b32 v60, 0
    v_mov_b32 v61, 0
    v_mov_b32 v62, 0
    v_mov_b32 v63, 0
    v_mov_b32 v148, 0
    v_mov_b32 v149, 0
    v_mov_b32 v150, 0
    v_mov_b32 v151, 0
    v_mov_b32 v152, 0
    v_mov_b32 v153, 0
    v_mov_b32 v154, 0
    v_mov_b32 v155, 0
    s_waitcnt vmcnt(18)
    s_waitcnt lgkmcnt(0)
    s_barrier
    s_mov_b32 exec_lo, 0x07ff07ff
    s_mov_b32 exec_hi, 0x07ff07ff
    ds_read_b32 v56, v7 offset:0
    ds_read_b32 v57, v7 offset:192
    ds_read_b32 v58, v7 offset:768
    ds_read_b32 v59, v7 offset:960
    ds_read_b32 v60, v7 offset:384
    ds_read_b32 v61, v7 offset:576
    ds_read_b32 v62, v7 offset:1152
    ds_read_b32 v63, v7 offset:1344
    ds_read_b32 v148, v7 offset:4
    ds_read_b32 v149, v7 offset:196
    ds_read_b32 v150, v7 offset:772
    ds_read_b32 v151, v7 offset:964
    ds_read_b32 v152, v7 offset:388
    ds_read_b32 v153, v7 offset:580
    ds_read_b32 v154, v7 offset:1156
    ds_read_b32 v155, v7 offset:1348
    s_mov_b64 exec, -1
    v_add_u32 v9, 135168, v6
    ds_read_b128 v[200:203], v9 offset:0
    ds_read_b128 v[204:207], v9 offset:1024
    ds_read_b128 v[208:211], v9 offset:2048
    ds_read_b128 v[212:215], v9 offset:3072
    ds_read_b128 v[216:219], v9 offset:4096
    ds_read_b128 v[220:223], v9 offset:5120
    ds_read_b128 v[224:227], v9 offset:6144
    ds_read_b128 v[228:231], v9 offset:7168
    ds_read_b128 v[232:235], v9 offset:8192
    ds_read_b128 v[236:239], v9 offset:9216
    s_sub_u32 s18, s42, 126
    s_lshl_b32 s18, s18, 23
    s_add_u32 s18, s18, 0x3e4ccccd
    s_mov_b32 s19, s18
    s_waitcnt lgkmcnt(0)
    s_barrier
    v_pk_mul_f16 v64, v56, s45 op_sel:[1,0] op_sel_hi:[0,1]
    v_pk_mul_f16 v156, v148, s45 op_sel:[1,0] op_sel_hi:[0,1]
    v_pk_mul_f16 v65, v57, s45 op_sel:[1,0] op_sel_hi:[0,1]
    v_pk_mul_f16 v157, v149, s45 op_sel:[1,0] op_sel_hi:[0,1]
    v_pk_mul_f16 v66, v58, s45 op_sel:[1,0] op_sel_hi:[0,1]
    v_pk_mul_f16 v158, v150, s45 op_sel:[1,0] op_sel_hi:[0,1]
    v_pk_mul_f16 v67, v59, s45 op_sel:[1,0] op_sel_hi:[0,1]
    v_pk_mul_f16 v159, v151, s45 op_sel:[1,0] op_sel_hi:[0,1]
    v_pk_mul_f16 v68, v60, s45 op_sel:[1,0] op_sel_hi:[0,1]
    v_pk_mul_f16 v160, v152, s45 op_sel:[1,0] op_sel_hi:[0,1]
    v_pk_mul_f16 v69, v61, s45 op_sel:[1,0] op_sel_hi:[0,1]
    v_pk_mul_f16 v161, v153, s45 op_sel:[1,0] op_sel_hi:[0,1]
    v_pk_mul_f16 v70, v62, s45 op_sel:[1,0] op_sel_hi:[0,1]
    v_pk_mul_f16 v162, v154, s45 op_sel:[1,0] op_sel_hi:[0,1]
    v_pk_mul_f16 v71, v63, s45 op_sel:[1,0] op_sel_hi:[0,1]
    v_pk_mul_f16 v163, v155, s45 op_sel:[1,0] op_sel_hi:[0,1]
    v_mfma_f32_16x16x32_f16 v[72:75], v[56:59], v[200:203], 0
    v_mfma_f32_16x16x32_f16 v[164:167], v[148:151], v[200:203], 0
    v_mfma_f32_16x16x32_f16 v[80:83], v[64:67], v[200:203], 0
    v_mfma_f32_16x16x32_f16 v[172:175], v[156:159], v[200:203], 0
    v_mfma_f32_16x16x32_f16 v[76:79], v[56:59], v[208:211], 0
    v_mfma_f32_16x16x32_f16 v[168:171], v[148:151], v[208:211], 0
    v_mfma_f32_16x16x32_f16 v[84:87], v[64:67], v[208:211], 0
    v_mfma_f32_16x16x32_f16 v[176:179], v[156:159], v[208:211], 0
    v_mfma_f32_16x16x32_f16 v[72:75], v[60:63], v[204:207], v[72:75]
    v_mfma_f32_16x16x32_f16 v[164:167], v[152:155], v[204:207], v[164:167]
    v_mfma_f32_16x16x32_f16 v[80:83], v[68:71], v[204:207], v[80:83]
    v_mfma_f32_16x16x32_f16 v[172:175], v[160:163], v[204:207], v[172:175]
    v_mfma_f32_16x16x32_f16 v[76:79], v[60:63], v[212:215], v[76:79]
    v_mfma_f32_16x16x32_f16 v[168:171], v[152:155], v[212:215], v[168:171]
    s_add_u32 s17, s14, 8192
    s_mov_b32 m0, s17
    s_nop 0
    global_load_lds_dwordx4 v6, s[20:21] offset:0
    v_mfma_f32_16x16x32_f16 v[84:87], v[68:71], v[212:215], v[84:87]
    v_mfma_f32_16x16x32_f16 v[176:179], v[160:163], v[212:215], v[176:179]
    v_mul_f32 v38, v80, v217
    v_mul_f32 v130, v172, v217
    v_mul_f32 v39, v80, v216
    v_mul_f32 v131, v172, v216
    v_mul_f32 v40, v81, v219
    v_mul_f32 v132, v173, v219
    v_mul_f32 v41, v81, v218
    v_mul_f32 v133, v173, v218
    v_mul_f32 v42, v82, v221
    v_mul_f32 v134, v174, v221
    v_mul_f32 v43, v82, v220
    v_mul_f32 v135, v174, v220
    v_mul_f32 v44, v83, v223
    v_mul_f32 v136, v175, v223
    v_mul_f32 v45, v83, v222
    v_mul_f32 v137, v175, v222
    v_mul_f32 v46, v84, v225
    v_mul_f32 v138, v176, v225
    v_mul_f32 v47, v84, v224
    v_mul_f32 v139, v176, v224
    v_mul_f32 v48, v85, v227
    v_mul_f32 v140, v177, v227
    v_mul_f32 v49, v85, v226
    v_mul_f32 v141, v177, v226
    v_mul_f32 v50, v86, v229
    v_mul_f32 v142, v178, v229
    v_mul_f32 v51, v86, v228
    v_mul_f32 v143, v178, v228
    v_mul_f32 v52, v87, v231
    v_mul_f32 v144, v179, v231
    s_add_u32 s17, s14, 8192
    s_mov_b32 m0, s17
    s_nop 0
    global_load_lds_dwordx4 v6, s[20:21] offset:1024
    v_mul_f32 v53, v87, v230
    v_mul_f32 v145, v179, v230
    v_fma_mixlo_f16 v96, v72, v216, -v38
    v_fma_mixlo_f16 v188, v164, v216, -v130
    v_fma_mixlo_f16 v97, v73, v218, -v40
    v_fma_mixlo_f16 v189, v165, v218, -v132
    v_fma_mixlo_f16 v98, v74, v220, -v42
    v_fma_mixlo_f16 v190, v166, v220, -v134
    v_fma_mixlo_f16 v99, v75, v222, -v44
    v_fma_mixlo_f16 v191, v167, v222, -v136
    v_fma_mixlo_f16 v100, v76, v224, -v46
    v_fma_mixlo_f16 v192, v168, v224, -v138
    v_fma_mixlo_f16 v101, v77, v226, -v48
    v_fma_mixlo_f16 v193, v169, v226, -v140
    v_fma_mixlo_f16 v102, v78, v228, -v50
    v_fma_mixlo_f16 v194, v170, v228, -v142
    v_fma_mixlo_f16 v103, v79, v230, -v52
    v_fma_mixlo_f16 v195, v171, v230, -v144
    v_fma_mixhi_f16 v96, v72, v217, v39
    v_fma_mixhi_f16 v188, v164, v217, v131
    v_fma_mixhi_f16 v97, v73, v219, v41
    v_fma_mixhi_f16 v189, v165, v219, v133
    v_fma_mixhi_f16 v98, v74, v221, v43
    v_fma_mixhi_f16 v190, v166, v221, v135
    v_fma_mixhi_f16 v99, v75, v223, v45
    v_fma_mixhi_f16 v191, v167, v223, v137
    v_fma_mixhi_f16 v100, v76, v225, v47
    v_fma_mixhi_f16 v192, v168, v225, v139
    v_fma_mixhi_f16 v101, v77, v227, v49
    v_fma_mixhi_f16 v193, v169, v227, v141
    s_add_u32 s17, s14, 8192
    s_mov_b32 m0, s17
    s_nop 0
    global_load_lds_dwordx4 v6, s[20:21] offset:2048
    v_fma_mixhi_f16 v102, v78, v229, v51
    v_fma_mixhi_f16 v194, v170, v229, v143
    v_fma_mixhi_f16 v103, v79, v231, v53
    v_fma_mixhi_f16 v195, v171, v231, v145
    v_mfma_f32_16x16x32_f16 v[72:75], v[232:235], v[96:99], 0
    v_mfma_f32_16x16x32_f16 v[164:167], v[232:235], v[188:191], 0
    v_mfma_f32_16x16x32_f16 v[76:79], v[236:239], v[96:99], 0
    v_mfma_f32_16x16x32_f16 v[168:171], v[236:239], v[188:191], 0
    v_mfma_f32_16x16x32_f16 v[80:83], v[232:235], v[100:103], 0
    v_mfma_f32_16x16x32_f16 v[172:175], v[232:235], v[192:195], 0
    v_mfma_f32_16x16x32_f16 v[84:87], v[236:239], v[100:103], 0
    v_mfma_f32_16x16x32_f16 v[176:179], v[236:239], v[192:195], 0
    s_waitcnt vmcnt(11)
    v_lshlrev_b32 v22, 16, v16
    v_lshlrev_b32 v114, 16, v108
    v_and_b32 v23, s16, v16
    v_and_b32 v115, s16, v108
    v_lshlrev_b32 v24, 16, v17
    v_lshlrev_b32 v116, 16, v109
    v_and_b32 v25, s16, v17
    v_and_b32 v117, s16, v109
    v_lshlrev_b32 v26, 16, v18
    v_lshlrev_b32 v118, 16, v110
    v_and_b32 v27, s16, v18
    v_and_b32 v119, s16, v110
    v_lshlrev_b32 v28, 16, v19
    v_lshlrev_b32 v120, 16, v111
    v_and_b32 v29, s16, v19
    v_and_b32 v121, s16, v111
    v_lshlrev_b32 v30, 16, v20
    v_lshlrev_b32 v122, 16, v112
    v_and_b32 v31, s16, v20
    v_and_b32 v123, s16, v112
    v_pk_mul_f32 v[72:73], v[72:73], s[18:19]
    v_pk_mul_f32 v[164:165], v[164:165], s[18:19]
    v_pk_mul_f32 v[74:75], v[74:75], s[18:19]
    v_pk_mul_f32 v[166:167], v[166:167], s[18:19]
    v_mul_f32 v76, s18, v76
    v_mul_f32 v168, s18, v168
    v_pk_mul_f32 v[80:81], v[80:81], s[18:19]
    v_pk_mul_f32 v[172:173], v[172:173], s[18:19]
    v_pk_mul_f32 v[82:83], v[82:83], s[18:19]
    v_pk_mul_f32 v[174:175], v[174:175], s[18:19]
    s_add_u32 s17, s14, 8192
    s_mov_b32 m0, s17
    s_nop 0
    global_load_lds_dwordx4 v6, s[20:21] offset:3072
    s_add_u32 s20, s20, 4096
    s_addc_u32 s21, s21, 0
    v_mul_f32 v84, s18, v84
    v_mul_f32 v176, s18, v176
    v_cvt_pk_bf16_f32 v32, v72, v80
    v_cvt_pk_bf16_f32 v124, v164, v172
    v_cvt_pk_bf16_f32 v33, v73, v81
    v_cvt_pk_bf16_f32 v125, v165, v173
    v_cvt_pk_bf16_f32 v34, v74, v82
    v_cvt_pk_bf16_f32 v126, v166, v174
    v_cvt_pk_bf16_f32 v35, v75, v83
    v_cvt_pk_bf16_f32 v127, v167, v175
    v_cvt_pk_bf16_f32 v36, v76, v84
    v_cvt_pk_bf16_f32 v128, v168, v176
    v_lshlrev_b32 v38, 16, v32
    v_lshlrev_b32 v130, 16, v124
    v_and_b32 v39, s16, v32
    v_and_b32 v131, s16, v124
    v_lshlrev_b32 v40, 16, v33
    v_lshlrev_b32 v132, 16, v125
    v_and_b32 v41, s16, v33
    v_and_b32 v133, s16, v125
    v_lshlrev_b32 v42, 16, v34
    v_lshlrev_b32 v134, 16, v126
    v_and_b32 v43, s16, v34
    v_and_b32 v135, s16, v126
    v_lshlrev_b32 v44, 16, v35
    v_lshlrev_b32 v136, 16, v127
    v_and_b32 v45, s16, v35
    v_and_b32 v137, s16, v127
    v_lshlrev_b32 v46, 16, v36
    v_lshlrev_b32 v138, 16, v128
    s_add_u32 s17, s14, 12288
    s_mov_b32 m0, s17
    s_nop 0
    global_load_lds_dwordx4 v6, s[20:21] offset:0
    v_and_b32 v47, s16, v36
    v_and_b32 v139, s16, v128
    v_pk_add_f32 v[22:23], v[22:23], v[38:39]
    v_pk_add_f32 v[114:115], v[114:115], v[130:131]
    v_pk_add_f32 v[24:25], v[24:25], v[40:41]
    v_pk_add_f32 v[116:117], v[116:117], v[132:133]
    v_pk_add_f32 v[26:27], v[26:27], v[42:43]
    v_pk_add_f32 v[118:119], v[118:119], v[134:135]
    v_pk_add_f32 v[28:29], v[28:29], v[44:45]
    v_pk_add_f32 v[120:121], v[120:121], v[136:137]
    v_pk_add_f32 v[30:31], v[30:31], v[46:47]
    v_pk_add_f32 v[122:123], v[122:123], v[138:139]
    v_cvt_pk_bf16_f32 v88, v22, v23
    v_cvt_pk_bf16_f32 v180, v114, v115
    v_cvt_pk_bf16_f32 v89, v24, v25
    v_cvt_pk_bf16_f32 v181, v116, v117
    v_cvt_pk_bf16_f32 v90, v26, v27
    v_cvt_pk_bf16_f32 v182, v118, v119
    v_cvt_pk_bf16_f32 v91, v28, v29
    v_cvt_pk_bf16_f32 v183, v120, v121
    v_cvt_pk_bf16_f32 v92, v30, v31
    v_cvt_pk_bf16_f32 v184, v122, v123
    ds_write_b32 v8, v88 offset:0
    ds_write_b32 v8, v180 offset:1280
    ds_write_b32 v8, v89 offset:64
    ds_write_b32 v8, v181 offset:1344
    ds_write_b32 v8, v90 offset:128
    ds_write_b32 v8, v182 offset:1408
    ds_write_b32 v8, v91 offset:192
    ds_write_b32 v8, v183 offset:1472
    s_add_u32 s17, s14, 12288
    s_mov_b32 m0, s17
    s_nop 0
    global_load_lds_dwordx4 v6, s[20:21] offset:1024
    ds_write_b32 v8, v92 offset:256
    ds_write_b32 v8, v184 offset:1536
    v_lshlrev_b32 v22, 16, v88
    v_lshlrev_b32 v114, 16, v180
    v_and_b32 v23, s16, v88
    v_and_b32 v115, s16, v180
    v_lshlrev_b32 v24, 16, v89
    v_lshlrev_b32 v116, 16, v181
    v_and_b32 v25, s16, v89
    v_and_b32 v117, s16, v181
    v_lshlrev_b32 v26, 16, v90
    v_lshlrev_b32 v118, 16, v182
    v_and_b32 v27, s16, v90
    v_and_b32 v119, s16, v182
    v_lshlrev_b32 v28, 16, v91
    v_lshlrev_b32 v120, 16, v183
    v_and_b32 v29, s16, v91
    v_and_b32 v121, s16, v183
    v_lshlrev_b32 v30, 16, v92
    v_lshlrev_b32 v122, 16, v184
    v_and_b32 v31, s16, v92
    v_and_b32 v123, s16, v184
    v_pk_add_f32 v[38:39], v[22:23], v[24:25]
    v_pk_add_f32 v[130:131], v[114:115], v[116:117]
    v_pk_add_f32 v[40:41], v[26:27], v[28:29]
    v_pk_add_f32 v[132:133], v[118:119], v[120:121]
    v_pk_add_f32 v[38:39], v[38:39], v[30:31]
    v_pk_add_f32 v[130:131], v[130:131], v[122:123]
    v_pk_add_f32 v[38:39], v[38:39], v[40:41]
    v_pk_add_f32 v[130:131], v[130:131], v[132:133]
    s_add_u32 s17, s14, 12288
    s_mov_b32 m0, s17
    s_nop 0
    global_load_lds_dwordx4 v6, s[20:21] offset:2048
    v_add_f32 v38, v38, v39
    v_add_f32 v130, v130, v131
    s_nop 0
    v_add_f32 v38, v38, v38 quad_perm:[1,0,3,2] row_mask:0xf bank_mask:0xf
    v_add_f32 v130, v130, v130 quad_perm:[1,0,3,2] row_mask:0xf bank_mask:0xf
    s_nop 0
    v_add_f32 v38, v38, v38 quad_perm:[2,3,0,1] row_mask:0xf bank_mask:0xf
    v_add_f32 v130, v130, v130 quad_perm:[2,3,0,1] row_mask:0xf bank_mask:0xf
    s_nop 0
    v_add_f32 v38, v38, v38 row_half_mirror row_mask:0xf bank_mask:0xf
    v_add_f32 v130, v130, v130 row_half_mirror row_mask:0xf bank_mask:0xf
    s_nop 0
    v_add_f32 v38, v38, v38 row_mirror row_mask:0xf bank_mask:0xf
    v_add_f32 v130, v130, v130 row_mirror row_mask:0xf bank_mask:0xf
    s_nop 0
    v_add_f32 v38, v38, v38 row_bcast:15 row_mask:0xa bank_mask:0xf
    v_add_f32 v130, v130, v130 row_bcast:15 row_mask:0xa bank_mask:0xf
    s_nop 0
    v_add_f32 v38, v38, v38 row_bcast:31 row_mask:0xc bank_mask:0xf
    v_add_f32 v130, v130, v130 row_bcast:31 row_mask:0xc bank_mask:0xf
    v_readlane_b32 s48, v38, 63
    v_readlane_b32 s50, v130, 63
    v_mov_b32 v39, 0x3acccccd
    v_mov_b32 v131, 0x3acccccd
    v_mul_f32 v50, s48, v39
    v_mul_f32 v142, s50, v131
    v_pk_add_f32 v[40:41], v[22:23], v[50:51] op_sel_hi:[1,0] neg_lo:[0,1] neg_hi:[0,1]
    v_pk_add_f32 v[132:133], v[114:115], v[142:143] op_sel_hi:[1,0] neg_lo:[0,1] neg_hi:[0,1]
    v_pk_add_f32 v[42:43], v[24:25], v[50:51] op_sel_hi:[1,0] neg_lo:[0,1] neg_hi:[0,1]
    v_pk_add_f32 v[134:135], v[116:117], v[142:143] op_sel_hi:[1,0] neg_lo:[0,1] neg_hi:[0,1]
    v_pk_add_f32 v[44:45], v[26:27], v[50:51] op_sel_hi:[1,0] neg_lo:[0,1] neg_hi:[0,1]
    v_pk_add_f32 v[136:137], v[118:119], v[142:143] op_sel_hi:[1,0] neg_lo:[0,1] neg_hi:[0,1]
    v_pk_add_f32 v[46:47], v[28:29], v[50:51] op_sel_hi:[1,0] neg_lo:[0,1] neg_hi:[0,1]
    v_pk_add_f32 v[138:139], v[120:121], v[142:143] op_sel_hi:[1,0] neg_lo:[0,1] neg_hi:[0,1]
    v_pk_add_f32 v[48:49], v[30:31], v[50:51] op_sel_hi:[1,0] neg_lo:[0,1] neg_hi:[0,1]
    v_pk_add_f32 v[140:141], v[122:123], v[142:143] op_sel_hi:[1,0] neg_lo:[0,1] neg_hi:[0,1]
    s_add_u32 s17, s14, 12288
    s_mov_b32 m0, s17
    s_nop 0
    global_load_lds_dwordx4 v6, s[20:21] offset:3072
    s_add_u32 s20, s20, 4096
    s_addc_u32 s21, s21, 0
    v_pk_mul_f32 v[32:33], v[40:41], v[40:41]
    v_pk_mul_f32 v[124:125], v[132:133], v[132:133]
    v_pk_fma_f32 v[32:33], v[42:43], v[42:43], v[32:33]
    v_pk_fma_f32 v[124:125], v[134:135], v[134:135], v[124:125]
    v_pk_fma_f32 v[32:33], v[44:45], v[44:45], v[32:33]
    v_pk_fma_f32 v[124:125], v[136:137], v[136:137], v[124:125]
    v_pk_fma_f32 v[32:33], v[46:47], v[46:47], v[32:33]
    v_pk_fma_f32 v[124:125], v[138:139], v[138:139], v[124:125]
    v_pk_fma_f32 v[32:33], v[48:49], v[48:49], v[32:33]
    v_pk_fma_f32 v[124:125], v[140:141], v[140:141], v[124:125]
    v_add_f32 v38, v32, v33
    v_add_f32 v130, v124, v125
    s_nop 0
    v_add_f32 v38, v38, v38 quad_perm:[1,0,3,2] row_mask:0xf bank_mask:0xf
    v_add_f32 v130, v130, v130 quad_perm:[1,0,3,2] row_mask:0xf bank_mask:0xf
    s_nop 0
    v_add_f32 v38, v38, v38 quad_perm:[2,3,0,1] row_mask:0xf bank_mask:0xf
    v_add_f32 v130, v130, v130 quad_perm:[2,3,0,1] row_mask:0xf bank_mask:0xf
    s_nop 0
    v_add_f32 v38, v38, v38 row_half_mirror row_mask:0xf bank_mask:0xf
    v_add_f32 v130, v130, v130 row_half_mirror row_mask:0xf bank_mask:0xf
    s_nop 0
    v_add_f32 v38, v38, v38 row_mirror row_mask:0xf bank_mask:0xf
    v_add_f32 v130, v130, v130 row_mirror row_mask:0xf bank_mask:0xf
    s_nop 0
    v_add_f32 v38, v38, v38 row_bcast:15 row_mask:0xa bank_mask:0xf
    v_add_f32 v130, v130, v130 row_bcast:15 row_mask:0xa bank_mask:0xf
    s_nop 0
    v_add_f32 v38, v38, v38 row_bcast:31 row_mask:0xc bank_mask:0xf
    v_add_f32 v130, v130, v130 row_bcast:31 row_mask:0xc bank_mask:0xf
    v_readlane_b32 s49, v38, 63
    v_readlane_b32 s51, v130, 63
    v_cvt_pk_bf16_f32 v50, v50, v50
    v_cvt_pk_bf16_f32 v142, v142, v142
    v_mul_f32 v38, s49, v39
    v_mul_f32 v130, s51, v131
    s_add_u32 s17, s14, 16384
    s_mov_b32 m0, s17
    s_nop 0
    global_load_lds_dwordx4 v6, s[20:21] offset:0
    v_and_b32 v50, s16, v50
    v_and_b32 v142, s16, v142
    v_cvt_pk_bf16_f32 v38, v38, v38
    v_cvt_pk_bf16_f32 v130, v130, v130
    v_and_b32 v38, s16, v38
    v_and_b32 v130, s16, v130
    v_add_f32 v38, 0x3727c5ac, v38
    v_add_f32 v130, 0x3727c5ac, v130
    v_cvt_pk_bf16_f32 v38, v38, v38
    v_cvt_pk_bf16_f32 v130, v130, v130
    v_and_b32 v38, s16, v38
    v_and_b32 v130, s16, v130
    v_sqrt_f32 v38, v38
    v_sqrt_f32 v130, v130
    v_pk_add_f32 v[40:41], v[22:23], v[50:51] op_sel_hi:[1,0] neg_lo:[0,1] neg_hi:[0,1]
    v_pk_add_f32 v[132:133], v[114:115], v[142:143] op_sel_hi:[1,0] neg_lo:[0,1] neg_hi:[0,1]
    v_pk_add_f32 v[42:43], v[24:25], v[50:51] op_sel_hi:[1,0] neg_lo:[0,1] neg_hi:[0,1]
    v_pk_add_f32 v[134:135], v[116:117], v[142:143] op_sel_hi:[1,0] neg_lo:[0,1] neg_hi:[0,1]
    v_pk_add_f32 v[44:45], v[26:27], v[50:51] op_sel_hi:[1,0] neg_lo:[0,1] neg_hi:[0,1]
    v_pk_add_f32 v[136:137], v[118:119], v[142:143] op_sel_hi:[1,0] neg_lo:[0,1] neg_hi:[0,1]
    v_pk_add_f32 v[46:47], v[28:29], v[50:51] op_sel_hi:[1,0] neg_lo:[0,1] neg_hi:[0,1]
    v_pk_add_f32 v[138:139], v[120:121], v[142:143] op_sel_hi:[1,0] neg_lo:[0,1] neg_hi:[0,1]
    v_pk_add_f32 v[48:49], v[30:31], v[50:51] op_sel_hi:[1,0] neg_lo:[0,1] neg_hi:[0,1]
    v_pk_add_f32 v[140:141], v[122:123], v[142:143] op_sel_hi:[1,0] neg_lo:[0,1] neg_hi:[0,1]
    v_cvt_pk_bf16_f32 v38, v38, v38
    v_cvt_pk_bf16_f32 v130, v130, v130
    v_and_b32 v38, s16, v38
    v_and_b32 v130, s16, v130
    v_rcp_f32 v38, v38
    v_rcp_f32 v130, v130
    s_add_u32 s17, s14, 16384
    s_mov_b32 m0, s17
    s_nop 0
    global_load_lds_dwordx4 v6, s[20:21] offset:1024
    v_cvt_pk_bf16_f32 v32, v40, v41
    v_cvt_pk_bf16_f32 v124, v132, v133
    v_cvt_pk_bf16_f32 v33, v42, v43
    v_cvt_pk_bf16_f32 v125, v134, v135
    v_cvt_pk_bf16_f32 v34, v44, v45
    v_cvt_pk_bf16_f32 v126, v136, v137
    v_cvt_pk_bf16_f32 v35, v46, v47
    v_cvt_pk_bf16_f32 v127, v138, v139
    v_cvt_pk_bf16_f32 v36, v48, v49
    v_cvt_pk_bf16_f32 v128, v140, v141
    v_lshlrev_b32 v40, 16, v32
    v_lshlrev_b32 v132, 16, v124
    v_and_b32 v41, s16, v32
    v_and_b32 v133, s16, v124
    v_lshlrev_b32 v42, 16, v33
    v_lshlrev_b32 v134, 16, v125
    v_and_b32 v43, s16, v33
    v_and_b32 v135, s16, v125
    v_lshlrev_b32 v44, 16, v34
    v_lshlrev_b32 v136, 16, v126
    v_and_b32 v45, s16, v34
    v_and_b32 v137, s16, v126
    v_lshlrev_b32 v46, 16, v35
    v_lshlrev_b32 v138, 16, v127
    v_and_b32 v47, s16, v35
    v_and_b32 v139, s16, v127
    v_lshlrev_b32 v48, 16, v36
    v_lshlrev_b32 v140, 16, v128
    v_and_b32 v49, s16, v36
    v_and_b32 v141, s16, v128
    s_add_u32 s17, s14, 16384
    s_mov_b32 m0, s17
    s_nop 0
    global_load_lds_dwordx4 v6, s[20:21] offset:2048
    v_pk_mul_f32 v[40:41], v[40:41], v[38:39] op_sel_hi:[1,0]
    v_pk_mul_f32 v[132:133], v[132:133], v[130:131] op_sel_hi:[1,0]
    v_pk_mul_f32 v[42:43], v[42:43], v[38:39] op_sel_hi:[1,0]
    v_pk_mul_f32 v[134:135], v[134:135], v[130:131] op_sel_hi:[1,0]
    v_pk_mul_f32 v[44:45], v[44:45], v[38:39] op_sel_hi:[1,0]
    v_pk_mul_f32 v[136:137], v[136:137], v[130:131] op_sel_hi:[1,0]
    v_pk_mul_f32 v[46:47], v[46:47], v[38:39] op_sel_hi:[1,0]
    v_pk_mul_f32 v[138:139], v[138:139], v[130:131] op_sel_hi:[1,0]
    v_pk_mul_f32 v[48:49], v[48:49], v[38:39] op_sel_hi:[1,0]
    v_pk_mul_f32 v[140:141], v[140:141], v[130:131] op_sel_hi:[1,0]
    v_cvt_pk_bf16_f32 v32, v40, v41
    v_cvt_pk_bf16_f32 v124, v132, v133
    v_cvt_pk_bf16_f32 v33, v42, v43
    v_cvt_pk_bf16_f32 v125, v134, v135
    v_cvt_pk_bf16_f32 v34, v44, v45
    v_cvt_pk_bf16_f32 v126, v136, v137
    v_cvt_pk_bf16_f32 v35, v46, v47
    v_cvt_pk_bf16_f32 v127, v138, v139
    v_cvt_pk_bf16_f32 v36, v48, v49
    v_cvt_pk_bf16_f32 v128, v140, v141
    ds_write_b32 v8, v32 offset:10240
    ds_write_b32 v8, v124 offset:11520
    ds_write_b32 v8, v33 offset:10304
    ds_write_b32 v8, v125 offset:11584
    ds_write_b32 v8, v34 offset:10368
    ds_write_b32 v8, v126 offset:11648
    ds_write_b32 v8, v35 offset:10432
    ds_write_b32 v8, v127 offset:11712
    ds_write_b32 v8, v36 offset:10496
    ds_write_b32 v8, v128 offset:11776
    v_mul_u32_u24 v9, 205, v0
    v_lshrrev_b32 v9, 14, v9
    v_mul_u32_u24 v10, 80, v9
    v_sub_u32 v10, v0, v10
    v_add_u32 v11, 16, v10
    v_add_u32 v12, 3, v9
    v_cmp_lt_u32 vcc, 79, v11
    v_subrev_u32 v13, 80, v11
    s_nop 0
    v_cndmask_b32 v11, v11, v13, vcc
    v_addc_co_u32 v12, vcc, 0, v12, vcc
    v_add_u32 v13, 16, v11
    v_add_u32 v14, 3, v12
    v_cmp_lt_u32 vcc, 79, v13
    v_subrev_u32 v15, 80, v13
    s_nop 0
    v_cndmask_b32 v13, v13, v15, vcc
    v_addc_co_u32 v14, vcc, 0, v14, vcc
    v_mul_u32_u24 v16, 1280, v9
    v_lshl_add_u32 v16, v10, 4, v16
    v_add_u32 v16, 135168, v16
    v_mul_u32_u24 v19, 40960, v9
    v_lshl_add_u32 v19, v10, 4, v19
    v_mul_u32_u24 v17, 1280, v12
    v_lshl_add_u32 v17, v11, 4, v17
    v_add_u32 v17, 135168, v17
    v_mul_u32_u24 v20, 40960, v12
    v_lshl_add_u32 v20, v11, 4, v20
    v_mul_u32_u24 v18, 1280, v14
    v_lshl_add_u32 v18, v13, 4, v18
    v_add_u32 v18, 135168, v18
    v_mul_u32_u24 v21, 40960, v14
    v_lshl_add_u32 v21, v13, 4, v21
    v_and_b32 v22, 7, v0
    v_lshrrev_b32 v23, 3, v0
    v_mul_u32_u24 v24, 1280, v22
    v_lshl_add_u32 v24, v23, 4, v24
    v_add_u32 v24, 135168, v24
    v_lshlrev_b32 v25, 8, v23
    v_lshl_add_u32 v25, v22, 4, v25
    s_add_u32 s13, s44, 0x600000
    s_add_u32 s22, s6, s13
    s_addc_u32 s23, s7, 0
    s_lshr_b32 s13, s43, 1
    s_mul_i32 s13, s13, 20480
    s_and_b32 s14, s43, 1
    s_lshl_b32 s14, s14, 7
    s_add_u32 s13, s13, s14
    s_add_u32 s13, s13, 0x900000
    s_add_u32 s24, s6, s13
    s_addc_u32 s25, s7, 0
    s_add_u32 s26, s24, 8192
    s_addc_u32 s27, s25, 0
    s_add_u32 s28, s24, 16384
    s_addc_u32 s29, s25, 0
    s_waitcnt lgkmcnt(0)
    s_barrier
    ds_read_b128 v[28:31], v24 offset:10240
    ds_read_b128 v[32:35], v24 offset:10752
    ds_read_b128 v[36:39], v24 offset:11264
    ds_read_b128 v[40:43], v16
    ds_read_b128 v[44:47], v17
    ds_read_b128 v[48:51], v18
    s_waitcnt lgkmcnt(3)
    global_store_dwordx4 v25, v[28:31], s[24:25] sc1
    global_store_dwordx4 v25, v[32:35], s[26:27] sc1
    s_waitcnt lgkmcnt(0)
    global_store_dwordx4 v19, v[40:43], s[22:23] sc1
    global_store_dwordx4 v20, v[44:47], s[22:23] sc1
    s_cmp_ge_u32 s10, 2
    s_cbranch_scc1 L_F_cst_done
    global_store_dwordx4 v25, v[36:39], s[28:29] sc1
    global_store_dwordx4 v21, v[48:51], s[22:23] sc1
L_F_cst_done:
    s_lshl_b32 s13, s11, 2
    s_lshr_b32 s14, s12, 2
    s_add_u32 s13, s13, s14
    s_lshl_b32 s13, s13, 7
    s_and_b32 s14, s12, 3
    s_lshl_b32 s14, s14, 4
    s_add_u32 s13, s13, s14
    s_lshl_b32 s14, s10, 2
    s_add_u32 s13, s13, s14
    s_add_u32 s13, s13, s35
    s_add_u32 s13, s13, 16384
    v_mov_b32 v8, s13
    v_mov_b32 v9, 1
    s_lshl_b32 s13, s11, 2
    s_add_u32 s13, s13, s10
    s_lshl_b32 s13, s13, 7
    s_add_u32 s13, s13, s35
    s_add_u32 s13, s13, 16384
    v_lshl_add_u32 v15, v2, 2, s13
    s_mul_i32 s14, s10, 30720
    s_add_u32 s17, s14, 16384
    s_mov_b32 m0, s17
    s_nop 0
    global_load_lds_dwordx4 v6, s[20:21] offset:3072
    s_add_u32 s20, s20, 4096
    s_addc_u32 s21, s21, 0
    s_add_u32 s17, s14, 20480
    s_mov_b32 m0, s17
    s_nop 0
    global_load_lds_dwordx4 v6, s[20:21] offset:0
    s_add_u32 s17, s14, 20480
    s_mov_b32 m0, s17
    s_nop 0
    global_load_lds_dwordx4 v6, s[20:21] offset:1024
    s_add_u32 s17, s14, 20480
    s_mov_b32 m0, s17
    s_nop 0
    global_load_lds_dwordx4 v6, s[20:21] offset:2048
    s_add_u32 s17, s14, 20480
    s_mov_b32 m0, s17
    s_nop 0
    global_load_lds_dwordx4 v6, s[20:21] offset:3072
    s_add_u32 s20, s20, 4096
    s_addc_u32 s21, s21, 0
    s_add_u32 s17, s14, 24576
    s_mov_b32 m0, s17
    s_nop 0
    global_load_lds_dwordx4 v6, s[20:21] offset:0
    s_add_u32 s17, s14, 24576
    s_mov_b32 m0, s17
    s_nop 0
    global_load_lds_dwordx4 v6, s[20:21] offset:1024
    s_add_u32 s17, s14, 24576
    s_mov_b32 m0, s17
    s_nop 0
    global_load_lds_dwordx4 v6, s[20:21] offset:2048
    s_add_u32 s17, s14, 24576
    s_mov_b32 m0, s17
    s_nop 0
    global_load_lds_dwordx4 v6, s[20:21] offset:3072
    s_add_u32 s20, s20, 4096
    s_addc_u32 s21, s21, 0
    s_add_u32 s17, s14, 28672
    s_mov_b32 m0, s17
    s_nop 0
    global_load_lds_dwordx4 v6, s[20:21] offset:0
    s_add_u32 s17, s14, 28672
    s_mov_b32 m0, s17
    s_nop 0
    global_load_lds_dwordx4 v6, s[20:21] offset:1024
    s_waitcnt vmcnt(11)
    s_mov_b64 exec, 1
    global_store_dword v8, v9, s[6:7] sc1
    s_mov_b64 exec, -1
    global_load_dwordx4 a[0:3], v6, s[38:39] offset:0
    global_load_dwordx4 a[4:7], v6, s[38:39] offset:1024
    global_load_dwordx4 a[8:11], v6, s[38:39] offset:2048
    global_load_dwordx4 a[12:15], v6, s[38:39] offset:3072
    s_add_u32 s38, s38, 4096
    s_addc_u32 s39, s39, 0
    global_load_dwordx4 a[16:19], v6, s[38:39] offset:0
    global_load_dwordx4 a[20:23], v6, s[38:39] offset:1024
    global_load_dwordx4 a[24:27], v6, s[38:39] offset:2048
    global_load_dwordx4 a[28:31], v6, s[38:39] offset:3072
    s_add_u32 s38, s38, 4096
    s_addc_u32 s39, s39, 0
    global_load_dwordx4 a[32:35], v6, s[38:39] offset:0
    global_load_dwordx4 a[36:39], v6, s[38:39] offset:1024
    global_load_dwordx4 a[40:43], v6, s[38:39] offset:2048
    global_load_dwordx4 a[44:47], v6, s[38:39] offset:3072
    s_add_u32 s38, s38, 4096
    s_addc_u32 s39, s39, 0
    global_load_dwordx4 a[48:51], v6, s[38:39] offset:0
    global_load_dwordx4 a[52:55], v6, s[38:39] offset:1024
    global_load_dwordx4 a[56:59], v6, s[38:39] offset:2048
    global_load_dwordx4 a[60:63], v6, s[38:39] offset:3072
    s_add_u32 s38, s38, 4096
    s_addc_u32 s39, s39, 0
    global_load_dwordx4 a[64:67], v6, s[38:39] offset:0
    global_load_dwordx4 a[68:71], v6, s[38:39] offset:1024
    global_load_dwordx4 a[72:75], v6, s[38:39] offset:2048
    global_load_dwordx4 a[76:79], v6, s[38:39] offset:3072
    s_add_u32 s38, s38, 4096
    s_addc_u32 s39, s39, 0
    global_load_dwordx4 a[80:83], v6, s[38:39] offset:0
    global_load_dwordx4 a[84:87], v6, s[38:39] offset:1024
    global_load_dwordx4 a[88:91], v6, s[38:39] offset:2048
    global_load_dwordx4 a[92:95], v6, s[38:39] offset:3072
    s_add_u32 s38, s38, 4096
    s_addc_u32 s39, s39, 0
    s_lshl_b32 s15, s11, 3
    s_lshl_b32 s16, s10, 1
    s_add_u32 s15, s15, s16
    s_mul_i32 s16, s15, 20480
    s_add_u32 s16, s16, 0x900000
    s_add_u32 s22, s6, s16
    s_addc_u32 s23, s7, 0
    s_add_u32 s24, s22, 20480
    s_addc_u32 s25, s23, 0
    v_mov_b32 v5, v15
    v_mov_b32 v8, 0
    v_mov_b32 v9, 0
    v_mov_b32 v10, 0
    v_mov_b32 v11, 0
    v_mov_b32 v12, 0
    v_mov_b32 v13, 0
    v_mov_b32 v14, 0
    v_mov_b32 v15, 0
    v_mov_b32 v16, 0
    v_mov_b32 v17, 0
    v_mov_b32 v18, 0
    v_mov_b32 v19, 0
    v_mov_b32 v20, 0
    v_mov_b32 v21, 0
    v_mov_b32 v22, 0
    v_mov_b32 v23, 0
    v_mov_b32 v24, 0
    v_mov_b32 v25, 0
    v_mov_b32 v26, 0
    v_mov_b32 v27, 0
    v_mov_b32 v28, 0
    v_mov_b32 v29, 0
    v_mov_b32 v30, 0
    v_mov_b32 v31, 0
    v_mov_b32 v32, 0
    v_mov_b32 v33, 0
    v_mov_b32 v34, 0
    v_mov_b32 v35, 0
    v_mov_b32 v36, 0
    v_mov_b32 v37, 0
    v_mov_b32 v38, 0
    v_mov_b32 v39, 0
    v_mov_b32 v40, 0
    v_mov_b32 v41, 0
    v_mov_b32 v42, 0
    v_mov_b32 v43, 0
    v_mov_b32 v44, 0
    v_mov_b32 v45, 0
    v_mov_b32 v46, 0
    v_mov_b32 v47, 0
    v_mov_b32 v48, 0
    v_mov_b32 v49, 0
    v_mov_b32 v50, 0
    v_mov_b32 v51, 0
    v_mov_b32 v52, 0
    v_mov_b32 v53, 0
    v_mov_b32 v54, 0
    v_mov_b32 v55, 0
    s_mov_b32 s19, 0x400000
    s_mov_b64 exec, 0xffff
L_F_poll1:
    global_load_dword v1, v5, s[6:7] sc1
    s_waitcnt vmcnt(0)
    v_cmp_eq_u32 vcc, 1, v1
    s_sub_u32 s19, s19, 1
    s_cmp_eq_u32 s19, 0
    s_cbranch_scc1 L_F_pdone1
    s_cmp_eq_u32 vcc_lo, 0xffff
    s_cbranch_scc1 L_F_pdone1
    s_sleep 1
    s_branch L_F_poll1
L_F_pdone1:
    s_mov_b64 exec, -1
    global_load_dwordx4 v[104:107], v6, s[22:23] offset:0 sc1
    global_load_dwordx4 v[108:111], v6, s[24:25] offset:0 sc1
    global_load_dwordx4 v[112:115], v6, s[22:23] offset:1024 sc1
    global_load_dwordx4 v[116:119], v6, s[24:25] offset:1024 sc1
    global_load_dwordx4 v[120:123], v6, s[22:23] offset:2048 sc1
    global_load_dwordx4 v[124:127], v6, s[24:25] offset:2048 sc1
    global_load_dwordx4 v[128:131], v6, s[22:23] offset:3072 sc1
    global_load_dwordx4 v[132:135], v6, s[24:25] offset:3072 sc1
    s_add_u32 s22, s22, 4096
    s_addc_u32 s23, s23, 0
    s_add_u32 s24, s24, 4096
    s_addc_u32 s25, s25, 0
    global_load_dwordx4 v[136:139], v6, s[22:23] offset:0 sc1
    global_load_dwordx4 v[140:143], v6, s[24:25] offset:0 sc1
    global_load_dwordx4 v[144:147], v6, s[22:23] offset:1024 sc1
    global_load_dwordx4 v[148:151], v6, s[24:25] offset:1024 sc1
    s_barrier
    v_add_u32 v7, 0, v6
    ds_read_b128 v[56:59], v7 offset:0
    ds_read_b128 v[60:63], v7 offset:1024
    ds_read_b128 v[64:67], v7 offset:2048
    ds_read_b128 v[68:71], v7 offset:3072
    ds_read_b128 v[72:75], v7 offset:4096
    ds_read_b128 v[76:79], v7 offset:5120
    ds_read_b128 v[80:83], v7 offset:6144
    ds_read_b128 v[84:87], v7 offset:7168
    ds_read_b128 v[88:91], v7 offset:8192
    ds_read_b128 v[92:95], v7 offset:9216
    ds_read_b128 v[96:99], v7 offset:10240
    ds_read_b128 v[100:103], v7 offset:11264
    s_waitcnt vmcnt(10)
    s_waitcnt lgkmcnt(11)
    v_mfma_f32_16x16x32_bf16 v[8:11], v[56:59], v[104:107], v[8:11]
    v_mfma_f32_16x16x32_bf16 v[12:15], v[56:59], v[108:111], v[12:15]
    global_load_dwordx4 v[152:155], v6, s[22:23] offset:2048 sc1
    s_waitcnt lgkmcnt(10)
    v_mfma_f32_16x16x32_bf16 v[16:19], v[60:63], v[104:107], v[16:19]
    v_mfma_f32_16x16x32_bf16 v[20:23], v[60:63], v[108:111], v[20:23]
    s_waitcnt lgkmcnt(9)
    v_mfma_f32_16x16x32_bf16 v[24:27], v[64:67], v[104:107], v[24:27]
    v_mfma_f32_16x16x32_bf16 v[28:31], v[64:67], v[108:111], v[28:31]
    global_load_dwordx4 v[156:159], v6, s[24:25] offset:2048 sc1
    s_waitcnt lgkmcnt(8)
    v_mfma_f32_16x16x32_bf16 v[32:35], v[68:71], v[104:107], v[32:35]
    v_mfma_f32_16x16x32_bf16 v[36:39], v[68:71], v[108:111], v[36:39]
    s_waitcnt lgkmcnt(7)
    v_mfma_f32_16x16x32_bf16 v[40:43], v[72:75], v[104:107], v[40:43]
    v_mfma_f32_16x16x32_bf16 v[44:47], v[72:75], v[108:111], v[44:47]
    global_load_dwordx4 a[96:99], v6, s[38:39] offset:0
    s_waitcnt lgkmcnt(6)
    v_mfma_f32_16x16x32_bf16 v[48:51], v[76:79], v[104:107], v[48:51]
    v_mfma_f32_16x16x32_bf16 v[52:55], v[76:79], v[108:111], v[52:55]
    ds_read_b128 v[56:59], v7 offset:12288
    ds_read_b128 v[60:63], v7 offset:13312
    ds_read_b128 v[64:67], v7 offset:14336
    ds_read_b128 v[68:71], v7 offset:15360
    ds_read_b128 v[72:75], v7 offset:16384
    ds_read_b128 v[76:79], v7 offset:17408
    s_waitcnt vmcnt(11)
    s_waitcnt lgkmcnt(11)
    v_mfma_f32_16x16x32_bf16 v[8:11], v[80:83], v[112:115], v[8:11]
    v_mfma_f32_16x16x32_bf16 v[12:15], v[80:83], v[116:119], v[12:15]
    global_load_dwordx4 v[160:163], v6, s[22:23] offset:3072 sc1
    s_waitcnt lgkmcnt(10)
    v_mfma_f32_16x16x32_bf16 v[16:19], v[84:87], v[112:115], v[16:19]
    v_mfma_f32_16x16x32_bf16 v[20:23], v[84:87], v[116:119], v[20:23]
    s_waitcnt lgkmcnt(9)
    v_mfma_f32_16x16x32_bf16 v[24:27], v[88:91], v[112:115], v[24:27]
    v_mfma_f32_16x16x32_bf16 v[28:31], v[88:91], v[116:119], v[28:31]
    global_load_dwordx4 v[164:167], v6, s[24:25] offset:3072 sc1
    s_waitcnt lgkmcnt(8)
    v_mfma_f32_16x16x32_bf16 v[32:35], v[92:95], v[112:115], v[32:35]
    v_mfma_f32_16x16x32_bf16 v[36:39], v[92:95], v[116:119], v[36:39]
    s_waitcnt lgkmcnt(7)
    v_mfma_f32_16x16x32_bf16 v[40:43], v[96:99], v[112:115], v[40:43]
    v_mfma_f32_16x16x32_bf16 v[44:47], v[96:99], v[116:119], v[44:47]
    global_load_dwordx4 a[100:103], v6, s[38:39] offset:1024
    s_waitcnt lgkmcnt(6)
    v_mfma_f32_16x16x32_bf16 v[48:51], v[100:103], v[112:115], v[48:51]
    v_mfma_f32_16x16x32_bf16 v[52:55], v[100:103], v[116:119], v[52:55]
    ds_read_b128 v[80:83], v7 offset:18432
    ds_read_b128 v[84:87], v7 offset:19456
    ds_read_b128 v[88:91], v7 offset:20480
    ds_read_b128 v[92:95], v7 offset:21504
    ds_read_b128 v[96:99], v7 offset:22528
    ds_read_b128 v[100:103], v7 offset:23552
    s_waitcnt vmcnt(12)
    s_waitcnt lgkmcnt(11)
    v_mfma_f32_16x16x32_bf16 v[8:11], v[56:59], v[120:123], v[8:11]
    v_mfma_f32_16x16x32_bf16 v[12:15], v[56:59], v[124:127], v[12:15]
    s_add_u32 s22, s22, 4096
    s_addc_u32 s23, s23, 0
    s_add_u32 s24, s24, 4096
    s_addc_u32 s25, s25, 0
    global_load_dwordx4 v[168:171], v6, s[22:23] offset:0 sc1
    s_waitcnt lgkmcnt(10)
    v_mfma_f32_16x16x32_bf16 v[16:19], v[60:63], v[120:123], v[16:19]
    v_mfma_f32_16x16x32_bf16 v[20:23], v[60:63], v[124:127], v[20:23]
    s_waitcnt lgkmcnt(9)
    v_mfma_f32_16x16x32_bf16 v[24:27], v[64:67], v[120:123], v[24:27]
    v_mfma_f32_16x16x32_bf16 v[28:31], v[64:67], v[124:127], v[28:31]
    global_load_dwordx4 v[172:175], v6, s[24:25] offset:0 sc1
    s_waitcnt lgkmcnt(8)
    v_mfma_f32_16x16x32_bf16 v[32:35], v[68:71], v[120:123], v[32:35]
    v_mfma_f32_16x16x32_bf16 v[36:39], v[68:71], v[124:127], v[36:39]
    s_waitcnt lgkmcnt(7)
    v_mfma_f32_16x16x32_bf16 v[40:43], v[72:75], v[120:123], v[40:43]
    v_mfma_f32_16x16x32_bf16 v[44:47], v[72:75], v[124:127], v[44:47]
    global_load_dwordx4 a[104:107], v6, s[38:39] offset:2048
    s_waitcnt lgkmcnt(6)
    v_mfma_f32_16x16x32_bf16 v[48:51], v[76:79], v[120:123], v[48:51]
    v_mfma_f32_16x16x32_bf16 v[52:55], v[76:79], v[124:127], v[52:55]
    v_add_u32 v7, 24576, v6
    ds_read_b128 v[56:59], v7 offset:0
    ds_read_b128 v[60:63], v7 offset:1024
    ds_read_b128 v[64:67], v7 offset:2048
    ds_read_b128 v[68:71], v7 offset:3072
    ds_read_b128 v[72:75], v7 offset:4096
    ds_read_b128 v[76:79], v7 offset:5120
    s_waitcnt vmcnt(13)
    s_waitcnt lgkmcnt(11)
    v_mfma_f32_16x16x32_bf16 v[8:11], v[80:83], v[128:131], v[8:11]
    v_mfma_f32_16x16x32_bf16 v[12:15], v[80:83], v[132:135], v[12:15]
    global_load_dwordx4 v[176:179], v6, s[22:23] offset:1024 sc1
    s_waitcnt lgkmcnt(10)
    v_mfma_f32_16x16x32_bf16 v[16:19], v[84:87], v[128:131], v[16:19]
    v_mfma_f32_16x16x32_bf16 v[20:23], v[84:87], v[132:135], v[20:23]
    s_waitcnt lgkmcnt(9)
    v_mfma_f32_16x16x32_bf16 v[24:27], v[88:91], v[128:131], v[24:27]
    v_mfma_f32_16x16x32_bf16 v[28:31], v[88:91], v[132:135], v[28:31]
    global_load_dwordx4 v[180:183], v6, s[24:25] offset:1024 sc1
    s_waitcnt lgkmcnt(8)
    v_mfma_f32_16x16x32_bf16 v[32:35], v[92:95], v[128:131], v[32:35]
    v_mfma_f32_16x16x32_bf16 v[36:39], v[92:95], v[132:135], v[36:39]
    s_waitcnt lgkmcnt(7)
    v_mfma_f32_16x16x32_bf16 v[40:43], v[96:99], v[128:131], v[40:43]
    v_mfma_f32_16x16x32_bf16 v[44:47], v[96:99], v[132:135], v[44:47]
    global_load_dwordx4 a[108:111], v6, s[38:39] offset:3072
    s_add_u32 s38, s38, 4096
    s_addc_u32 s39, s39, 0
    s_waitcnt lgkmcnt(6)
    v_mfma_f32_16x16x32_bf16 v[48:51], v[100:103], v[128:131], v[48:51]
    v_mfma_f32_16x16x32_bf16 v[52:55], v[100:103], v[132:135], v[52:55]
    ds_read_b128 v[80:83], v7 offset:6144
    ds_read_b128 v[84:87], v7 offset:7168
    ds_read_b128 v[88:91], v7 offset:8192
    ds_read_b128 v[92:95], v7 offset:9216
    ds_read_b128 v[96:99], v7 offset:10240
    ds_read_b128 v[100:103], v7 offset:11264
    s_waitcnt vmcnt(14)
    s_waitcnt lgkmcnt(11)
    v_mfma_f32_16x16x32_bf16 v[8:11], v[56:59], v[136:139], v[8:11]
    v_mfma_f32_16x16x32_bf16 v[12:15], v[56:59], v[140:143], v[12:15]
    global_load_dwordx4 v[184:187], v6, s[22:23] offset:2048 sc1
    s_waitcnt lgkmcnt(10)
    v_mfma_f32_16x16x32_bf16 v[16:19], v[60:63], v[136:139], v[16:19]
    v_mfma_f32_16x16x32_bf16 v[20:23], v[60:63], v[140:143], v[20:23]
    s_waitcnt lgkmcnt(9)
    v_mfma_f32_16x16x32_bf16 v[24:27], v[64:67], v[136:139], v[24:27]
    v_mfma_f32_16x16x32_bf16 v[28:31], v[64:67], v[140:143], v[28:31]
    global_load_dwordx4 v[188:191], v6, s[24:25] offset:2048 sc1
    s_waitcnt lgkmcnt(8)
    v_mfma_f32_16x16x32_bf16 v[32:35], v[68:71], v[136:139], v[32:35]
    v_mfma_f32_16x16x32_bf16 v[36:39], v[68:71], v[140:143], v[36:39]
    s_waitcnt lgkmcnt(7)
    v_mfma_f32_16x16x32_bf16 v[40:43], v[72:75], v[136:139], v[40:43]
    v_mfma_f32_16x16x32_bf16 v[44:47], v[72:75], v[140:143], v[44:47]
    global_load_dwordx4 a[112:115], v6, s[38:39] offset:0
    s_waitcnt lgkmcnt(6)
    v_mfma_f32_16x16x32_bf16 v[48:51], v[76:79], v[136:139], v[48:51]
    v_mfma_f32_16x16x32_bf16 v[52:55], v[76:79], v[140:143], v[52:55]
    ds_read_b128 v[56:59], v7 offset:12288
    ds_read_b128 v[60:63], v7 offset:13312
    ds_read_b128 v[64:67], v7 offset:14336
    ds_read_b128 v[68:71], v7 offset:15360
    ds_read_b128 v[72:75], v7 offset:16384
    ds_read_b128 v[76:79], v7 offset:17408
    s_waitcnt vmcnt(15)
    s_waitcnt lgkmcnt(11)
    v_mfma_f32_16x16x32_bf16 v[8:11], v[80:83], v[144:147], v[8:11]
    v_mfma_f32_16x16x32_bf16 v[12:15], v[80:83], v[148:151], v[12:15]
    global_load_dwordx4 v[192:195], v6, s[22:23] offset:3072 sc1
    s_waitcnt lgkmcnt(10)
    v_mfma_f32_16x16x32_bf16 v[16:19], v[84:87], v[144:147], v[16:19]
    v_mfma_f32_16x16x32_bf16 v[20:23], v[84:87], v[148:151], v[20:23]
    s_waitcnt lgkmcnt(9)
    v_mfma_f32_16x16x32_bf16 v[24:27], v[88:91], v[144:147], v[24:27]
    v_mfma_f32_16x16x32_bf16 v[28:31], v[88:91], v[148:151], v[28:31]
    global_load_dwordx4 v[196:199], v6, s[24:25] offset:3072 sc1
    s_waitcnt lgkmcnt(8)
    v_mfma_f32_16x16x32_bf16 v[32:35], v[92:95], v[144:147], v[32:35]
    v_mfma_f32_16x16x32_bf16 v[36:39], v[92:95], v[148:151], v[36:39]
    s_waitcnt lgkmcnt(7)
    v_mfma_f32_16x16x32_bf16 v[40:43], v[96:99], v[144:147], v[40:43]
    v_mfma_f32_16x16x32_bf16 v[44:47], v[96:99], v[148:151], v[44:47]
    global_load_dwordx4 a[116:119], v6, s[38:39] offset:1024
    s_waitcnt lgkmcnt(6)
    v_mfma_f32_16x16x32_bf16 v[48:51], v[100:103], v[144:147], v[48:51]
    v_mfma_f32_16x16x32_bf16 v[52:55], v[100:103], v[148:151], v[52:55]
    ds_read_b128 v[80:83], v7 offset:18432
    ds_read_b128 v[84:87], v7 offset:19456
    ds_read_b128 v[88:91], v7 offset:20480
    ds_read_b128 v[92:95], v7 offset:21504
    ds_read_b128 v[96:99], v7 offset:22528
    ds_read_b128 v[100:103], v7 offset:23552
    s_waitcnt vmcnt(16)
    s_waitcnt lgkmcnt(11)
    v_mfma_f32_16x16x32_bf16 v[8:11], v[56:59], v[152:155], v[8:11]
    v_mfma_f32_16x16x32_bf16 v[12:15], v[56:59], v[156:159], v[12:15]
    s_add_u32 s22, s22, 4096
    s_addc_u32 s23, s23, 0
    s_add_u32 s24, s24, 4096
    s_addc_u32 s25, s25, 0
    global_load_dwordx4 v[104:107], v6, s[22:23] offset:0 sc1
    s_waitcnt lgkmcnt(10)
    v_mfma_f32_16x16x32_bf16 v[16:19], v[60:63], v[152:155], v[16:19]
    v_mfma_f32_16x16x32_bf16 v[20:23], v[60:63], v[156:159], v[20:23]
    s_waitcnt lgkmcnt(9)
    v_mfma_f32_16x16x32_bf16 v[24:27], v[64:67], v[152:155], v[24:27]
    v_mfma_f32_16x16x32_bf16 v[28:31], v[64:67], v[156:159], v[28:31]
    global_load_dwordx4 v[108:111], v6, s[24:25] offset:0 sc1
    s_waitcnt lgkmcnt(8)
    v_mfma_f32_16x16x32_bf16 v[32:35], v[68:71], v[152:155], v[32:35]
    v_mfma_f32_16x16x32_bf16 v[36:39], v[68:71], v[156:159], v[36:39]
    s_waitcnt lgkmcnt(7)
    v_mfma_f32_16x16x32_bf16 v[40:43], v[72:75], v[152:155], v[40:43]
    v_mfma_f32_16x16x32_bf16 v[44:47], v[72:75], v[156:159], v[44:47]
    global_load_dwordx4 a[120:123], v6, s[38:39] offset:2048
    s_waitcnt lgkmcnt(6)
    v_mfma_f32_16x16x32_bf16 v[48:51], v[76:79], v[152:155], v[48:51]
    v_mfma_f32_16x16x32_bf16 v[52:55], v[76:79], v[156:159], v[52:55]
    v_add_u32 v7, 49152, v6
    ds_read_b128 v[56:59], v7 offset:0
    ds_read_b128 v[60:63], v7 offset:1024
    ds_read_b128 v[64:67], v7 offset:2048
    ds_read_b128 v[68:71], v7 offset:3072
    ds_read_b128 v[72:75], v7 offset:4096
    ds_read_b128 v[76:79], v7 offset:5120
    s_waitcnt vmcnt(16)
    s_waitcnt lgkmcnt(11)
    v_mfma_f32_16x16x32_bf16 v[8:11], v[80:83], v[160:163], v[8:11]
    v_mfma_f32_16x16x32_bf16 v[12:15], v[80:83], v[164:167], v[12:15]
    global_load_dwordx4 v[112:115], v6, s[22:23] offset:1024 sc1
    s_waitcnt lgkmcnt(10)
    v_mfma_f32_16x16x32_bf16 v[16:19], v[84:87], v[160:163], v[16:19]
    v_mfma_f32_16x16x32_bf16 v[20:23], v[84:87], v[164:167], v[20:23]
    s_waitcnt lgkmcnt(9)
    v_mfma_f32_16x16x32_bf16 v[24:27], v[88:91], v[160:163], v[24:27]
    v_mfma_f32_16x16x32_bf16 v[28:31], v[88:91], v[164:167], v[28:31]
    global_load_dwordx4 v[116:119], v6, s[24:25] offset:1024 sc1
    s_waitcnt lgkmcnt(8)
    v_mfma_f32_16x16x32_bf16 v[32:35], v[92:95], v[160:163], v[32:35]
    v_mfma_f32_16x16x32_bf16 v[36:39], v[92:95], v[164:167], v[36:39]
    s_waitcnt lgkmcnt(7)
    v_mfma_f32_16x16x32_bf16 v[40:43], v[96:99], v[160:163], v[40:43]
    v_mfma_f32_16x16x32_bf16 v[44:47], v[96:99], v[164:167], v[44:47]
    global_load_dwordx4 a[124:127], v6, s[38:39] offset:3072
    s_add_u32 s38, s38, 4096
    s_addc_u32 s39, s39, 0
    s_waitcnt lgkmcnt(6)
    v_mfma_f32_16x16x32_bf16 v[48:51], v[100:103], v[160:163], v[48:51]
    v_mfma_f32_16x16x32_bf16 v[52:55], v[100:103], v[164:167], v[52:55]
    ds_read_b128 v[80:83], v7 offset:6144
    ds_read_b128 v[84:87], v7 offset:7168
    ds_read_b128 v[88:91], v7 offset:8192
    ds_read_b128 v[92:95], v7 offset:9216
    ds_read_b128 v[96:99], v7 offset:10240
    ds_read_b128 v[100:103], v7 offset:11264
    s_waitcnt vmcnt(16)
    s_waitcnt lgkmcnt(11)
    v_mfma_f32_16x16x32_bf16 v[8:11], v[56:59], v[168:171], v[8:11]
    v_mfma_f32_16x16x32_bf16 v[12:15], v[56:59], v[172:175], v[12:15]
    global_load_dwordx4 v[120:123], v6, s[22:23] offset:2048 sc1
    s_waitcnt lgkmcnt(10)
    v_mfma_f32_16x16x32_bf16 v[16:19], v[60:63], v[168:171], v[16:19]
    v_mfma_f32_16x16x32_bf16 v[20:23], v[60:63], v[172:175], v[20:23]
    s_waitcnt lgkmcnt(9)
    v_mfma_f32_16x16x32_bf16 v[24:27], v[64:67], v[168:171], v[24:27]
    v_mfma_f32_16x16x32_bf16 v[28:31], v[64:67], v[172:175], v[28:31]
    global_load_dwordx4 v[124:127], v6, s[24:25] offset:2048 sc1
    s_waitcnt lgkmcnt(8)
    v_mfma_f32_16x16x32_bf16 v[32:35], v[68:71], v[168:171], v[32:35]
    v_mfma_f32_16x16x32_bf16 v[36:39], v[68:71], v[172:175], v[36:39]
    s_waitcnt lgkmcnt(7)
    v_mfma_f32_16x16x32_bf16 v[40:43], v[72:75], v[168:171], v[40:43]
    v_mfma_f32_16x16x32_bf16 v[44:47], v[72:75], v[172:175], v[44:47]
    global_load_dwordx4 a[128:131], v6, s[38:39] offset:0
    s_waitcnt lgkmcnt(6)
    v_mfma_f32_16x16x32_bf16 v[48:51], v[76:79], v[168:171], v[48:51]
    v_mfma_f32_16x16x32_bf16 v[52:55], v[76:79], v[172:175], v[52:55]
    ds_read_b128 v[56:59], v7 offset:12288
    ds_read_b128 v[60:63], v7 offset:13312
    ds_read_b128 v[64:67], v7 offset:14336
    ds_read_b128 v[68:71], v7 offset:15360
    ds_read_b128 v[72:75], v7 offset:16384
    ds_read_b128 v[76:79], v7 offset:17408
    s_waitcnt vmcnt(16)
    s_waitcnt lgkmcnt(11)
    v_mfma_f32_16x16x32_bf16 v[8:11], v[80:83], v[176:179], v[8:11]
    v_mfma_f32_16x16x32_bf16 v[12:15], v[80:83], v[180:183], v[12:15]
    global_load_dwordx4 v[128:131], v6, s[22:23] offset:3072 sc1
    s_waitcnt lgkmcnt(10)
    v_mfma_f32_16x16x32_bf16 v[16:19], v[84:87], v[176:179], v[16:19]
    v_mfma_f32_16x16x32_bf16 v[20:23], v[84:87], v[180:183], v[20:23]
    s_waitcnt lgkmcnt(9)
    v_mfma_f32_16x16x32_bf16 v[24:27], v[88:91], v[176:179], v[24:27]
    v_mfma_f32_16x16x32_bf16 v[28:31], v[88:91], v[180:183], v[28:31]
    global_load_dwordx4 v[132:135], v6, s[24:25] offset:3072 sc1
    s_waitcnt lgkmcnt(8)
    v_mfma_f32_16x16x32_bf16 v[32:35], v[92:95], v[176:179], v[32:35]
    v_mfma_f32_16x16x32_bf16 v[36:39], v[92:95], v[180:183], v[36:39]
    s_waitcnt lgkmcnt(7)
    v_mfma_f32_16x16x32_bf16 v[40:43], v[96:99], v[176:179], v[40:43]
    v_mfma_f32_16x16x32_bf16 v[44:47], v[96:99], v[180:183], v[44:47]
    global_load_dwordx4 a[132:135], v6, s[38:39] offset:1024
    s_waitcnt lgkmcnt(6)
    v_mfma_f32_16x16x32_bf16 v[48:51], v[100:103], v[176:179], v[48:51]
    v_mfma_f32_16x16x32_bf16 v[52:55], v[100:103], v[180:183], v[52:55]
    ds_read_b128 v[80:83], v7 offset:18432
    ds_read_b128 v[84:87], v7 offset:19456
    ds_read_b128 v[88:91], v7 offset:20480
    ds_read_b128 v[92:95], v7 offset:21504
    ds_read_b128 v[96:99], v7 offset:22528
    ds_read_b128 v[100:103], v7 offset:23552
    s_waitcnt vmcnt(16)
    s_waitcnt lgkmcnt(11)
    v_mfma_f32_16x16x32_bf16 v[8:11], v[56:59], v[184:187], v[8:11]
    v_mfma_f32_16x16x32_bf16 v[12:15], v[56:59], v[188:191], v[12:15]
    s_add_u32 s22, s22, 4096
    s_addc_u32 s23, s23, 0
    s_add_u32 s24, s24, 4096
    s_addc_u32 s25, s25, 0
    global_load_dwordx4 v[136:139], v6, s[22:23] offset:0 sc1
    s_waitcnt lgkmcnt(10)
    v_mfma_f32_16x16x32_bf16 v[16:19], v[60:63], v[184:187], v[16:19]
    v_mfma_f32_16x16x32_bf16 v[20:23], v[60:63], v[188:191], v[20:23]
    s_waitcnt lgkmcnt(9)
    v_mfma_f32_16x16x32_bf16 v[24:27], v[64:67], v[184:187], v[24:27]
    v_mfma_f32_16x16x32_bf16 v[28:31], v[64:67], v[188:191], v[28:31]
    global_load_dwordx4 v[140:143], v6, s[24:25] offset:0 sc1
    s_waitcnt lgkmcnt(8)
    v_mfma_f32_16x16x32_bf16 v[32:35], v[68:71], v[184:187], v[32:35]
    v_mfma_f32_16x16x32_bf16 v[36:39], v[68:71], v[188:191], v[36:39]
    s_waitcnt lgkmcnt(7)
    v_mfma_f32_16x16x32_bf16 v[40:43], v[72:75], v[184:187], v[40:43]
    v_mfma_f32_16x16x32_bf16 v[44:47], v[72:75], v[188:191], v[44:47]
    global_load_dwordx4 a[136:139], v6, s[38:39] offset:2048
    s_waitcnt lgkmcnt(6)
    v_mfma_f32_16x16x32_bf16 v[48:51], v[76:79], v[184:187], v[48:51]
    v_mfma_f32_16x16x32_bf16 v[52:55], v[76:79], v[188:191], v[52:55]
    v_add_u32 v7, 73728, v6
    ds_read_b128 v[56:59], v7 offset:0
    ds_read_b128 v[60:63], v7 offset:1024
    ds_read_b128 v[64:67], v7 offset:2048
    ds_read_b128 v[68:71], v7 offset:3072
    ds_read_b128 v[72:75], v7 offset:4096
    ds_read_b128 v[76:79], v7 offset:5120
    s_waitcnt vmcnt(16)
    s_waitcnt lgkmcnt(11)
    v_mfma_f32_16x16x32_bf16 v[8:11], v[80:83], v[192:195], v[8:11]
    v_mfma_f32_16x16x32_bf16 v[12:15], v[80:83], v[196:199], v[12:15]
    global_load_dwordx4 v[144:147], v6, s[22:23] offset:1024 sc1
    s_waitcnt lgkmcnt(10)
    v_mfma_f32_16x16x32_bf16 v[16:19], v[84:87], v[192:195], v[16:19]
    v_mfma_f32_16x16x32_bf16 v[20:23], v[84:87], v[196:199], v[20:23]
    s_waitcnt lgkmcnt(9)
    v_mfma_f32_16x16x32_bf16 v[24:27], v[88:91], v[192:195], v[24:27]
    v_mfma_f32_16x16x32_bf16 v[28:31], v[88:91], v[196:199], v[28:31]
    global_load_dwordx4 v[148:151], v6, s[24:25] offset:1024 sc1
    s_waitcnt lgkmcnt(8)
    v_mfma_f32_16x16x32_bf16 v[32:35], v[92:95], v[192:195], v[32:35]
    v_mfma_f32_16x16x32_bf16 v[36:39], v[92:95], v[196:199], v[36:39]
    s_waitcnt lgkmcnt(7)
    v_mfma_f32_16x16x32_bf16 v[40:43], v[96:99], v[192:195], v[40:43]
    v_mfma_f32_16x16x32_bf16 v[44:47], v[96:99], v[196:199], v[44:47]
    global_load_dwordx4 a[140:143], v6, s[38:39] offset:3072
    s_add_u32 s38, s38, 4096
    s_addc_u32 s39, s39, 0
    s_waitcnt lgkmcnt(6)
    v_mfma_f32_16x16x32_bf16 v[48:51], v[100:103], v[192:195], v[48:51]
    v_mfma_f32_16x16x32_bf16 v[52:55], v[100:103], v[196:199], v[52:55]
    ds_read_b128 v[80:83], v7 offset:6144
    ds_read_b128 v[84:87], v7 offset:7168
    ds_read_b128 v[88:91], v7 offset:8192
    ds_read_b128 v[92:95], v7 offset:9216
    ds_read_b128 v[96:99], v7 offset:10240
    ds_read_b128 v[100:103], v7 offset:11264
    s_waitcnt vmcnt(16)
    s_waitcnt lgkmcnt(11)
    v_mfma_f32_16x16x32_bf16 v[8:11], v[56:59], v[104:107], v[8:11]
    v_mfma_f32_16x16x32_bf16 v[12:15], v[56:59], v[108:111], v[12:15]
    global_load_dwordx4 v[152:155], v6, s[22:23] offset:2048 sc1
    s_waitcnt lgkmcnt(10)
    v_mfma_f32_16x16x32_bf16 v[16:19], v[60:63], v[104:107], v[16:19]
    v_mfma_f32_16x16x32_bf16 v[20:23], v[60:63], v[108:111], v[20:23]
    s_waitcnt lgkmcnt(9)
    v_mfma_f32_16x16x32_bf16 v[24:27], v[64:67], v[104:107], v[24:27]
    v_mfma_f32_16x16x32_bf16 v[28:31], v[64:67], v[108:111], v[28:31]
    global_load_dwordx4 v[156:159], v6, s[24:25] offset:2048 sc1
    s_waitcnt lgkmcnt(8)
    v_mfma_f32_16x16x32_bf16 v[32:35], v[68:71], v[104:107], v[32:35]
    v_mfma_f32_16x16x32_bf16 v[36:39], v[68:71], v[108:111], v[36:39]
    s_waitcnt lgkmcnt(7)
    v_mfma_f32_16x16x32_bf16 v[40:43], v[72:75], v[104:107], v[40:43]
    v_mfma_f32_16x16x32_bf16 v[44:47], v[72:75], v[108:111], v[44:47]
    global_load_dwordx4 a[144:147], v6, s[38:39] offset:0
    s_waitcnt lgkmcnt(6)
    v_mfma_f32_16x16x32_bf16 v[48:51], v[76:79], v[104:107], v[48:51]
    v_mfma_f32_16x16x32_bf16 v[52:55], v[76:79], v[108:111], v[52:55]
    ds_read_b128 v[56:59], v7 offset:12288
    ds_read_b128 v[60:63], v7 offset:13312
    ds_read_b128 v[64:67], v7 offset:14336
    ds_read_b128 v[68:71], v7 offset:15360
    ds_read_b128 v[72:75], v7 offset:16384
    ds_read_b128 v[76:79], v7 offset:17408
    s_waitcnt vmcnt(16)
    s_waitcnt lgkmcnt(11)
    v_mfma_f32_16x16x32_bf16 v[8:11], v[80:83], v[112:115], v[8:11]
    v_mfma_f32_16x16x32_bf16 v[12:15], v[80:83], v[116:119], v[12:15]
    global_load_dwordx4 v[160:163], v6, s[22:23] offset:3072 sc1
    s_waitcnt lgkmcnt(10)
    v_mfma_f32_16x16x32_bf16 v[16:19], v[84:87], v[112:115], v[16:19]
    v_mfma_f32_16x16x32_bf16 v[20:23], v[84:87], v[116:119], v[20:23]
    s_waitcnt lgkmcnt(9)
    v_mfma_f32_16x16x32_bf16 v[24:27], v[88:91], v[112:115], v[24:27]
    v_mfma_f32_16x16x32_bf16 v[28:31], v[88:91], v[116:119], v[28:31]
    global_load_dwordx4 v[164:167], v6, s[24:25] offset:3072 sc1
    s_waitcnt lgkmcnt(8)
    v_mfma_f32_16x16x32_bf16 v[32:35], v[92:95], v[112:115], v[32:35]
    v_mfma_f32_16x16x32_bf16 v[36:39], v[92:95], v[116:119], v[36:39]
    s_waitcnt lgkmcnt(7)
    v_mfma_f32_16x16x32_bf16 v[40:43], v[96:99], v[112:115], v[40:43]
    v_mfma_f32_16x16x32_bf16 v[44:47], v[96:99], v[116:119], v[44:47]
    global_load_dwordx4 a[148:151], v6, s[38:39] offset:1024
    s_waitcnt lgkmcnt(6)
    v_mfma_f32_16x16x32_bf16 v[48:51], v[100:103], v[112:115], v[48:51]
    v_mfma_f32_16x16x32_bf16 v[52:55], v[100:103], v[116:119], v[52:55]
    ds_read_b128 v[80:83], v7 offset:18432
    ds_read_b128 v[84:87], v7 offset:19456
    ds_read_b128 v[88:91], v7 offset:20480
    ds_read_b128 v[92:95], v7 offset:21504
    ds_read_b128 v[96:99], v7 offset:22528
    ds_read_b128 v[100:103], v7 offset:23552
    s_waitcnt vmcnt(16)
    s_waitcnt lgkmcnt(11)
    v_mfma_f32_16x16x32_bf16 v[8:11], v[56:59], v[120:123], v[8:11]
    v_mfma_f32_16x16x32_bf16 v[12:15], v[56:59], v[124:127], v[12:15]
    s_waitcnt lgkmcnt(10)
    v_mfma_f32_16x16x32_bf16 v[16:19], v[60:63], v[120:123], v[16:19]
    v_mfma_f32_16x16x32_bf16 v[20:23], v[60:63], v[124:127], v[20:23]
    s_waitcnt lgkmcnt(9)
    v_mfma_f32_16x16x32_bf16 v[24:27], v[64:67], v[120:123], v[24:27]
    v_mfma_f32_16x16x32_bf16 v[28:31], v[64:67], v[124:127], v[28:31]
    s_waitcnt lgkmcnt(8)
    v_mfma_f32_16x16x32_bf16 v[32:35], v[68:71], v[120:123], v[32:35]
    v_mfma_f32_16x16x32_bf16 v[36:39], v[68:71], v[124:127], v[36:39]
    s_waitcnt lgkmcnt(7)
    v_mfma_f32_16x16x32_bf16 v[40:43], v[72:75], v[120:123], v[40:43]
    v_mfma_f32_16x16x32_bf16 v[44:47], v[72:75], v[124:127], v[44:47]
    global_load_dwordx4 a[152:155], v6, s[38:39] offset:2048
    s_waitcnt lgkmcnt(6)
    v_mfma_f32_16x16x32_bf16 v[48:51], v[76:79], v[120:123], v[48:51]
    v_mfma_f32_16x16x32_bf16 v[52:55], v[76:79], v[124:127], v[52:55]
    v_add_u32 v7, 98304, v6
    ds_read_b128 v[56:59], v7 offset:0
    ds_read_b128 v[60:63], v7 offset:1024
    ds_read_b128 v[64:67], v7 offset:2048
    ds_read_b128 v[68:71], v7 offset:3072
    ds_read_b128 v[72:75], v7 offset:4096
    ds_read_b128 v[76:79], v7 offset:5120
    s_waitcnt vmcnt(14)
    s_waitcnt lgkmcnt(11)
    v_mfma_f32_16x16x32_bf16 v[8:11], v[80:83], v[128:131], v[8:11]
    v_mfma_f32_16x16x32_bf16 v[12:15], v[80:83], v[132:135], v[12:15]
    s_waitcnt lgkmcnt(10)
    v_mfma_f32_16x16x32_bf16 v[16:19], v[84:87], v[128:131], v[16:19]
    v_mfma_f32_16x16x32_bf16 v[20:23], v[84:87], v[132:135], v[20:23]
    s_waitcnt lgkmcnt(9)
    v_mfma_f32_16x16x32_bf16 v[24:27], v[88:91], v[128:131], v[24:27]
    v_mfma_f32_16x16x32_bf16 v[28:31], v[88:91], v[132:135], v[28:31]
    s_waitcnt lgkmcnt(8)
    v_mfma_f32_16x16x32_bf16 v[32:35], v[92:95], v[128:131], v[32:35]
    v_mfma_f32_16x16x32_bf16 v[36:39], v[92:95], v[132:135], v[36:39]
    s_waitcnt lgkmcnt(7)
    v_mfma_f32_16x16x32_bf16 v[40:43], v[96:99], v[128:131], v[40:43]
    v_mfma_f32_16x16x32_bf16 v[44:47], v[96:99], v[132:135], v[44:47]
    global_load_dwordx4 a[156:159], v6, s[38:39] offset:3072
    s_add_u32 s38, s38, 4096
    s_addc_u32 s39, s39, 0
    s_waitcnt lgkmcnt(6)
    v_mfma_f32_16x16x32_bf16 v[48:51], v[100:103], v[128:131], v[48:51]
    v_mfma_f32_16x16x32_bf16 v[52:55], v[100:103], v[132:135], v[52:55]
    ds_read_b128 v[80:83], v7 offset:6144
    ds_read_b128 v[84:87], v7 offset:7168
    ds_read_b128 v[88:91], v7 offset:8192
    ds_read_b128 v[92:95], v7 offset:9216
    ds_read_b128 v[96:99], v7 offset:10240
    ds_read_b128 v[100:103], v7 offset:11264
    s_waitcnt vmcnt(12)
    s_waitcnt lgkmcnt(11)
    v_mfma_f32_16x16x32_bf16 v[8:11], v[56:59], v[136:139], v[8:11]
    v_mfma_f32_16x16x32_bf16 v[12:15], v[56:59], v[140:143], v[12:15]
    s_waitcnt lgkmcnt(10)
    v_mfma_f32_16x16x32_bf16 v[16:19], v[60:63], v[136:139], v[16:19]
    v_mfma_f32_16x16x32_bf16 v[20:23], v[60:63], v[140:143], v[20:23]
    s_waitcnt lgkmcnt(9)
    v_mfma_f32_16x16x32_bf16 v[24:27], v[64:67], v[136:139], v[24:27]
    v_mfma_f32_16x16x32_bf16 v[28:31], v[64:67], v[140:143], v[28:31]
    s_waitcnt lgkmcnt(8)
    v_mfma_f32_16x16x32_bf16 v[32:35], v[68:71], v[136:139], v[32:35]
    v_mfma_f32_16x16x32_bf16 v[36:39], v[68:71], v[140:143], v[36:39]
    s_waitcnt lgkmcnt(7)
    v_mfma_f32_16x16x32_bf16 v[40:43], v[72:75], v[136:139], v[40:43]
    v_mfma_f32_16x16x32_bf16 v[44:47], v[72:75], v[140:143], v[44:47]
    global_load_dwordx4 a[160:163], v6, s[38:39] offset:0
    s_waitcnt lgkmcnt(6)
    v_mfma_f32_16x16x32_bf16 v[48:51], v[76:79], v[136:139], v[48:51]
    v_mfma_f32_16x16x32_bf16 v[52:55], v[76:79], v[140:143], v[52:55]
    ds_read_b128 v[56:59], v7 offset:12288
    ds_read_b128 v[60:63], v7 offset:13312
    ds_read_b128 v[64:67], v7 offset:14336
    ds_read_b128 v[68:71], v7 offset:15360
    ds_read_b128 v[72:75], v7 offset:16384
    ds_read_b128 v[76:79], v7 offset:17408
    s_waitcnt vmcnt(10)
    s_waitcnt lgkmcnt(11)
    v_mfma_f32_16x16x32_bf16 v[8:11], v[80:83], v[144:147], v[8:11]
    v_mfma_f32_16x16x32_bf16 v[12:15], v[80:83], v[148:151], v[12:15]
    s_waitcnt lgkmcnt(10)
    v_mfma_f32_16x16x32_bf16 v[16:19], v[84:87], v[144:147], v[16:19]
    v_mfma_f32_16x16x32_bf16 v[20:23], v[84:87], v[148:151], v[20:23]
    s_waitcnt lgkmcnt(9)
    v_mfma_f32_16x16x32_bf16 v[24:27], v[88:91], v[144:147], v[24:27]
    v_mfma_f32_16x16x32_bf16 v[28:31], v[88:91], v[148:151], v[28:31]
    s_waitcnt lgkmcnt(8)
    v_mfma_f32_16x16x32_bf16 v[32:35], v[92:95], v[144:147], v[32:35]
    v_mfma_f32_16x16x32_bf16 v[36:39], v[92:95], v[148:151], v[36:39]
    s_waitcnt lgkmcnt(7)
    v_mfma_f32_16x16x32_bf16 v[40:43], v[96:99], v[144:147], v[40:43]
    v_mfma_f32_16x16x32_bf16 v[44:47], v[96:99], v[148:151], v[44:47]
    global_load_dwordx4 a[164:167], v6, s[38:39] offset:1024
    s_waitcnt lgkmcnt(6)
    v_mfma_f32_16x16x32_bf16 v[48:51], v[100:103], v[144:147], v[48:51]
    v_mfma_f32_16x16x32_bf16 v[52:55], v[100:103], v[148:151], v[52:55]
    ds_read_b128 v[80:83], v7 offset:18432
    ds_read_b128 v[84:87], v7 offset:19456
    ds_read_b128 v[88:91], v7 offset:20480
    ds_read_b128 v[92:95], v7 offset:21504
    ds_read_b128 v[96:99], v7 offset:22528
    ds_read_b128 v[100:103], v7 offset:23552
    s_waitcnt vmcnt(8)
    s_waitcnt lgkmcnt(11)
    v_mfma_f32_16x16x32_bf16 v[8:11], v[56:59], v[152:155], v[8:11]
    v_mfma_f32_16x16x32_bf16 v[12:15], v[56:59], v[156:159], v[12:15]
    s_waitcnt lgkmcnt(10)
    v_mfma_f32_16x16x32_bf16 v[16:19], v[60:63], v[152:155], v[16:19]
    v_mfma_f32_16x16x32_bf16 v[20:23], v[60:63], v[156:159], v[20:23]
    s_waitcnt lgkmcnt(9)
    v_mfma_f32_16x16x32_bf16 v[24:27], v[64:67], v[152:155], v[24:27]
    v_mfma_f32_16x16x32_bf16 v[28:31], v[64:67], v[156:159], v[28:31]
    s_waitcnt lgkmcnt(8)
    v_mfma_f32_16x16x32_bf16 v[32:35], v[68:71], v[152:155], v[32:35]
    v_mfma_f32_16x16x32_bf16 v[36:39], v[68:71], v[156:159], v[36:39]
    s_waitcnt lgkmcnt(7)
    v_mfma_f32_16x16x32_bf16 v[40:43], v[72:75], v[152:155], v[40:43]
    v_mfma_f32_16x16x32_bf16 v[44:47], v[72:75], v[156:159], v[44:47]
    global_load_dwordx4 a[168:171], v6, s[38:39] offset:2048
    s_waitcnt lgkmcnt(6)
    v_mfma_f32_16x16x32_bf16 v[48:51], v[76:79], v[152:155], v[48:51]
    v_mfma_f32_16x16x32_bf16 v[52:55], v[76:79], v[156:159], v[52:55]
    s_waitcnt vmcnt(6)
    s_waitcnt lgkmcnt(5)
    v_mfma_f32_16x16x32_bf16 v[8:11], v[80:83], v[160:163], v[8:11]
    v_mfma_f32_16x16x32_bf16 v[12:15], v[80:83], v[164:167], v[12:15]
    s_waitcnt lgkmcnt(4)
    v_mfma_f32_16x16x32_bf16 v[16:19], v[84:87], v[160:163], v[16:19]
    v_mfma_f32_16x16x32_bf16 v[20:23], v[84:87], v[164:167], v[20:23]
    s_waitcnt lgkmcnt(3)
    v_mfma_f32_16x16x32_bf16 v[24:27], v[88:91], v[160:163], v[24:27]
    v_mfma_f32_16x16x32_bf16 v[28:31], v[88:91], v[164:167], v[28:31]
    s_waitcnt lgkmcnt(2)
    v_mfma_f32_16x16x32_bf16 v[32:35], v[92:95], v[160:163], v[32:35]
    v_mfma_f32_16x16x32_bf16 v[36:39], v[92:95], v[164:167], v[36:39]
    s_waitcnt lgkmcnt(1)
    v_mfma_f32_16x16x32_bf16 v[40:43], v[96:99], v[160:163], v[40:43]
    v_mfma_f32_16x16x32_bf16 v[44:47], v[96:99], v[164:167], v[44:47]
    global_load_dwordx4 a[172:175], v6, s[38:39] offset:3072
    s_add_u32 s38, s38, 4096
    s_addc_u32 s39, s39, 0
    s_waitcnt lgkmcnt(0)
    v_mfma_f32_16x16x32_bf16 v[48:51], v[100:103], v[160:163], v[48:51]
    v_mfma_f32_16x16x32_bf16 v[52:55], v[100:103], v[164:167], v[52:55]
    s_mov_b32 s16, 0xffff0000
    s_mov_b32 s28, 0xbfb8aa3b
    s_mov_b32 s29, 0xbfb8aa3b
    s_mul_i32 s13, s15, 49152
    s_mul_i32 s14, s12, 3072
    s_add_u32 s13, s13, s14
    s_add_u32 s13, s13, s34
    s_add_u32 s20, s6, s13
    s_addc_u32 s21, s7, 0
    s_add_u32 s22, s20, 49152
    s_addc_u32 s23, s21, 0
    v_cvt_pk_bf16_f32 v112, v8, v9
    v_cvt_pk_bf16_f32 v113, v10, v11
    v_cvt_pk_bf16_f32 v114, v16, v17
    v_cvt_pk_bf16_f32 v115, v18, v19
    v_lshlrev_b32 v104, 16, v112
    v_and_b32 v105, s16, v112
    v_lshlrev_b32 v106, 16, v113
    v_and_b32 v107, s16, v113
    v_lshlrev_b32 v108, 16, v114
    v_and_b32 v109, s16, v114
    v_lshlrev_b32 v110, 16, v115
    v_and_b32 v111, s16, v115
    v_pk_mul_f32 v[112:113], v[104:105], s[28:29]
    v_pk_mul_f32 v[114:115], v[106:107], s[28:29]
    v_pk_mul_f32 v[116:117], v[108:109], s[28:29]
    v_pk_mul_f32 v[118:119], v[110:111], s[28:29]
    v_exp_f32 v112, v112
    v_exp_f32 v113, v113
    v_exp_f32 v114, v114
    v_exp_f32 v115, v115
    v_exp_f32 v116, v116
    v_exp_f32 v117, v117
    v_exp_f32 v118, v118
    v_exp_f32 v119, v119
    v_pk_add_f32 v[112:113], v[112:113], 1.0 op_sel_hi:[1,0]
    v_pk_add_f32 v[114:115], v[114:115], 1.0 op_sel_hi:[1,0]
    v_pk_add_f32 v[116:117], v[116:117], 1.0 op_sel_hi:[1,0]
    v_pk_add_f32 v[118:119], v[118:119], 1.0 op_sel_hi:[1,0]
    v_rcp_f32 v112, v112
    v_rcp_f32 v113, v113
    v_rcp_f32 v114, v114
    v_rcp_f32 v115, v115
    v_rcp_f32 v116, v116
    v_rcp_f32 v117, v117
    v_rcp_f32 v118, v118
    v_rcp_f32 v119, v119
    v_pk_mul_f32 v[104:105], v[104:105], v[112:113]
    v_pk_mul_f32 v[106:107], v[106:107], v[114:115]
    v_pk_mul_f32 v[108:109], v[108:109], v[116:117]
    v_pk_mul_f32 v[110:111], v[110:111], v[118:119]
    v_cvt_pk_bf16_f32 v120, v104, v105
    v_cvt_pk_bf16_f32 v121, v106, v107
    v_cvt_pk_bf16_f32 v122, v108, v109
    v_cvt_pk_bf16_f32 v123, v110, v111
    global_store_dwordx4 v6, v[120:123], s[20:21] offset:0 sc1
    v_cvt_pk_bf16_f32 v136, v12, v13
    v_cvt_pk_bf16_f32 v137, v14, v15
    v_cvt_pk_bf16_f32 v138, v20, v21
    v_cvt_pk_bf16_f32 v139, v22, v23
    v_lshlrev_b32 v128, 16, v136
    v_and_b32 v129, s16, v136
    v_lshlrev_b32 v130, 16, v137
    v_and_b32 v131, s16, v137
    v_lshlrev_b32 v132, 16, v138
    v_and_b32 v133, s16, v138
    v_lshlrev_b32 v134, 16, v139
    v_and_b32 v135, s16, v139
    v_pk_mul_f32 v[136:137], v[128:129], s[28:29]
    v_pk_mul_f32 v[138:139], v[130:131], s[28:29]
    v_pk_mul_f32 v[140:141], v[132:133], s[28:29]
    v_pk_mul_f32 v[142:143], v[134:135], s[28:29]
    v_exp_f32 v136, v136
    v_exp_f32 v137, v137
    v_exp_f32 v138, v138
    v_exp_f32 v139, v139
    v_exp_f32 v140, v140
    v_exp_f32 v141, v141
    v_exp_f32 v142, v142
    v_exp_f32 v143, v143
    v_pk_add_f32 v[136:137], v[136:137], 1.0 op_sel_hi:[1,0]
    v_pk_add_f32 v[138:139], v[138:139], 1.0 op_sel_hi:[1,0]
    v_pk_add_f32 v[140:141], v[140:141], 1.0 op_sel_hi:[1,0]
    v_pk_add_f32 v[142:143], v[142:143], 1.0 op_sel_hi:[1,0]
    v_rcp_f32 v136, v136
    v_rcp_f32 v137, v137
    v_rcp_f32 v138, v138
    v_rcp_f32 v139, v139
    v_rcp_f32 v140, v140
    v_rcp_f32 v141, v141
    v_rcp_f32 v142, v142
    v_rcp_f32 v143, v143
    v_pk_mul_f32 v[128:129], v[128:129], v[136:137]
    v_pk_mul_f32 v[130:131], v[130:131], v[138:139]
    v_pk_mul_f32 v[132:133], v[132:133], v[140:141]
    v_pk_mul_f32 v[134:135], v[134:135], v[142:143]
    v_cvt_pk_bf16_f32 v144, v128, v129
    v_cvt_pk_bf16_f32 v145, v130, v131
    v_cvt_pk_bf16_f32 v146, v132, v133
    v_cvt_pk_bf16_f32 v147, v134, v135
    global_store_dwordx4 v6, v[144:147], s[22:23] offset:0 sc1
    v_cvt_pk_bf16_f32 v160, v24, v25
    v_cvt_pk_bf16_f32 v161, v26, v27
    v_cvt_pk_bf16_f32 v162, v32, v33
    v_cvt_pk_bf16_f32 v163, v34, v35
    v_lshlrev_b32 v152, 16, v160
    v_and_b32 v153, s16, v160
    v_lshlrev_b32 v154, 16, v161
    v_and_b32 v155, s16, v161
    v_lshlrev_b32 v156, 16, v162
    v_and_b32 v157, s16, v162
    v_lshlrev_b32 v158, 16, v163
    v_and_b32 v159, s16, v163
    v_pk_mul_f32 v[160:161], v[152:153], s[28:29]
    v_pk_mul_f32 v[162:163], v[154:155], s[28:29]
    v_pk_mul_f32 v[164:165], v[156:157], s[28:29]
    v_pk_mul_f32 v[166:167], v[158:159], s[28:29]
    v_exp_f32 v160, v160
    v_exp_f32 v161, v161
    v_exp_f32 v162, v162
    v_exp_f32 v163, v163
    v_exp_f32 v164, v164
    v_exp_f32 v165, v165
    v_exp_f32 v166, v166
    v_exp_f32 v167, v167
    v_pk_add_f32 v[160:161], v[160:161], 1.0 op_sel_hi:[1,0]
    v_pk_add_f32 v[162:163], v[162:163], 1.0 op_sel_hi:[1,0]
    v_pk_add_f32 v[164:165], v[164:165], 1.0 op_sel_hi:[1,0]
    v_pk_add_f32 v[166:167], v[166:167], 1.0 op_sel_hi:[1,0]
    v_rcp_f32 v160, v160
    v_rcp_f32 v161, v161
    v_rcp_f32 v162, v162
    v_rcp_f32 v163, v163
    v_rcp_f32 v164, v164
    v_rcp_f32 v165, v165
    v_rcp_f32 v166, v166
    v_rcp_f32 v167, v167
    v_pk_mul_f32 v[152:153], v[152:153], v[160:161]
    v_pk_mul_f32 v[154:155], v[154:155], v[162:163]
    v_pk_mul_f32 v[156:157], v[156:157], v[164:165]
    v_pk_mul_f32 v[158:159], v[158:159], v[166:167]
    v_cvt_pk_bf16_f32 v168, v152, v153
    v_cvt_pk_bf16_f32 v169, v154, v155
    v_cvt_pk_bf16_f32 v170, v156, v157
    v_cvt_pk_bf16_f32 v171, v158, v159
    global_store_dwordx4 v6, v[168:171], s[20:21] offset:1024 sc1
    v_cvt_pk_bf16_f32 v184, v28, v29
    v_cvt_pk_bf16_f32 v185, v30, v31
    v_cvt_pk_bf16_f32 v186, v36, v37
    v_cvt_pk_bf16_f32 v187, v38, v39
    v_lshlrev_b32 v176, 16, v184
    v_and_b32 v177, s16, v184
    v_lshlrev_b32 v178, 16, v185
    v_and_b32 v179, s16, v185
    v_lshlrev_b32 v180, 16, v186
    v_and_b32 v181, s16, v186
    v_lshlrev_b32 v182, 16, v187
    v_and_b32 v183, s16, v187
    v_pk_mul_f32 v[184:185], v[176:177], s[28:29]
    v_pk_mul_f32 v[186:187], v[178:179], s[28:29]
    v_pk_mul_f32 v[188:189], v[180:181], s[28:29]
    v_pk_mul_f32 v[190:191], v[182:183], s[28:29]
    v_exp_f32 v184, v184
    v_exp_f32 v185, v185
    v_exp_f32 v186, v186
    v_exp_f32 v187, v187
    v_exp_f32 v188, v188
    v_exp_f32 v189, v189
    v_exp_f32 v190, v190
    v_exp_f32 v191, v191
    v_pk_add_f32 v[184:185], v[184:185], 1.0 op_sel_hi:[1,0]
    v_pk_add_f32 v[186:187], v[186:187], 1.0 op_sel_hi:[1,0]
    v_pk_add_f32 v[188:189], v[188:189], 1.0 op_sel_hi:[1,0]
    v_pk_add_f32 v[190:191], v[190:191], 1.0 op_sel_hi:[1,0]
    v_rcp_f32 v184, v184
    v_rcp_f32 v185, v185
    v_rcp_f32 v186, v186
    v_rcp_f32 v187, v187
    v_rcp_f32 v188, v188
    v_rcp_f32 v189, v189
    v_rcp_f32 v190, v190
    v_rcp_f32 v191, v191
    v_pk_mul_f32 v[176:177], v[176:177], v[184:185]
    v_pk_mul_f32 v[178:179], v[178:179], v[186:187]
    v_pk_mul_f32 v[180:181], v[180:181], v[188:189]
    v_pk_mul_f32 v[182:183], v[182:183], v[190:191]
    v_cvt_pk_bf16_f32 v192, v176, v177
    v_cvt_pk_bf16_f32 v193, v178, v179
    v_cvt_pk_bf16_f32 v194, v180, v181
    v_cvt_pk_bf16_f32 v195, v182, v183
    global_store_dwordx4 v6, v[192:195], s[22:23] offset:1024 sc1
    v_cvt_pk_bf16_f32 v112, v40, v41
    v_cvt_pk_bf16_f32 v113, v42, v43
    v_cvt_pk_bf16_f32 v114, v48, v49
    v_cvt_pk_bf16_f32 v115, v50, v51
    v_lshlrev_b32 v104, 16, v112
    v_and_b32 v105, s16, v112
    v_lshlrev_b32 v106, 16, v113
    v_and_b32 v107, s16, v113
    v_lshlrev_b32 v108, 16, v114
    v_and_b32 v109, s16, v114
    v_lshlrev_b32 v110, 16, v115
    v_and_b32 v111, s16, v115
    v_pk_mul_f32 v[112:113], v[104:105], s[28:29]
    v_pk_mul_f32 v[114:115], v[106:107], s[28:29]
    v_pk_mul_f32 v[116:117], v[108:109], s[28:29]
    v_pk_mul_f32 v[118:119], v[110:111], s[28:29]
    v_exp_f32 v112, v112
    v_exp_f32 v113, v113
    v_exp_f32 v114, v114
    v_exp_f32 v115, v115
    v_exp_f32 v116, v116
    v_exp_f32 v117, v117
    v_exp_f32 v118, v118
    v_exp_f32 v119, v119
    v_pk_add_f32 v[112:113], v[112:113], 1.0 op_sel_hi:[1,0]
    v_pk_add_f32 v[114:115], v[114:115], 1.0 op_sel_hi:[1,0]
    v_pk_add_f32 v[116:117], v[116:117], 1.0 op_sel_hi:[1,0]
    v_pk_add_f32 v[118:119], v[118:119], 1.0 op_sel_hi:[1,0]
    v_rcp_f32 v112, v112
    v_rcp_f32 v113, v113
    v_rcp_f32 v114, v114
    v_rcp_f32 v115, v115
    v_rcp_f32 v116, v116
    v_rcp_f32 v117, v117
    v_rcp_f32 v118, v118
    v_rcp_f32 v119, v119
    v_pk_mul_f32 v[104:105], v[104:105], v[112:113]
    v_pk_mul_f32 v[106:107], v[106:107], v[114:115]
    v_pk_mul_f32 v[108:109], v[108:109], v[116:117]
    v_pk_mul_f32 v[110:111], v[110:111], v[118:119]
    v_cvt_pk_bf16_f32 v120, v104, v105
    v_cvt_pk_bf16_f32 v121, v106, v107
    v_cvt_pk_bf16_f32 v122, v108, v109
    v_cvt_pk_bf16_f32 v123, v110, v111
    global_store_dwordx4 v6, v[120:123], s[20:21] offset:2048 sc1
    v_cvt_pk_bf16_f32 v136, v44, v45
    v_cvt_pk_bf16_f32 v137, v46, v47
    v_cvt_pk_bf16_f32 v138, v52, v53
    v_cvt_pk_bf16_f32 v139, v54, v55
    v_lshlrev_b32 v128, 16, v136
    v_and_b32 v129, s16, v136
    v_lshlrev_b32 v130, 16, v137
    v_and_b32 v131, s16, v137
    v_lshlrev_b32 v132, 16, v138
    v_and_b32 v133, s16, v138
    v_lshlrev_b32 v134, 16, v139
    v_and_b32 v135, s16, v139
    v_pk_mul_f32 v[136:137], v[128:129], s[28:29]
    v_pk_mul_f32 v[138:139], v[130:131], s[28:29]
    v_pk_mul_f32 v[140:141], v[132:133], s[28:29]
    v_pk_mul_f32 v[142:143], v[134:135], s[28:29]
    v_exp_f32 v136, v136
    v_exp_f32 v137, v137
    v_exp_f32 v138, v138
    v_exp_f32 v139, v139
    v_exp_f32 v140, v140
    v_exp_f32 v141, v141
    v_exp_f32 v142, v142
    v_exp_f32 v143, v143
    v_pk_add_f32 v[136:137], v[136:137], 1.0 op_sel_hi:[1,0]
    v_pk_add_f32 v[138:139], v[138:139], 1.0 op_sel_hi:[1,0]
    v_pk_add_f32 v[140:141], v[140:141], 1.0 op_sel_hi:[1,0]
    v_pk_add_f32 v[142:143], v[142:143], 1.0 op_sel_hi:[1,0]
    v_rcp_f32 v136, v136
    v_rcp_f32 v137, v137
    v_rcp_f32 v138, v138
    v_rcp_f32 v139, v139
    v_rcp_f32 v140, v140
    v_rcp_f32 v141, v141
    v_rcp_f32 v142, v142
    v_rcp_f32 v143, v143
    v_pk_mul_f32 v[128:129], v[128:129], v[136:137]
    v_pk_mul_f32 v[130:131], v[130:131], v[138:139]
    v_pk_mul_f32 v[132:133], v[132:133], v[140:141]
    v_pk_mul_f32 v[134:135], v[134:135], v[142:143]
    v_cvt_pk_bf16_f32 v144, v128, v129
    v_cvt_pk_bf16_f32 v145, v130, v131
    v_cvt_pk_bf16_f32 v146, v132, v133
    v_cvt_pk_bf16_f32 v147, v134, v135
    global_store_dwordx4 v6, v[144:147], s[22:23] offset:2048 sc1
    s_lshl_b32 s13, s11, 3
    s_lshr_b32 s14, s10, 1
    s_lshl_b32 s14, s14, 2
    s_add_u32 s13, s13, s14
    s_lshr_b32 s14, s12, 2
    s_add_u32 s13, s13, s14
    s_lshl_b32 s13, s13, 7
    s_and_b32 s14, s12, 3
    s_lshl_b32 s14, s14, 3
    s_add_u32 s13, s13, s14
    s_and_b32 s14, s10, 1
    s_lshl_b32 s14, s14, 2
    s_add_u32 s13, s13, s14
    s_add_u32 s13, s13, s35
    v_mov_b32 v8, s13
    v_mov_b32 v9, 1
    s_lshl_b32 s13, s11, 3
    s_and_b32 s14, s36, 1
    s_lshl_b32 s14, s14, 2
    s_add_u32 s13, s13, s14
    s_add_u32 s13, s13, s10
    s_lshl_b32 s13, s13, 7
    s_add_u32 s13, s13, s35
    v_lshl_add_u32 v15, v2, 2, s13
    global_load_dwordx4 a[176:179], v6, s[38:39] offset:0
    global_load_dwordx4 a[180:183], v6, s[38:39] offset:1024
    global_load_dwordx4 a[184:187], v6, s[38:39] offset:2048
    global_load_dwordx4 a[188:191], v6, s[38:39] offset:3072
    s_add_u32 s38, s38, 4096
    s_addc_u32 s39, s39, 0
    global_load_dwordx4 a[192:195], v6, s[38:39] offset:0
    global_load_dwordx4 a[196:199], v6, s[38:39] offset:1024
    global_load_dwordx4 a[200:203], v6, s[38:39] offset:2048
    global_load_dwordx4 a[204:207], v6, s[38:39] offset:3072
    s_add_u32 s38, s38, 4096
    s_addc_u32 s39, s39, 0
    global_load_dwordx4 a[208:211], v6, s[38:39] offset:0
    global_load_dwordx4 a[212:215], v6, s[38:39] offset:1024
    s_waitcnt vmcnt(10)
    s_mov_b64 exec, 1
    global_store_dword v8, v9, s[6:7] sc1
    s_mov_b64 exec, -1
    global_load_dwordx4 a[216:219], v6, s[38:39] offset:2048
    global_load_dwordx4 a[220:223], v6, s[38:39] offset:3072
    s_add_u32 s38, s38, 4096
    s_addc_u32 s39, s39, 0
    global_load_dwordx4 a[224:227], v6, s[38:39] offset:0
    global_load_dwordx4 a[228:231], v6, s[38:39] offset:1024
    global_load_dwordx4 a[232:235], v6, s[38:39] offset:2048
    global_load_dwordx4 a[236:239], v6, s[38:39] offset:3072
    s_add_u32 s38, s38, 4096
    s_addc_u32 s39, s39, 0
    s_add_u32 s13, s10, 0
    s_and_b32 s13, s13, 3
    s_lshl_b32 s14, s36, 2
    s_add_u32 s13, s13, s14
    s_mul_i32 s13, s13, 49152
    s_mul_i32 s14, s10, 12288
    s_add_u32 s13, s13, s14
    s_add_u32 s13, s13, s34
    s_add_u32 s20, s6, s13
    s_addc_u32 s21, s7, 0
    s_add_u32 s13, s10, 1
    s_and_b32 s13, s13, 3
    s_lshl_b32 s14, s36, 2
    s_add_u32 s13, s13, s14
    s_mul_i32 s13, s13, 49152
    s_mul_i32 s14, s10, 12288
    s_add_u32 s13, s13, s14
    s_add_u32 s13, s13, s34
    s_add_u32 s22, s6, s13
    s_addc_u32 s23, s7, 0
    s_add_u32 s13, s10, 2
    s_and_b32 s13, s13, 3
    s_lshl_b32 s14, s36, 2
    s_add_u32 s13, s13, s14
    s_mul_i32 s13, s13, 49152
    s_mul_i32 s14, s10, 12288
    s_add_u32 s13, s13, s14
    s_add_u32 s13, s13, s34
    s_add_u32 s24, s6, s13
    s_addc_u32 s25, s7, 0
    s_add_u32 s13, s10, 3
    s_and_b32 s13, s13, 3
    s_lshl_b32 s14, s36, 2
    s_add_u32 s13, s13, s14
    s_mul_i32 s13, s13, 49152
    s_mul_i32 s14, s10, 12288
    s_add_u32 s13, s13, s14
    s_add_u32 s13, s13, s34
    s_add_u32 s26, s6, s13
    s_addc_u32 s27, s7, 0
    s_lshl_b32 s13, s36, 2
    s_add_u32 s13, s13, s10
    s_lshr_b32 s14, s13, 4
    s_lshl_b32 s14, s14, 8
    s_and_b32 s15, s13, 15
    s_lshl_b32 s15, s15, 1
    s_add_u32 s14, s14, s15
    v_and_b32 v7, 7, v3
    v_lshlrev_b32 v7, 5, v7
    v_lshrrev_b32 v10, 3, v3
    v_add3_u32 v7, v7, v10, s14
    v_mul_u32_u24 v7, 1280, v7
    v_lshl_add_u32 v7, v4, 3, v7
    s_mul_i32 s14, s37, 160
    v_add_u32 v7, s14, v7
    s_add_u32 s16, s6, 0x600000
    s_addc_u32 s17, s7, 0
    v_mov_b32 v16, 0
    v_mov_b32 v17, 0
    v_mov_b32 v18, 0
    v_mov_b32 v19, 0
    v_mov_b32 v20, 0
    v_mov_b32 v21, 0
    v_mov_b32 v22, 0
    v_mov_b32 v23, 0
    v_mov_b32 v24, 0
    v_mov_b32 v25, 0
    v_mov_b32 v26, 0
    v_mov_b32 v27, 0
    v_mov_b32 v28, 0
    v_mov_b32 v29, 0
    v_mov_b32 v30, 0
    v_mov_b32 v31, 0
    v_mov_b32 v32, 0
    v_mov_b32 v33, 0
    v_mov_b32 v34, 0
    v_mov_b32 v35, 0
    v_mov_b32 v36, 0
    v_mov_b32 v37, 0
    v_mov_b32 v38, 0
    v_mov_b32 v39, 0
    v_mov_b32 v40, 0
    v_mov_b32 v41, 0
    v_mov_b32 v42, 0
    v_mov_b32 v43, 0
    v_mov_b32 v44, 0
    v_mov_b32 v45, 0
    v_mov_b32 v46, 0
    v_mov_b32 v47, 0
    v_mov_b32 v48, 0
    v_mov_b32 v49, 0
    v_mov_b32 v50, 0
    v_mov_b32 v51, 0
    v_mov_b32 v52, 0
    v_mov_b32 v53, 0
    v_mov_b32 v54, 0
    v_mov_b32 v55, 0
    v_mov_b32 v56, 0
    v_mov_b32 v57, 0
    v_mov_b32 v58, 0
    v_mov_b32 v59, 0
    v_mov_b32 v60, 0
    v_mov_b32 v61, 0
    v_mov_b32 v62, 0
    v_mov_b32 v63, 0
    v_mov_b32 v64, 0
    v_mov_b32 v65, 0
    v_mov_b32 v66, 0
    v_mov_b32 v67, 0
    v_mov_b32 v68, 0
    v_mov_b32 v69, 0
    v_mov_b32 v70, 0
    v_mov_b32 v71, 0
    v_mov_b32 v72, 0
    v_mov_b32 v73, 0
    v_mov_b32 v74, 0
    v_mov_b32 v75, 0
    v_mov_b32 v76, 0
    v_mov_b32 v77, 0
    v_mov_b32 v78, 0
    v_mov_b32 v79, 0
    v_mov_b32 v80, 0
    v_mov_b32 v81, 0
    v_mov_b32 v82, 0
    v_mov_b32 v83, 0
    v_mov_b32 v84, 0
    v_mov_b32 v85, 0
    v_mov_b32 v86, 0
    v_mov_b32 v87, 0
    v_mov_b32 v88, 0
    v_mov_b32 v89, 0
    v_mov_b32 v90, 0
    v_mov_b32 v91, 0
    v_mov_b32 v92, 0
    v_mov_b32 v93, 0
    v_mov_b32 v94, 0
    v_mov_b32 v95, 0
    s_add_u32 s13, s10, 1
    s_and_b32 s13, s13, 3
    s_mul_i32 s13, s13, 15360
    s_add_u32 s13, s13, 0
    v_add_u32 v12, s13, v6
    s_add_u32 s13, s10, 2
    s_and_b32 s13, s13, 3
    s_mul_i32 s13, s13, 15360
    s_add_u32 s13, s13, 5120
    v_add_u32 v13, s13, v6
    s_add_u32 s13, s10, 3
    s_and_b32 s13, s13, 3
    s_mul_i32 s13, s13, 15360
    s_add_u32 s13, s13, 10240
    v_add_u32 v14, s13, v6
    s_mul_i32 s13, s10, 15360
    v_add_u32 v11, s13, v6
    s_mov_b32 s18, 0xffff0000
    s_barrier
    s_mov_b32 s19, 0x400000
    s_mov_b64 exec, 0xff
L_F_poll:
    global_load_dword v10, v15, s[6:7] sc1
    s_waitcnt vmcnt(0)
    v_cmp_eq_u32 vcc, 1, v10
    s_sub_u32 s19, s19, 1
    s_cmp_eq_u32 s19, 0
    s_cbranch_scc1 L_F_pdone
    s_cmp_eq_u32 vcc_lo, 0xff
    s_cbranch_scc1 L_F_pdone
    s_sleep 1
    s_branch L_F_poll
L_F_pdone:
    s_mov_b64 exec, -1
    global_load_dwordx4 v[108:111], v6, s[20:21] offset:0 sc1
    global_load_dwordx4 v[112:115], v6, s[22:23] offset:0 sc1
    global_load_dwordx4 v[116:119], v6, s[24:25] offset:0 sc1
    global_load_dwordx4 v[120:123], v6, s[26:27] offset:0 sc1
    global_load_dwordx4 v[124:127], v6, s[20:21] offset:1024 sc1
    global_load_dwordx4 v[128:131], v6, s[22:23] offset:1024 sc1
    global_load_dwordx4 v[132:135], v6, s[24:25] offset:1024 sc1
    global_load_dwordx4 v[136:139], v6, s[26:27] offset:1024 sc1
    global_load_dwordx4 v[140:143], v6, s[20:21] offset:2048 sc1
    global_load_dwordx4 v[144:147], v6, s[22:23] offset:2048 sc1
    global_load_dwordx4 v[148:151], v6, s[24:25] offset:2048 sc1
    global_load_dwordx4 v[152:155], v6, s[26:27] offset:2048 sc1
    global_load_dwordx2 v[96:97], v7, s[16:17] offset:0 sc1
    global_load_dwordx2 v[98:99], v7, s[16:17] offset:32 sc1
    global_load_dwordx2 v[100:101], v7, s[16:17] offset:64 sc1
    global_load_dwordx2 v[102:103], v7, s[16:17] offset:96 sc1
    global_load_dwordx2 v[104:105], v7, s[16:17] offset:128 sc1
    s_waitcnt vmcnt(13)
    v_mfma_f32_16x16x32_bf16 v[16:19], a[0:3], v[108:111], v[16:19]
    v_mfma_f32_16x16x32_bf16 v[20:23], a[4:7], v[108:111], v[20:23]
    global_load_dwordx4 v[156:159], v6, s[20:21] offset:3072 sc1
    v_mfma_f32_16x16x32_bf16 v[24:27], a[8:11], v[108:111], v[24:27]
    v_mfma_f32_16x16x32_bf16 v[28:31], a[12:15], v[108:111], v[28:31]
    v_mfma_f32_16x16x32_bf16 v[32:35], a[16:19], v[108:111], v[32:35]
    v_mfma_f32_16x16x32_bf16 v[36:39], a[0:3], v[112:115], v[36:39]
    global_load_dwordx4 v[160:163], v6, s[22:23] offset:3072 sc1
    v_mfma_f32_16x16x32_bf16 v[40:43], a[4:7], v[112:115], v[40:43]
    v_mfma_f32_16x16x32_bf16 v[44:47], a[8:11], v[112:115], v[44:47]
    v_mfma_f32_16x16x32_bf16 v[48:51], a[12:15], v[112:115], v[48:51]
    v_mfma_f32_16x16x32_bf16 v[52:55], a[16:19], v[112:115], v[52:55]
    global_load_dwordx4 v[164:167], v6, s[24:25] offset:3072 sc1
    v_mfma_f32_16x16x32_bf16 v[56:59], a[0:3], v[116:119], v[56:59]
    v_mfma_f32_16x16x32_bf16 v[60:63], a[4:7], v[116:119], v[60:63]
    v_mfma_f32_16x16x32_bf16 v[64:67], a[8:11], v[116:119], v[64:67]
    v_mfma_f32_16x16x32_bf16 v[68:71], a[12:15], v[116:119], v[68:71]
    global_load_dwordx4 v[168:171], v6, s[26:27] offset:3072 sc1
    v_mfma_f32_16x16x32_bf16 v[72:75], a[16:19], v[116:119], v[72:75]
    v_mfma_f32_16x16x32_bf16 v[76:79], a[0:3], v[120:123], v[76:79]
    v_mfma_f32_16x16x32_bf16 v[80:83], a[4:7], v[120:123], v[80:83]
    v_mfma_f32_16x16x32_bf16 v[84:87], a[8:11], v[120:123], v[84:87]
    v_mfma_f32_16x16x32_bf16 v[88:91], a[12:15], v[120:123], v[88:91]
    v_mfma_f32_16x16x32_bf16 v[92:95], a[16:19], v[120:123], v[92:95]
    s_waitcnt vmcnt(13)
    v_mfma_f32_16x16x32_bf16 v[16:19], a[20:23], v[124:127], v[16:19]
    v_mfma_f32_16x16x32_bf16 v[20:23], a[24:27], v[124:127], v[20:23]
    s_add_u32 s20, s20, 4096
    s_addc_u32 s21, s21, 0
    s_add_u32 s22, s22, 4096
    s_addc_u32 s23, s23, 0
    s_add_u32 s24, s24, 4096
    s_addc_u32 s25, s25, 0
    s_add_u32 s26, s26, 4096
    s_addc_u32 s27, s27, 0
    global_load_dwordx4 v[172:175], v6, s[20:21] offset:0 sc1
    v_mfma_f32_16x16x32_bf16 v[24:27], a[28:31], v[124:127], v[24:27]
    v_mfma_f32_16x16x32_bf16 v[28:31], a[32:35], v[124:127], v[28:31]
    v_mfma_f32_16x16x32_bf16 v[32:35], a[36:39], v[124:127], v[32:35]
    v_mfma_f32_16x16x32_bf16 v[36:39], a[20:23], v[128:131], v[36:39]
    global_load_dwordx4 v[176:179], v6, s[22:23] offset:0 sc1
    v_mfma_f32_16x16x32_bf16 v[40:43], a[24:27], v[128:131], v[40:43]
    v_mfma_f32_16x16x32_bf16 v[44:47], a[28:31], v[128:131], v[44:47]
    v_mfma_f32_16x16x32_bf16 v[48:51], a[32:35], v[128:131], v[48:51]
    v_mfma_f32_16x16x32_bf16 v[52:55], a[36:39], v[128:131], v[52:55]
    global_load_dwordx4 v[180:183], v6, s[24:25] offset:0 sc1
    v_mfma_f32_16x16x32_bf16 v[56:59], a[20:23], v[132:135], v[56:59]
    v_mfma_f32_16x16x32_bf16 v[60:63], a[24:27], v[132:135], v[60:63]
    v_mfma_f32_16x16x32_bf16 v[64:67], a[28:31], v[132:135], v[64:67]
    v_mfma_f32_16x16x32_bf16 v[68:71], a[32:35], v[132:135], v[68:71]
    global_load_dwordx4 v[184:187], v6, s[26:27] offset:0 sc1
    v_mfma_f32_16x16x32_bf16 v[72:75], a[36:39], v[132:135], v[72:75]
    v_mfma_f32_16x16x32_bf16 v[76:79], a[20:23], v[136:139], v[76:79]
    v_mfma_f32_16x16x32_bf16 v[80:83], a[24:27], v[136:139], v[80:83]
    v_mfma_f32_16x16x32_bf16 v[84:87], a[28:31], v[136:139], v[84:87]
    v_mfma_f32_16x16x32_bf16 v[88:91], a[32:35], v[136:139], v[88:91]
    v_mfma_f32_16x16x32_bf16 v[92:95], a[36:39], v[136:139], v[92:95]
    s_waitcnt vmcnt(13)
    v_mfma_f32_16x16x32_bf16 v[16:19], a[40:43], v[140:143], v[16:19]
    v_mfma_f32_16x16x32_bf16 v[20:23], a[44:47], v[140:143], v[20:23]
    global_load_dwordx4 v[188:191], v6, s[20:21] offset:1024 sc1
    v_mfma_f32_16x16x32_bf16 v[24:27], a[48:51], v[140:143], v[24:27]
    v_mfma_f32_16x16x32_bf16 v[28:31], a[52:55], v[140:143], v[28:31]
    v_mfma_f32_16x16x32_bf16 v[32:35], a[56:59], v[140:143], v[32:35]
    v_mfma_f32_16x16x32_bf16 v[36:39], a[40:43], v[144:147], v[36:39]
    global_load_dwordx4 v[192:195], v6, s[22:23] offset:1024 sc1
    v_mfma_f32_16x16x32_bf16 v[40:43], a[44:47], v[144:147], v[40:43]
    v_mfma_f32_16x16x32_bf16 v[44:47], a[48:51], v[144:147], v[44:47]
    v_mfma_f32_16x16x32_bf16 v[48:51], a[52:55], v[144:147], v[48:51]
    v_mfma_f32_16x16x32_bf16 v[52:55], a[56:59], v[144:147], v[52:55]
    global_load_dwordx4 v[196:199], v6, s[24:25] offset:1024 sc1
    v_mfma_f32_16x16x32_bf16 v[56:59], a[40:43], v[148:151], v[56:59]
    v_mfma_f32_16x16x32_bf16 v[60:63], a[44:47], v[148:151], v[60:63]
    v_mfma_f32_16x16x32_bf16 v[64:67], a[48:51], v[148:151], v[64:67]
    v_mfma_f32_16x16x32_bf16 v[68:71], a[52:55], v[148:151], v[68:71]
    global_load_dwordx4 v[200:203], v6, s[26:27] offset:1024 sc1
    v_mfma_f32_16x16x32_bf16 v[72:75], a[56:59], v[148:151], v[72:75]
    v_mfma_f32_16x16x32_bf16 v[76:79], a[40:43], v[152:155], v[76:79]
    v_mfma_f32_16x16x32_bf16 v[80:83], a[44:47], v[152:155], v[80:83]
    v_mfma_f32_16x16x32_bf16 v[84:87], a[48:51], v[152:155], v[84:87]
    v_mfma_f32_16x16x32_bf16 v[88:91], a[52:55], v[152:155], v[88:91]
    v_mfma_f32_16x16x32_bf16 v[92:95], a[56:59], v[152:155], v[92:95]
    s_waitcnt vmcnt(8)
    v_mfma_f32_16x16x32_bf16 v[16:19], a[60:63], v[156:159], v[16:19]
    v_mfma_f32_16x16x32_bf16 v[20:23], a[64:67], v[156:159], v[20:23]
    global_load_dwordx4 v[204:207], v6, s[20:21] offset:2048 sc1
    v_mfma_f32_16x16x32_bf16 v[24:27], a[68:71], v[156:159], v[24:27]
    v_mfma_f32_16x16x32_bf16 v[28:31], a[72:75], v[156:159], v[28:31]
    v_mfma_f32_16x16x32_bf16 v[32:35], a[76:79], v[156:159], v[32:35]
    v_mfma_f32_16x16x32_bf16 v[36:39], a[60:63], v[160:163], v[36:39]
    global_load_dwordx4 v[208:211], v6, s[22:23] offset:2048 sc1
    v_mfma_f32_16x16x32_bf16 v[40:43], a[64:67], v[160:163], v[40:43]
    v_mfma_f32_16x16x32_bf16 v[44:47], a[68:71], v[160:163], v[44:47]
    v_mfma_f32_16x16x32_bf16 v[48:51], a[72:75], v[160:163], v[48:51]
    v_mfma_f32_16x16x32_bf16 v[52:55], a[76:79], v[160:163], v[52:55]
    global_load_dwordx4 v[212:215], v6, s[24:25] offset:2048 sc1
    v_mfma_f32_16x16x32_bf16 v[56:59], a[60:63], v[164:167], v[56:59]
    v_mfma_f32_16x16x32_bf16 v[60:63], a[64:67], v[164:167], v[60:63]
    v_mfma_f32_16x16x32_bf16 v[64:67], a[68:71], v[164:167], v[64:67]
    v_mfma_f32_16x16x32_bf16 v[68:71], a[72:75], v[164:167], v[68:71]
    global_load_dwordx4 v[216:219], v6, s[26:27] offset:2048 sc1
    v_mfma_f32_16x16x32_bf16 v[72:75], a[76:79], v[164:167], v[72:75]
    v_mfma_f32_16x16x32_bf16 v[76:79], a[60:63], v[168:171], v[76:79]
    v_mfma_f32_16x16x32_bf16 v[80:83], a[64:67], v[168:171], v[80:83]
    v_mfma_f32_16x16x32_bf16 v[84:87], a[68:71], v[168:171], v[84:87]
    v_mfma_f32_16x16x32_bf16 v[88:91], a[72:75], v[168:171], v[88:91]
    v_mfma_f32_16x16x32_bf16 v[92:95], a[76:79], v[168:171], v[92:95]
    s_waitcnt vmcnt(8)
    v_mfma_f32_16x16x32_bf16 v[16:19], a[80:83], v[172:175], v[16:19]
    v_mfma_f32_16x16x32_bf16 v[20:23], a[84:87], v[172:175], v[20:23]
    global_load_dwordx4 v[220:223], v6, s[20:21] offset:3072 sc1
    v_mfma_f32_16x16x32_bf16 v[24:27], a[88:91], v[172:175], v[24:27]
    v_mfma_f32_16x16x32_bf16 v[28:31], a[92:95], v[172:175], v[28:31]
    v_mfma_f32_16x16x32_bf16 v[32:35], a[96:99], v[172:175], v[32:35]
    v_mfma_f32_16x16x32_bf16 v[36:39], a[80:83], v[176:179], v[36:39]
    global_load_dwordx4 v[224:227], v6, s[22:23] offset:3072 sc1
    v_mfma_f32_16x16x32_bf16 v[40:43], a[84:87], v[176:179], v[40:43]
    v_mfma_f32_16x16x32_bf16 v[44:47], a[88:91], v[176:179], v[44:47]
    v_mfma_f32_16x16x32_bf16 v[48:51], a[92:95], v[176:179], v[48:51]
    v_mfma_f32_16x16x32_bf16 v[52:55], a[96:99], v[176:179], v[52:55]
    global_load_dwordx4 v[228:231], v6, s[24:25] offset:3072 sc1
    v_mfma_f32_16x16x32_bf16 v[56:59], a[80:83], v[180:183], v[56:59]
    v_mfma_f32_16x16x32_bf16 v[60:63], a[84:87], v[180:183], v[60:63]
    v_mfma_f32_16x16x32_bf16 v[64:67], a[88:91], v[180:183], v[64:67]
    v_mfma_f32_16x16x32_bf16 v[68:71], a[92:95], v[180:183], v[68:71]
    global_load_dwordx4 v[232:235], v6, s[26:27] offset:3072 sc1
    v_mfma_f32_16x16x32_bf16 v[72:75], a[96:99], v[180:183], v[72:75]
    v_mfma_f32_16x16x32_bf16 v[76:79], a[80:83], v[184:187], v[76:79]
    v_mfma_f32_16x16x32_bf16 v[80:83], a[84:87], v[184:187], v[80:83]
    v_mfma_f32_16x16x32_bf16 v[84:87], a[88:91], v[184:187], v[84:87]
    v_mfma_f32_16x16x32_bf16 v[88:91], a[92:95], v[184:187], v[88:91]
    v_mfma_f32_16x16x32_bf16 v[92:95], a[96:99], v[184:187], v[92:95]
    s_waitcnt vmcnt(8)
    v_mfma_f32_16x16x32_bf16 v[16:19], a[100:103], v[188:191], v[16:19]
    v_mfma_f32_16x16x32_bf16 v[20:23], a[104:107], v[188:191], v[20:23]
    s_add_u32 s20, s20, 4096
    s_addc_u32 s21, s21, 0
    s_add_u32 s22, s22, 4096
    s_addc_u32 s23, s23, 0
    s_add_u32 s24, s24, 4096
    s_addc_u32 s25, s25, 0
    s_add_u32 s26, s26, 4096
    s_addc_u32 s27, s27, 0
    global_load_dwordx4 v[236:239], v6, s[20:21] offset:0 sc1
    v_mfma_f32_16x16x32_bf16 v[24:27], a[108:111], v[188:191], v[24:27]
    v_mfma_f32_16x16x32_bf16 v[28:31], a[112:115], v[188:191], v[28:31]
    v_mfma_f32_16x16x32_bf16 v[32:35], a[116:119], v[188:191], v[32:35]
    v_mfma_f32_16x16x32_bf16 v[36:39], a[100:103], v[192:195], v[36:39]
    global_load_dwordx4 v[240:243], v6, s[22:23] offset:0 sc1
    v_mfma_f32_16x16x32_bf16 v[40:43], a[104:107], v[192:195], v[40:43]
    v_mfma_f32_16x16x32_bf16 v[44:47], a[108:111], v[192:195], v[44:47]
    v_mfma_f32_16x16x32_bf16 v[48:51], a[112:115], v[192:195], v[48:51]
    v_mfma_f32_16x16x32_bf16 v[52:55], a[116:119], v[192:195], v[52:55]
    global_load_dwordx4 v[244:247], v6, s[24:25] offset:0 sc1
    v_mfma_f32_16x16x32_bf16 v[56:59], a[100:103], v[196:199], v[56:59]
    v_mfma_f32_16x16x32_bf16 v[60:63], a[104:107], v[196:199], v[60:63]
    v_mfma_f32_16x16x32_bf16 v[64:67], a[108:111], v[196:199], v[64:67]
    v_mfma_f32_16x16x32_bf16 v[68:71], a[112:115], v[196:199], v[68:71]
    global_load_dwordx4 v[248:251], v6, s[26:27] offset:0 sc1
    v_mfma_f32_16x16x32_bf16 v[72:75], a[116:119], v[196:199], v[72:75]
    v_mfma_f32_16x16x32_bf16 v[76:79], a[100:103], v[200:203], v[76:79]
    v_mfma_f32_16x16x32_bf16 v[80:83], a[104:107], v[200:203], v[80:83]
    v_mfma_f32_16x16x32_bf16 v[84:87], a[108:111], v[200:203], v[84:87]
    v_mfma_f32_16x16x32_bf16 v[88:91], a[112:115], v[200:203], v[88:91]
    v_mfma_f32_16x16x32_bf16 v[92:95], a[116:119], v[200:203], v[92:95]
    s_waitcnt vmcnt(8)
    v_mfma_f32_16x16x32_bf16 v[16:19], a[120:123], v[204:207], v[16:19]
    v_mfma_f32_16x16x32_bf16 v[20:23], a[124:127], v[204:207], v[20:23]
    global_load_dwordx4 v[108:111], v6, s[20:21] offset:1024 sc1
    v_mfma_f32_16x16x32_bf16 v[24:27], a[128:131], v[204:207], v[24:27]
    v_mfma_f32_16x16x32_bf16 v[28:31], a[132:135], v[204:207], v[28:31]
    v_mfma_f32_16x16x32_bf16 v[32:35], a[136:139], v[204:207], v[32:35]
    v_mfma_f32_16x16x32_bf16 v[36:39], a[120:123], v[208:211], v[36:39]
    global_load_dwordx4 v[112:115], v6, s[22:23] offset:1024 sc1
    v_mfma_f32_16x16x32_bf16 v[40:43], a[124:127], v[208:211], v[40:43]
    v_mfma_f32_16x16x32_bf16 v[44:47], a[128:131], v[208:211], v[44:47]
    v_mfma_f32_16x16x32_bf16 v[48:51], a[132:135], v[208:211], v[48:51]
    v_mfma_f32_16x16x32_bf16 v[52:55], a[136:139], v[208:211], v[52:55]
    global_load_dwordx4 v[116:119], v6, s[24:25] offset:1024 sc1
    v_mfma_f32_16x16x32_bf16 v[56:59], a[120:123], v[212:215], v[56:59]
    v_mfma_f32_16x16x32_bf16 v[60:63], a[124:127], v[212:215], v[60:63]
    v_mfma_f32_16x16x32_bf16 v[64:67], a[128:131], v[212:215], v[64:67]
    v_mfma_f32_16x16x32_bf16 v[68:71], a[132:135], v[212:215], v[68:71]
    global_load_dwordx4 v[120:123], v6, s[26:27] offset:1024 sc1
    v_mfma_f32_16x16x32_bf16 v[72:75], a[136:139], v[212:215], v[72:75]
    v_mfma_f32_16x16x32_bf16 v[76:79], a[120:123], v[216:219], v[76:79]
    v_mfma_f32_16x16x32_bf16 v[80:83], a[124:127], v[216:219], v[80:83]
    v_mfma_f32_16x16x32_bf16 v[84:87], a[128:131], v[216:219], v[84:87]
    v_mfma_f32_16x16x32_bf16 v[88:91], a[132:135], v[216:219], v[88:91]
    v_mfma_f32_16x16x32_bf16 v[92:95], a[136:139], v[216:219], v[92:95]
    s_waitcnt vmcnt(8)
    v_mfma_f32_16x16x32_bf16 v[16:19], a[140:143], v[220:223], v[16:19]
    v_mfma_f32_16x16x32_bf16 v[20:23], a[144:147], v[220:223], v[20:23]
    global_load_dwordx4 v[124:127], v6, s[20:21] offset:2048 sc1
    v_mfma_f32_16x16x32_bf16 v[24:27], a[148:151], v[220:223], v[24:27]
    v_mfma_f32_16x16x32_bf16 v[28:31], a[152:155], v[220:223], v[28:31]
    v_mfma_f32_16x16x32_bf16 v[32:35], a[156:159], v[220:223], v[32:35]
    v_mfma_f32_16x16x32_bf16 v[36:39], a[140:143], v[224:227], v[36:39]
    global_load_dwordx4 v[128:131], v6, s[22:23] offset:2048 sc1
    v_mfma_f32_16x16x32_bf16 v[40:43], a[144:147], v[224:227], v[40:43]
    v_mfma_f32_16x16x32_bf16 v[44:47], a[148:151], v[224:227], v[44:47]
    v_mfma_f32_16x16x32_bf16 v[48:51], a[152:155], v[224:227], v[48:51]
    v_mfma_f32_16x16x32_bf16 v[52:55], a[156:159], v[224:227], v[52:55]
    global_load_dwordx4 v[132:135], v6, s[24:25] offset:2048 sc1
    v_mfma_f32_16x16x32_bf16 v[56:59], a[140:143], v[228:231], v[56:59]
    v_mfma_f32_16x16x32_bf16 v[60:63], a[144:147], v[228:231], v[60:63]
    v_mfma_f32_16x16x32_bf16 v[64:67], a[148:151], v[228:231], v[64:67]
    v_mfma_f32_16x16x32_bf16 v[68:71], a[152:155], v[228:231], v[68:71]
    global_load_dwordx4 v[136:139], v6, s[26:27] offset:2048 sc1
    v_mfma_f32_16x16x32_bf16 v[72:75], a[156:159], v[228:231], v[72:75]
    v_mfma_f32_16x16x32_bf16 v[76:79], a[140:143], v[232:235], v[76:79]
    v_mfma_f32_16x16x32_bf16 v[80:83], a[144:147], v[232:235], v[80:83]
    v_mfma_f32_16x16x32_bf16 v[84:87], a[148:151], v[232:235], v[84:87]
    v_mfma_f32_16x16x32_bf16 v[88:91], a[152:155], v[232:235], v[88:91]
    v_mfma_f32_16x16x32_bf16 v[92:95], a[156:159], v[232:235], v[92:95]
    s_waitcnt vmcnt(8)
    v_mfma_f32_16x16x32_bf16 v[16:19], a[160:163], v[236:239], v[16:19]
    v_mfma_f32_16x16x32_bf16 v[20:23], a[164:167], v[236:239], v[20:23]
    global_load_dwordx4 v[140:143], v6, s[20:21] offset:3072 sc1
    v_mfma_f32_16x16x32_bf16 v[24:27], a[168:171], v[236:239], v[24:27]
    v_mfma_f32_16x16x32_bf16 v[28:31], a[172:175], v[236:239], v[28:31]
    v_mfma_f32_16x16x32_bf16 v[32:35], a[176:179], v[236:239], v[32:35]
    v_mfma_f32_16x16x32_bf16 v[36:39], a[160:163], v[240:243], v[36:39]
    global_load_dwordx4 v[144:147], v6, s[22:23] offset:3072 sc1
    v_mfma_f32_16x16x32_bf16 v[40:43], a[164:167], v[240:243], v[40:43]
    v_mfma_f32_16x16x32_bf16 v[44:47], a[168:171], v[240:243], v[44:47]
    v_mfma_f32_16x16x32_bf16 v[48:51], a[172:175], v[240:243], v[48:51]
    v_mfma_f32_16x16x32_bf16 v[52:55], a[176:179], v[240:243], v[52:55]
    global_load_dwordx4 v[148:151], v6, s[24:25] offset:3072 sc1
    v_mfma_f32_16x16x32_bf16 v[56:59], a[160:163], v[244:247], v[56:59]
    v_mfma_f32_16x16x32_bf16 v[60:63], a[164:167], v[244:247], v[60:63]
    v_mfma_f32_16x16x32_bf16 v[64:67], a[168:171], v[244:247], v[64:67]
    v_mfma_f32_16x16x32_bf16 v[68:71], a[172:175], v[244:247], v[68:71]
    global_load_dwordx4 v[152:155], v6, s[26:27] offset:3072 sc1
    v_mfma_f32_16x16x32_bf16 v[72:75], a[176:179], v[244:247], v[72:75]
    v_mfma_f32_16x16x32_bf16 v[76:79], a[160:163], v[248:251], v[76:79]
    v_mfma_f32_16x16x32_bf16 v[80:83], a[164:167], v[248:251], v[80:83]
    v_mfma_f32_16x16x32_bf16 v[84:87], a[168:171], v[248:251], v[84:87]
    v_mfma_f32_16x16x32_bf16 v[88:91], a[172:175], v[248:251], v[88:91]
    v_mfma_f32_16x16x32_bf16 v[92:95], a[176:179], v[248:251], v[92:95]
    s_waitcnt vmcnt(8)
    v_mfma_f32_16x16x32_bf16 v[16:19], a[180:183], v[108:111], v[16:19]
    v_mfma_f32_16x16x32_bf16 v[20:23], a[184:187], v[108:111], v[20:23]
    v_mfma_f32_16x16x32_bf16 v[24:27], a[188:191], v[108:111], v[24:27]
    v_mfma_f32_16x16x32_bf16 v[28:31], a[192:195], v[108:111], v[28:31]
    v_mfma_f32_16x16x32_bf16 v[32:35], a[196:199], v[108:111], v[32:35]
    v_mfma_f32_16x16x32_bf16 v[36:39], a[180:183], v[112:115], v[36:39]
    v_mfma_f32_16x16x32_bf16 v[40:43], a[184:187], v[112:115], v[40:43]
    v_mfma_f32_16x16x32_bf16 v[44:47], a[188:191], v[112:115], v[44:47]
    v_mfma_f32_16x16x32_bf16 v[48:51], a[192:195], v[112:115], v[48:51]
    v_mfma_f32_16x16x32_bf16 v[52:55], a[196:199], v[112:115], v[52:55]
    v_mfma_f32_16x16x32_bf16 v[56:59], a[180:183], v[116:119], v[56:59]
    v_mfma_f32_16x16x32_bf16 v[60:63], a[184:187], v[116:119], v[60:63]
    v_mfma_f32_16x16x32_bf16 v[64:67], a[188:191], v[116:119], v[64:67]
    v_mfma_f32_16x16x32_bf16 v[68:71], a[192:195], v[116:119], v[68:71]
    v_mfma_f32_16x16x32_bf16 v[72:75], a[196:199], v[116:119], v[72:75]
    v_mfma_f32_16x16x32_bf16 v[76:79], a[180:183], v[120:123], v[76:79]
    v_mfma_f32_16x16x32_bf16 v[80:83], a[184:187], v[120:123], v[80:83]
    v_mfma_f32_16x16x32_bf16 v[84:87], a[188:191], v[120:123], v[84:87]
    v_mfma_f32_16x16x32_bf16 v[88:91], a[192:195], v[120:123], v[88:91]
    v_mfma_f32_16x16x32_bf16 v[92:95], a[196:199], v[120:123], v[92:95]
    s_waitcnt vmcnt(4)
    v_mfma_f32_16x16x32_bf16 v[16:19], a[200:203], v[124:127], v[16:19]
    v_mfma_f32_16x16x32_bf16 v[20:23], a[204:207], v[124:127], v[20:23]
    v_mfma_f32_16x16x32_bf16 v[24:27], a[208:211], v[124:127], v[24:27]
    v_mfma_f32_16x16x32_bf16 v[28:31], a[212:215], v[124:127], v[28:31]
    v_mfma_f32_16x16x32_bf16 v[32:35], a[216:219], v[124:127], v[32:35]
    v_mfma_f32_16x16x32_bf16 v[36:39], a[200:203], v[128:131], v[36:39]
    v_mfma_f32_16x16x32_bf16 v[40:43], a[204:207], v[128:131], v[40:43]
    v_mfma_f32_16x16x32_bf16 v[44:47], a[208:211], v[128:131], v[44:47]
    v_mfma_f32_16x16x32_bf16 v[48:51], a[212:215], v[128:131], v[48:51]
    v_mfma_f32_16x16x32_bf16 v[52:55], a[216:219], v[128:131], v[52:55]
    v_mfma_f32_16x16x32_bf16 v[56:59], a[200:203], v[132:135], v[56:59]
    v_mfma_f32_16x16x32_bf16 v[60:63], a[204:207], v[132:135], v[60:63]
    v_mfma_f32_16x16x32_bf16 v[64:67], a[208:211], v[132:135], v[64:67]
    v_mfma_f32_16x16x32_bf16 v[68:71], a[212:215], v[132:135], v[68:71]
    v_mfma_f32_16x16x32_bf16 v[72:75], a[216:219], v[132:135], v[72:75]
    v_mfma_f32_16x16x32_bf16 v[76:79], a[200:203], v[136:139], v[76:79]
    v_mfma_f32_16x16x32_bf16 v[80:83], a[204:207], v[136:139], v[80:83]
    v_mfma_f32_16x16x32_bf16 v[84:87], a[208:211], v[136:139], v[84:87]
    v_mfma_f32_16x16x32_bf16 v[88:91], a[212:215], v[136:139], v[88:91]
    v_mfma_f32_16x16x32_bf16 v[92:95], a[216:219], v[136:139], v[92:95]
    s_waitcnt vmcnt(0)
    v_mfma_f32_16x16x32_bf16 v[36:39], a[220:223], v[144:147], v[36:39]
    v_mfma_f32_16x16x32_bf16 v[40:43], a[224:227], v[144:147], v[40:43]
    v_mfma_f32_16x16x32_bf16 v[44:47], a[228:231], v[144:147], v[44:47]
    v_mfma_f32_16x16x32_bf16 v[48:51], a[232:235], v[144:147], v[48:51]
    v_mfma_f32_16x16x32_bf16 v[52:55], a[236:239], v[144:147], v[52:55]
    v_mfma_f32_16x16x32_bf16 v[56:59], a[220:223], v[148:151], v[56:59]
    v_mfma_f32_16x16x32_bf16 v[60:63], a[224:227], v[148:151], v[60:63]
    v_mfma_f32_16x16x32_bf16 v[64:67], a[228:231], v[148:151], v[64:67]
    s_nop 0
    ds_write_b128 v12, v[36:39] offset:0
    v_mfma_f32_16x16x32_bf16 v[68:71], a[232:235], v[148:151], v[68:71]
    ds_write_b128 v12, v[40:43] offset:1024
    v_mfma_f32_16x16x32_bf16 v[72:75], a[236:239], v[148:151], v[72:75]
    ds_write_b128 v12, v[44:47] offset:2048
    v_mfma_f32_16x16x32_bf16 v[76:79], a[220:223], v[152:155], v[76:79]
    ds_write_b128 v12, v[48:51] offset:3072
    v_mfma_f32_16x16x32_bf16 v[80:83], a[224:227], v[152:155], v[80:83]
    ds_write_b128 v12, v[52:55] offset:4096
    v_mfma_f32_16x16x32_bf16 v[84:87], a[228:231], v[152:155], v[84:87]
    ds_write_b128 v13, v[56:59] offset:0
    v_mfma_f32_16x16x32_bf16 v[88:91], a[232:235], v[152:155], v[88:91]
    ds_write_b128 v13, v[60:63] offset:1024
    v_mfma_f32_16x16x32_bf16 v[92:95], a[236:239], v[152:155], v[92:95]
    ds_write_b128 v13, v[64:67] offset:2048
    v_mfma_f32_16x16x32_bf16 v[16:19], a[220:223], v[140:143], v[16:19]
    ds_write_b128 v13, v[68:71] offset:3072
    v_mfma_f32_16x16x32_bf16 v[20:23], a[224:227], v[140:143], v[20:23]
    ds_write_b128 v13, v[72:75] offset:4096
    v_mfma_f32_16x16x32_bf16 v[24:27], a[228:231], v[140:143], v[24:27]
    ds_write_b128 v14, v[76:79] offset:0
    v_mfma_f32_16x16x32_bf16 v[28:31], a[232:235], v[140:143], v[28:31]
    ds_write_b128 v14, v[80:83] offset:1024
    v_mfma_f32_16x16x32_bf16 v[32:35], a[236:239], v[140:143], v[32:35]
    ds_write_b128 v14, v[84:87] offset:2048
    ds_write_b128 v14, v[88:91] offset:3072
    ds_write_b128 v14, v[92:95] offset:4096
    v_lshlrev_b32 v130, 16, v96
    v_and_b32 v131, s18, v96
    v_lshlrev_b32 v132, 16, v97
    v_and_b32 v133, s18, v97
    v_lshlrev_b32 v134, 16, v98
    v_and_b32 v135, s18, v98
    v_lshlrev_b32 v136, 16, v99
    v_and_b32 v137, s18, v99
    v_lshlrev_b32 v138, 16, v100
    v_and_b32 v139, s18, v100
    v_lshlrev_b32 v140, 16, v101
    v_and_b32 v141, s18, v101
    v_lshlrev_b32 v142, 16, v102
    v_and_b32 v143, s18, v102
    v_lshlrev_b32 v144, 16, v103
    v_and_b32 v145, s18, v103
    v_lshlrev_b32 v146, 16, v104
    v_and_b32 v147, s18, v104
    v_lshlrev_b32 v148, 16, v105
    v_and_b32 v149, s18, v105
    s_waitcnt lgkmcnt(0)
    s_barrier
    ds_read_b128 v[160:163], v11 offset:0
    ds_read_b128 v[164:167], v11 offset:1024
    ds_read_b128 v[168:171], v11 offset:2048
    ds_read_b128 v[172:175], v11 offset:3072
    ds_read_b128 v[176:179], v11 offset:4096
    ds_read_b128 v[180:183], v11 offset:5120
    ds_read_b128 v[184:187], v11 offset:6144
    ds_read_b128 v[188:191], v11 offset:7168
    ds_read_b128 v[192:195], v11 offset:8192
    ds_read_b128 v[196:199], v11 offset:9216
    ds_read_b128 v[200:203], v11 offset:10240
    ds_read_b128 v[204:207], v11 offset:11264
    ds_read_b128 v[208:211], v11 offset:12288
    ds_read_b128 v[212:215], v11 offset:13312
    ds_read_b128 v[216:219], v11 offset:14336
    s_waitcnt lgkmcnt(10)
    v_pk_add_f32 v[16:17], v[16:17], v[160:161]
    v_pk_add_f32 v[18:19], v[18:19], v[162:163]
    v_pk_add_f32 v[20:21], v[20:21], v[164:165]
    v_pk_add_f32 v[22:23], v[22:23], v[166:167]
    v_pk_add_f32 v[24:25], v[24:25], v[168:169]
    v_pk_add_f32 v[26:27], v[26:27], v[170:171]
    v_pk_add_f32 v[28:29], v[28:29], v[172:173]
    v_pk_add_f32 v[30:31], v[30:31], v[174:175]
    v_pk_add_f32 v[32:33], v[32:33], v[176:177]
    v_pk_add_f32 v[34:35], v[34:35], v[178:179]
    s_waitcnt lgkmcnt(5)
    v_pk_add_f32 v[16:17], v[16:17], v[180:181]
    v_pk_add_f32 v[18:19], v[18:19], v[182:183]
    v_pk_add_f32 v[20:21], v[20:21], v[184:185]
    v_pk_add_f32 v[22:23], v[22:23], v[186:187]
    v_pk_add_f32 v[24:25], v[24:25], v[188:189]
    v_pk_add_f32 v[26:27], v[26:27], v[190:191]
    v_pk_add_f32 v[28:29], v[28:29], v[192:193]
    v_pk_add_f32 v[30:31], v[30:31], v[194:195]
    v_pk_add_f32 v[32:33], v[32:33], v[196:197]
    v_pk_add_f32 v[34:35], v[34:35], v[198:199]
    s_waitcnt lgkmcnt(0)
    v_pk_add_f32 v[16:17], v[16:17], v[200:201]
    v_pk_add_f32 v[18:19], v[18:19], v[202:203]
    v_pk_add_f32 v[20:21], v[20:21], v[204:205]
    v_pk_add_f32 v[22:23], v[22:23], v[206:207]
    v_pk_add_f32 v[24:25], v[24:25], v[208:209]
    v_pk_add_f32 v[26:27], v[26:27], v[210:211]
    v_pk_add_f32 v[28:29], v[28:29], v[212:213]
    v_pk_add_f32 v[30:31], v[30:31], v[214:215]
    v_pk_add_f32 v[32:33], v[32:33], v[216:217]
    v_pk_add_f32 v[34:35], v[34:35], v[218:219]
    v_cvt_pk_bf16_f32 v120, v16, v17
    v_cvt_pk_bf16_f32 v121, v18, v19
    v_cvt_pk_bf16_f32 v122, v20, v21
    v_cvt_pk_bf16_f32 v123, v22, v23
    v_cvt_pk_bf16_f32 v124, v24, v25
    v_cvt_pk_bf16_f32 v125, v26, v27
    v_cvt_pk_bf16_f32 v126, v28, v29
    v_cvt_pk_bf16_f32 v127, v30, v31
    v_cvt_pk_bf16_f32 v128, v32, v33
    v_cvt_pk_bf16_f32 v129, v34, v35
    v_lshlrev_b32 v16, 16, v120
    v_and_b32 v17, s18, v120
    v_lshlrev_b32 v18, 16, v121
    v_and_b32 v19, s18, v121
    v_lshlrev_b32 v20, 16, v122
    v_and_b32 v21, s18, v122
    v_lshlrev_b32 v22, 16, v123
    v_and_b32 v23, s18, v123
    v_lshlrev_b32 v24, 16, v124
    v_and_b32 v25, s18, v124
    v_lshlrev_b32 v26, 16, v125
    v_and_b32 v27, s18, v125
    v_lshlrev_b32 v28, 16, v126
    v_and_b32 v29, s18, v126
    v_lshlrev_b32 v30, 16, v127
    v_and_b32 v31, s18, v127
    v_lshlrev_b32 v32, 16, v128
    v_and_b32 v33, s18, v128
    v_lshlrev_b32 v34, 16, v129
    v_and_b32 v35, s18, v129
    v_pk_add_f32 v[16:17], v[16:17], v[130:131]
    v_pk_add_f32 v[18:19], v[18:19], v[132:133]
    v_pk_add_f32 v[20:21], v[20:21], v[134:135]
    v_pk_add_f32 v[22:23], v[22:23], v[136:137]
    v_pk_add_f32 v[24:25], v[24:25], v[138:139]
    v_pk_add_f32 v[26:27], v[26:27], v[140:141]
    v_pk_add_f32 v[28:29], v[28:29], v[142:143]
    v_pk_add_f32 v[30:31], v[30:31], v[144:145]
    v_pk_add_f32 v[32:33], v[32:33], v[146:147]
    v_pk_add_f32 v[34:35], v[34:35], v[148:149]
    v_cvt_pk_bf16_f32 v120, v16, v17
    v_cvt_pk_bf16_f32 v121, v18, v19
    v_cvt_pk_bf16_f32 v122, v20, v21
    v_cvt_pk_bf16_f32 v123, v22, v23
    v_cvt_pk_bf16_f32 v124, v24, v25
    v_cvt_pk_bf16_f32 v125, v26, v27
    v_cvt_pk_bf16_f32 v126, v28, v29
    v_cvt_pk_bf16_f32 v127, v30, v31
    v_cvt_pk_bf16_f32 v128, v32, v33
    v_cvt_pk_bf16_f32 v129, v34, v35
    global_store_dwordx2 v7, v[120:121], s[4:5] offset:0
    global_store_dwordx2 v7, v[122:123], s[4:5] offset:32
    global_store_dwordx2 v7, v[124:125], s[4:5] offset:64
    global_store_dwordx2 v7, v[126:127], s[4:5] offset:96
    global_store_dwordx2 v7, v[128:129], s[4:5] offset:128
L_F_end:
    s_endpgm
.p2align 8
.type cdna_tbl,@object
cdna_tbl:
.long 0x34003400,0x34003400,0x00003400,0x00000000,0x339c3400,0x30b43279,0x00002cf2,0x00000000
.long 0x32793400,0xacf22cf2,0x0000b279,0x00000000,0x30b43400,0xb39cacf2,0x0000b279,0x00000000
.long 0x2cf23400,0xb279b279,0x00002cf2,0x00000000,0x00003400,0x0000b400,0x00003400,0x00000000
.long 0xacf23400,0x3279b279,0x00002cf2,0x00000000,0xb0b43400,0x339cacf2,0x0000b279,0x00000000
.long 0xb2793400,0x2cf22cf2,0x0000b279,0x00000000,0xb39c3400,0xb0b43279,0x00002cf2,0x00000000
.long 0xb4003400,0xb4003400,0x00003400,0x00000000,0x00000000,0x00000000,0x00000000,0x00000000
.long 0x00000000,0x00000000,0x00000000,0x00000000,0x00000000,0x00000000,0x00000000,0x00000000
.long 0x00000000,0x00000000,0x00000000,0x00000000,0x00000000,0x00000000,0x00000000,0x00000000
.long 0x34003400,0x34003400,0x00003400,0x00000000,0xacf20000,0xb279b0b4,0x0000b39c,0x00000000
.long 0xb279b400,0x2cf2acf2,0x00003279,0x00000000,0x32790000,0x2cf2339c,0x0000b0b4,0x00000000
.long 0x2cf23400,0xb279b279,0x00002cf2,0x00000000,0xb4000000,0x34000000,0x00000000,0x00000000
.long 0x2cf2b400,0xb2793279,0x0000acf2,0x00000000,0x32790000,0x2cf2b39c,0x000030b4,0x00000000
.long 0xb2793400,0x2cf22cf2,0x0000b279,0x00000000,0xacf20000,0xb27930b4,0x0000339c,0x00000000
.long 0x3400b400,0x3400b400,0x0000b400,0x00000000,0x00000000,0x00000000,0x00000000,0x00000000
.long 0x00000000,0x00000000,0x00000000,0x00000000,0x00000000,0x00000000,0x00000000,0x00000000
.long 0x00000000,0x00000000,0x00000000,0x00000000,0x00000000,0x00000000,0x00000000,0x00000000
.long 0x34003400,0x34003400,0x00003400,0x00000000,0xb39cb400,0xb0b4b279,0x0000acf2,0x00000000
.long 0x32793400,0xacf22cf2,0x0000b279,0x00000000,0xb0b4b400,0x339c2cf2,0x00003279,0x00000000
.long 0x2cf23400,0xb279b279,0x00002cf2,0x00000000,0x0000b400,0x00003400,0x0000b400,0x00000000
.long 0xacf23400,0x3279b279,0x00002cf2,0x00000000,0x30b4b400,0xb39c2cf2,0x00003279,0x00000000
.long 0xb2793400,0x2cf22cf2,0x0000b279,0x00000000,0x339cb400,0x30b4b279,0x0000acf2,0x00000000
.long 0xb4003400,0xb4003400,0x00003400,0x00000000,0x00000000,0x00000000,0x00000000,0x00000000
.long 0x00000000,0x00000000,0x00000000,0x00000000,0x00000000,0x00000000,0x00000000,0x00000000
.long 0x00000000,0x00000000,0x00000000,0x00000000,0x00000000,0x00000000,0x00000000,0x00000000
.long 0x34003400,0x34003400,0x00003400,0x00000000,0x2cf20000,0x327930b4,0x0000339c,0x00000000
.long 0xb279b400,0x2cf2acf2,0x00003279,0x00000000,0xb2790000,0xacf2b39c,0x000030b4,0x00000000
.long 0x2cf23400,0xb279b279,0x00002cf2,0x00000000,0x34000000,0xb4000000,0x00000000,0x00000000
.long 0x2cf2b400,0xb2793279,0x0000acf2,0x00000000,0xb2790000,0xacf2339c,0x0000b0b4,0x00000000
.long 0xb2793400,0x2cf22cf2,0x0000b279,0x00000000,0x2cf20000,0x3279b0b4,0x0000b39c,0x00000000
.long 0x3400b400,0x3400b400,0x0000b400,0x00000000,0x00000000,0x00000000,0x00000000,0x00000000
.long 0x00000000,0x00000000,0x00000000,0x00000000,0x00000000,0x00000000,0x00000000,0x00000000
.long 0x00000000,0x00000000,0x00000000,0x00000000,0x00000000,0x00000000,0x00000000,0x00000000
.long 0x80008000,0x80008000,0x00008000,0x00000000,0xacf28000,0xb279b0b4,0x0000b39c,0x00000000
.long 0xb0b48000,0xb39cb39c,0x0000b0b4,0x00000000,0xb2798000,0xacf2b39c,0x000030b4,0x00000000
.long 0xb39c8000,0x30b4b0b4,0x0000339c,0x00000000,0xb4008000,0x34008000,0x00008000,0x00000000
.long 0xb39c8000,0x30b430b4,0x0000b39c,0x00000000,0xb2798000,0xacf2339c,0x0000b0b4,0x00000000
.long 0xb0b48000,0xb39c339c,0x000030b4,0x00000000,0xacf28000,0xb27930b4,0x0000339c,0x00000000
.long 0x80008000,0x80008000,0x00008000,0x00000000,0x00000000,0x00000000,0x00000000,0x00000000
.long 0x00000000,0x00000000,0x00000000,0x00000000,0x00000000,0x00000000,0x00000000,0x00000000
.long 0x00000000,0x00000000,0x00000000,0x00000000,0x00000000,0x00000000,0x00000000,0x00000000
.long 0x80008000,0x80008000,0x00008000,0x00000000,0xb39cb400,0xb0b4b279,0x0000acf2,0x00000000
.long 0x30b48000,0x339c339c,0x000030b4,0x00000000,0x30b43400,0xb39cacf2,0x0000b279,0x00000000
.long 0xb39c8000,0x30b4b0b4,0x0000339c,0x00000000,0x8000b400,0x80003400,0x0000b400,0x00000000
.long 0x339c8000,0xb0b4b0b4,0x0000339c,0x00000000,0xb0b43400,0x339cacf2,0x0000b279,0x00000000
.long 0xb0b48000,0xb39c339c,0x000030b4,0x00000000,0x339cb400,0x30b4b279,0x0000acf2,0x00000000
.long 0x80008000,0x80008000,0x00008000,0x00000000,0x00000000,0x00000000,0x00000000,0x00000000
.long 0x00000000,0x00000000,0x00000000,0x00000000,0x00000000,0x00000000,0x00000000,0x00000000
.long 0x00000000,0x00000000,0x00000000,0x00000000,0x00000000,0x00000000,0x00000000,0x00000000
.long 0x80008000,0x80008000,0x00008000,0x00000000,0x2cf28000,0x327930b4,0x0000339c,0x00000000
.long 0xb0b48000,0xb39cb39c,0x0000b0b4,0x00000000,0x32798000,0x2cf2339c,0x0000b0b4,0x00000000
.long 0xb39c8000,0x30b4b0b4,0x0000339c,0x00000000,0x34008000,0xb4008000,0x00008000,0x00000000
.long 0xb39c8000,0x30b430b4,0x0000b39c,0x00000000,0x32798000,0x2cf2b39c,0x000030b4,0x00000000
.long 0xb0b48000,0xb39c339c,0x000030b4,0x00000000,0x2cf28000,0x3279b0b4,0x0000b39c,0x00000000
.long 0x80008000,0x80008000,0x00008000,0x00000000,0x00000000,0x00000000,0x00000000,0x00000000
.long 0x00000000,0x00000000,0x00000000,0x00000000,0x00000000,0x00000000,0x00000000,0x00000000
.long 0x00000000,0x00000000,0x00000000,0x00000000,0x00000000,0x00000000,0x00000000,0x00000000
.long 0x80008000,0x80008000,0x00008000,0x00000000,0x339c3400,0x30b43279,0x00002cf2,0x00000000
.long 0x30b48000,0x339c339c,0x000030b4,0x00000000,0xb0b4b400,0x339c2cf2,0x00003279,0x00000000
.long 0xb39c8000,0x30b4b0b4,0x0000339c,0x00000000,0x80003400,0x8000b400,0x00003400,0x00000000
.long 0x339c8000,0xb0b4b0b4,0x0000339c,0x00000000,0x30b4b400,0xb39c2cf2,0x00003279,0x00000000
.long 0xb0b48000,0xb39c339c,0x000030b4,0x00000000,0xb39c3400,0xb0b43279,0x00002cf2,0x00000000
.long 0x80008000,0x80008000,0x00008000,0x00000000,0x00000000,0x00000000,0x00000000,0x00000000
.long 0x00000000,0x00000000,0x00000000,0x00000000,0x00000000,0x00000000,0x00000000,0x00000000
.long 0x00000000,0x00000000,0x00000000,0x00000000,0x00000000,0x00000000,0x00000000,0x00000000
.long 0x3f800000,0x80000000,0x3f800000,0x80000000,0x3f800000,0x80000000,0x3f7ff35e,0xbca0d6d6
.long 0x3f800000,0x80000000,0x3f7fcd79,0xbd20cee7,0x3f800000,0x80000000,0x3f7f8e56,0xbd712283
.long 0x3f800000,0x80000000,0x3f7f35f9,0xbda0af2a,0x3f800000,0x80000000,0x3f7ec46d,0xbdc8bd36
.long 0x3f800000,0x80000000,0x3f7e39bc,0xbdf0b772,0x3f800000,0x80000000,0x3f7d95f4,0xbe0c4cf7
.long 0x3f800000,0x80000000,0x3f7cd925,0xbe20305b,0x3f800000,0x80000000,0x3f7c0361,0xbe3403f1
.long 0x3f800000,0x80000000,0x3f7b14be,0xbe47c5c2,0x3f800000,0x80000000,0x3f7a0d54,0xbe5b73dc
.long 0x3f800000,0x80000000,0x3f78ed3c,0xbe6f0c4d,0x3f800000,0x80000000,0x3f77b493,0xbe814693
.long 0x3f800000,0x80000000,0x3f766377,0xbe8afa3e,0x3f800000,0x80000000,0x3f74fa0b,0xbe94a031
.long 0x3f800000,0x80000000,0x3f800000,0x80000000,0x3f7f35f9,0xbda0af2a,0x3f7ec46d,0xbdc8bd36
.long 0x3f7cd925,0xbe20305b,0x3f7b14be,0xbe47c5c2,0x3f78ed3c,0xbe6f0c4d,0x3f74fa0b,0xbe94a031
.long 0x3f737871,0xbe9e377a,0x3f6c835e,0xbec3ef15,0x3f6c835e,0xbec3ef15,0x3f61c598,0xbef15aea
.long 0x3f641901,0xbee87171,0x3f54db31,0xbf0e39da,0x3f5a46a0,0xbf05c277,0x3f45e403,0xbf226799
.long 0x3f4f1bbd,0xbf167918,0x3f3504f3,0xbf3504f3,0x3f42a9f7,0xbf26423a,0x3f226799,0xbf45e403
.long 0x3f3504f3,0xbf3504f3,0x3f0e39da,0xbf54db31,0x3f26423a,0xbf42a9f7,0x3ef15aea,0xbf61c598
.long 0x3f167918,0xbf4f1bbd,0x3ec3ef15,0xbf6c835e,0x3f05c277,0xbf5a46a0,0x3e94a031,0xbf74fa0b
.long 0x3ee87171,0xbf641901,0x3e47c5c2,0xbf7b14be,0x3ec3ef15,0xbf6c835e,0x3dc8bd36,0xbf7ec46d
.long 0x3f800000,0x80000000,0x3f800000,0x80000000,0x3f7cd925,0xbe20305b,0x3f7c0361,0xbe3403f1
.long 0x3f737871,0xbe9e377a,0x3f702d4f,0xbeb13641,0x3f641901,0xbee87171,0x3f5cdc29,0xbf0172c3
.long 0x3f4f1bbd,0xbf167918,0x3f42a9f7,0xbf26423a,0x3f3504f3,0xbf3504f3,0x3f226799,0xbf45e403
.long 0x3f167918,0xbf4f1bbd,0x3efa2c90,0xbf5f5be6,0x3ee87171,0xbf641901,0x3ea7bf25,0xbf71decf
.long 0x3e9e377a,0xbf737871,0x3e20305b,0xbf7cd925,0x3e20305b,0xbf7cd925,0xbca0d6d6,0xbf7ff35e
.long 0x00000000,0xbf800000,0xbe47c5c2,0xbf7b14be,0xbe20305b,0xbf7cd925,0xbeba9be1,0xbf6e641a
.long 0xbe9e377a,0xbf737871,0xbf05c277,0xbf5a46a0,0xbee87171,0xbf641901,0xbf2a0c73,0xbf3f5cb5
.long 0xbf167918,0xbf4f1bbd,0xbf490a88,0xbf1e7cf1,0xbf3504f3,0xbf3504f3,0xbf61c598,0xbef15aea
.long 0x3f800000,0x80000000,0x3f800000,0x80000000,0x3f78ed3c,0xbe6f0c4d,0x3f77b493,0xbe814693
.long 0x3f641901,0xbee87171,0x3f5f5be6,0xbefa2c90,0x3f42a9f7,0xbf26423a,0x3f3889dc,0xbf316e2c
.long 0x3f167918,0xbf4f1bbd,0x3f05c277,0xbf5a46a0,0x3ec3ef15,0xbf6c835e,0x3e94a031,0xbf74fa0b
.long 0x3e20305b,0xbf7cd925,0x3d20cee7,0xbf7fcd79,0xbda0af2a,0xbf7f35f9,0xbe5b73dc,0xbf7a0d54
.long 0xbe9e377a,0xbf737871,0xbee87171,0xbf641901,0xbf05c277,0xbf5a46a0,0xbf2a0c73,0xbf3f5cb5
.long 0xbf3504f3,0xbf3504f3,0xbf54db31,0xbf0e39da,0xbf5a46a0,0xbf05c277,0xbf71decf,0xbea7bf25
.long 0xbf737871,0xbe9e377a,0xbf7f35f9,0xbda0af2a,0xbf7f35f9,0xbda0af2a,0xbf7c0361,0x3e3403f1
.long 0xbf7cd925,0x3e20305b,0xbf687c12,0x3ed65a92,0xbf6c835e,0x3ec3ef15,0xbf45e403,0x3f226799
.long 0x3f800000,0x80000000,0x3f800000,0x80000000,0x3f7fcd79,0xbd20cee7,0x3f7f8e56,0xbd712283
.long 0x3f7f35f9,0xbda0af2a,0x3f7e39bc,0xbdf0b772,0x3f7e39bc,0xbdf0b772,0x3f7c0361,0xbe3403f1
.long 0x3f7cd925,0xbe20305b,0x3f78ed3c,0xbe6f0c4d,0x3f7b14be,0xbe47c5c2,0x3f74fa0b,0xbe94a031
.long 0x3f78ed3c,0xbe6f0c4d,0x3f702d4f,0xbeb13641,0x3f766377,0xbe8afa3e,0x3f6a8b4b,0xbecd2ef3
.long 0x3f737871,0xbe9e377a,0x3f641901,0xbee87171,0x3f702d4f,0xbeb13641,0x3f5cdc29,0xbf0172c3
.long 0x3f6c835e,0xbec3ef15,0x3f54db31,0xbf0e39da,0x3f687c12,0xbed65a92,0x3f4c1d35,0xbf1a82a4
.long 0x3f641901,0xbee87171,0x3f42a9f7,0xbf26423a,0x3f5f5be6,0xbefa2c90,0x3f3889dc,0xbf316e2c
.long 0x3f5a46a0,0xbf05c277,0x3f2dc5e3,0xbf3bfc8f,0x3f54db31,0xbf0e39da,0x3f226799,0xbf45e403
.long 0x3f800000,0x80000000,0x3f800000,0x80000000,0x3f7e39bc,0xbdf0b772,0x3f7d95f4,0xbe0c4cf7
.long 0x3f78ed3c,0xbe6f0c4d,0x3f766377,0xbe8afa3e,0x3f702d4f,0xbeb13641,0x3f6a8b4b,0xbecd2ef3
.long 0x3f641901,0xbee87171,0x3f5a46a0,0xbf05c277,0x3f54db31,0xbf0e39da,0x3f45e403,0xbf226799
.long 0x3f42a9f7,0xbf26423a,0x3f2dc5e3,0xbf3bfc8f,0x3f2dc5e3,0xbf3bfc8f,0x3f1260b2,0xbf5205d4
.long 0x3f167918,0xbf4f1bbd,0x3ee87171,0xbf641901,0x3efa2c90,0xbf5f5be6,0x3ea7bf25,0xbf71decf
.long 0x3ec3ef15,0xbf6c835e,0x3e47c5c2,0xbf7b14be,0x3e8afa3e,0xbf766377,0x3d712283,0xbf7f8e56
.long 0x3e20305b,0xbf7cd925,0xbda0af2a,0xbf7f35f9,0x3d20cee7,0xbf7fcd79,0xbe5b73dc,0xbf7a0d54
.long 0xbda0af2a,0xbf7f35f9,0xbeb13641,0xbf702d4f,0xbe47c5c2,0xbf7b14be,0xbef15aea,0xbf61c598
.long 0x3f800000,0x80000000,0x3f800000,0x80000000,0x3f7b14be,0xbe47c5c2,0x3f7a0d54,0xbe5b73dc
.long 0x3f6c835e,0xbec3ef15,0x3f687c12,0xbed65a92,0x3f54db31,0xbf0e39da,0x3f4c1d35,0xbf1a82a4
.long 0x3f3504f3,0xbf3504f3,0x3f26423a,0xbf42a9f7,0x3f0e39da,0xbf54db31,0x3ef15aea,0xbf61c598
.long 0x3ec3ef15,0xbf6c835e,0x3e8afa3e,0xbf766377,0x3e47c5c2,0xbf7b14be,0x3d712283,0xbf7f8e56
.long 0x00000000,0xbf800000,0xbe20305b,0xbf7cd925,0xbe47c5c2,0xbf7b14be,0xbeba9be1,0xbf6e641a
.long 0xbec3ef15,0xbf6c835e,0xbf0e39da,0xbf54db31,0xbf0e39da,0xbf54db31,0xbf3889dc,0xbf316e2c
.long 0xbf3504f3,0xbf3504f3,0xbf5a46a0,0xbf05c277,0xbf54db31,0xbf0e39da,0xbf71decf,0xbea7bf25
.long 0xbf6c835e,0xbec3ef15,0xbf7e39bc,0xbdf0b772,0xbf7b14be,0xbe47c5c2,0xbf7ec46d,0x3dc8bd36
.long 0x3f800000,0x80000000,0x3f800000,0x80000000,0x3f766377,0xbe8afa3e,0x3f74fa0b,0xbe94a031
.long 0x3f5a46a0,0xbf05c277,0x3f54db31,0xbf0e39da,0x3f2dc5e3,0xbf3bfc8f,0x3f226799,0xbf45e403
.long 0x3ee87171,0xbf641901,0x3ec3ef15,0xbf6c835e,0x3e47c5c2,0xbf7b14be,0x3dc8bd36,0xbf7ec46d
.long 0xbda0af2a,0xbf7f35f9,0xbe47c5c2,0xbf7b14be,0xbeb13641,0xbf702d4f,0xbef15aea,0xbf61c598
.long 0xbf167918,0xbf4f1bbd,0xbf3504f3,0xbf3504f3,0xbf490a88,0xbf1e7cf1,0xbf61c598,0xbef15aea
.long 0xbf6c835e,0xbec3ef15,0xbf7b14be,0xbe47c5c2,0xbf7e39bc,0xbdf0b772,0xbf7ec46d,0x3dc8bd36
.long 0xbf7cd925,0x3e20305b,0xbf6c835e,0x3ec3ef15,0xbf687c12,0x3ed65a92,0xbf45e403,0x3f226799
.long 0xbf42a9f7,0x3f26423a,0xbf0e39da,0x3f54db31,0xbf0e39da,0x3f54db31,0xbe94a031,0x3f74fa0b
.long 0x3f800000,0x80000000,0x3f800000,0x80000000,0x3f7ffcd7,0xbc20d8d2,0x3f7fe394,0xbcf13d4c
.long 0x3f7ff35e,0xbca0d6d6,0x3f7f8e56,0xbd712283,0x3f7fe394,0xbcf13d4c,0x3f7f0059,0xbdb4b86a
.long 0x3f7fcd79,0xbd20cee7,0x3f7e39bc,0xbdf0b772,0x3f7fb10f,0xbd48fb30,0x3f7d3aac,0xbe164083
.long 0x3f7f8e56,0xbd712283,0x3f7c0361,0xbe3403f1,0x3f7f654e,0xbd8ca1f2,0x3f7a9421,0xbe519f65
.long 0x3f7f35f9,0xbda0af2a,0x3f78ed3c,0xbe6f0c4d,0x3f7f0059,0xbdb4b86a,0x3f770f11,0xbe862210
.long 0x3f7ec46d,0xbdc8bd36,0x3f74fa0b,0xbe94a031,0x3f7e8238,0xbddcbd0d,0x3f72ae9e,0xbea2fd52
.long 0x3f7e39bc,0xbdf0b772,0x3f702d4f,0xbeb13641,0x3f7deafa,0xbe0255f4,0x3f6d76aa,0xbebf47d7
.long 0x3f7d95f4,0xbe0c4cf7,0x3f6a8b4b,0xbecd2ef3,0x3f7d3aac,0xbe164083,0x3f676bd8,0xbedae880
.long 0x3f800000,0x80000000,0x3f800000,0x80000000,0x3f7f0059,0xbdb4b86a,0x3f7e8238,0xbddcbd0d
.long 0x3f7c0361,0xbe3403f1,0x3f7a0d54,0xbe5b73dc,0x3f770f11,0xbe862210,0x3f72ae9e,0xbea2fd52
.long 0x3f702d4f,0xbeb13641,0x3f687c12,0xbed65a92,0x3f676bd8,0xbedae880,0x3f5b941a,0xbf039c3d
.long 0x3f5cdc29,0xbf0172c3,0x3f4c1d35,0xbf1a82a4,0x3f50935b,0xbf146eba,0x3f3a4582,0xbf2f9c32
.long 0x3f42a9f7,0xbf26423a,0x3f26423a,0xbf42a9f7,0x3f333bc6,0xbf36c9a9,0x3f104f0e,0xbf53731f
.long 0x3f226799,0xbf45e403,0x3ef15aea,0xbf61c598,0x3f104f0e,0xbf53731f,0x3ebf47d7,0xbf6d76aa
.long 0x3efa2c90,0xbf5f5be6,0x3e8afa3e,0xbf766377,0x3ed1c759,0xbf698690,0x3e2a1c3f,0xbf7c7160
.long 0x3ea7bf25,0xbf71decf,0x3d712283,0xbf7f8e56,0x3e78cfcc,0xbf7853f8,0xbd48fb30,0xbf7fb10f
.long 0x3f800000,0x80000000,0x3f800000,0x80000000,0x3f7c7160,0xbe2a1c3f,0x3f7b8f2a,0xbe3de731
.long 0x3f71decf,0xbea7bf25,0x3f6e641a,0xbeba9be1,0x3f609384,0xbef5c6c5,0x3f58f3c4,0xbf07e565
.long 0x3f490a88,0xbf1e7cf1,0x3f3bfc8f,0xbf2dc5e3,0x3f2beb4a,0xbf3daef9,0x3f187fc0,0xbf4d9f02
.long 0x3f0a04f8,0xbf579b8c,0x3edf7108,0xbf6655e7,0x3ec8917e,0xbf6b8a3d,0x3e862210,0xbf770f11
.long 0x3e6f0c4d,0xbf78ed3c,0x3da0af2a,0xbf7f35f9,0x3d8ca1f2,0xbf7f654e,0xbddcbd0d,0xbf7e8238
.long 0xbdc8bd36,0xbf7ec46d,0xbe94a031,0xbf74fa0b,0xbe862210,0xbf770f11,0xbeece91a,0xbf62f219
.long 0xbed65a92,0xbf687c12,0xbf1e7cf1,0xbf490a88,0xbf104f0e,0xbf53731f,0xbf4105b8,0xbf28296a
.long 0xbf316e2c,0xbf3889dc,0xbf5cdc29,0xbf0172c3,0xbf4d9f02,0xbf187fc0,0xbf710908,0xbeac7cd4
.long 0x3f800000,0x80000000,0x3f800000,0x80000000,0x3f7853f8,0xbe78cfcc,0x3f770f11,0xbe862210
.long 0x3f61c598,0xbef15aea,0x3f5cdc29,0xbf0172c3,0x3f3daef9,0xbf2beb4a,0x3f333bc6,0xbf36c9a9
.long 0x3f0e39da,0xbf54db31,0x3efa2c90,0xbf5f5be6,0x3eac7cd4,0xbf710908,0x3e78cfcc,0xbf7853f8
.long 0x3dc8bd36,0xbf7ec46d,0xbca0d6d6,0xbf7ff35e,0xbe164083,0xbf7d3aac,0xbe8fcefe,0xbf75b1c9
.long 0xbec3ef15,0xbf6c835e,0xbf05c277,0xbf5a46a0,0xbf187fc0,0xbf4d9f02,0xbf3a4582,0xbf2f9c32
.long 0xbf45e403,0xbf226799,0xbf61c598,0xbef15aea,0xbf676bd8,0xbedae880,0xbf79805c,0xbe6542e9
.long 0xbf7b14be,0xbe47c5c2,0xbf7fcd79,0x3d20cee7,0xbf7fb10f,0x3d48fb30,0xbf743c41,0x3e996dba
.long 0xbf74fa0b,0x3e94a031,0xbf579b8c,0x3f0a04f8,0xbf5b941a,0x3f039c3d,0xbf2beb4a,0x3f3daef9
.long 0x3f800000,0x80000000,0x3f800000,0x80000000,0x3f7fb10f,0xbd48fb30,0x3f7f654e,0xbd8ca1f2
.long 0x3f7ec46d,0xbdc8bd36,0x3f7d95f4,0xbe0c4cf7,0x3f7d3aac,0xbe164083,0x3f7a9421,0xbe519f65
.long 0x3f7b14be,0xbe47c5c2,0x3f766377,0xbe8afa3e,0x3f7853f8,0xbe78cfcc,0x3f710908,0xbeac7cd4
.long 0x3f74fa0b,0xbe94a031,0x3f6a8b4b,0xbecd2ef3,0x3f710908,0xbeac7cd4,0x3f62f219,0xbeece91a
.long 0x3f6c835e,0xbec3ef15,0x3f5a46a0,0xbf05c277,0x3f676bd8,0xbedae880,0x3f50935b,0xbf146eba
.long 0x3f61c598,0xbef15aea,0x3f45e403,0xbf226799,0x3f5b941a,0xbf039c3d,0x3f3a4582,0xbf2f9c32
.long 0x3f54db31,0xbf0e39da,0x3f2dc5e3,0xbf3bfc8f,0x3f4d9f02,0xbf187fc0,0x3f207440,0xbf4779bc
.long 0x3f45e403,0xbf226799,0x3f1260b2,0xbf5205d4,0x3f3daef9,0xbf2beb4a,0x3f039c3d,0xbf5b941a
.long 0x3f800000,0x80000000,0x3f800000,0x80000000,0x3f7deafa,0xbe0255f4,0x3f7d3aac,0xbe164083
.long 0x3f77b493,0xbe814693,0x3f74fa0b,0xbe94a031,0x3f6d76aa,0xbebf47d7,0x3f676bd8,0xbedae880
.long 0x3f5f5be6,0xbefa2c90,0x3f54db31,0xbf0e39da,0x3f4d9f02,0xbf187fc0,0x3f3daef9,0xbf2beb4a
.long 0x3f3889dc,0xbf316e2c,0x3f226799,0xbf45e403,0x3f207440,0xbf4779bc,0x3f039c3d,0xbf5b941a
.long 0x3f05c277,0xbf5a46a0,0x3ec3ef15,0xbf6c835e,0x3ed1c759,0xbf698690,0x3e78cfcc,0xbf7853f8
.long 0x3e94a031,0xbf74fa0b,0x3dc8bd36,0xbf7ec46d,0x3e2a1c3f,0xbf7c7160,0xbd48fb30,0xbf7fb10f
.long 0x3d20cee7,0xbf7fcd79,0xbe47c5c2,0xbf7b14be,0xbdb4b86a,0xbf7f0059,0xbeac7cd4,0xbf710908
.long 0xbe5b73dc,0xbf7a0d54,0xbef15aea,0xbf61c598,0xbeac7cd4,0xbf710908,0xbf187fc0,0xbf4d9f02
.long 0x3f800000,0x80000000,0x3f800000,0x80000000,0x3f7a9421,0xbe519f65,0x3f79805c,0xbe6542e9
.long 0x3f6a8b4b,0xbecd2ef3,0x3f6655e7,0xbedf7108,0x3f50935b,0xbf146eba,0x3f4779bc,0xbf207440
.long 0x3f2dc5e3,0xbf3bfc8f,0x3f1e7cf1,0xbf490a88,0x3f039c3d,0xbf5b941a,0x3edae880,0xbf676bd8
.long 0x3ea7bf25,0xbf71decf,0x3e5b73dc,0xbf7a0d54,0x3e0255f4,0xbf7deafa,0xbc20d8d2,0xbf7ffcd7
.long 0xbda0af2a,0xbf7f35f9,0xbe6f0c4d,0xbf78ed3c,0xbe8fcefe,0xbf75b1c9,0xbee3f40d,0xbf653a48
.long 0xbef15aea,0xbf61c598,0xbf226799,0xbf45e403,0xbf2456f1,0xbf444969,0xbf4a965e,0xbf1c81b9
.long 0xbf490a88,0xbf1e7cf1,0xbf687c12,0xbed65a92,0xbf653a48,0xbee3f40d,0xbf7a9421,0xbe519f65
.long 0xbf77b493,0xbe814693,0xbf7ff35e,0x3ca0d6d6,0xbf7fb10f,0xbd48fb30,0xbf7853f8,0x3e78cfcc
.long 0x3f800000,0x80000000,0x3f800000,0x80000000,0x3f75b1c9,0xbe8fcefe,0x3f743c41,0xbe996dba
.long 0x3f579b8c,0xbf0a04f8,0x3f5205d4,0xbf1260b2,0x3f28296a,0xbf4105b8,0x3f1c81b9,0xbf4a965e
.long 0x3ed65a92,0xbf687c12,0x3eb13641,0xbf702d4f,0x3e164083,0xbf7d3aac,0x3d48fb30,0xbf7fb10f
.long 0xbe0c4cf7,0xbf7d95f4,0xbe814693,0xbf77b493,0xbed1c759,0xbf698690,0xbf07e565,0xbf58f3c4
.long 0xbf26423a,0xbf42a9f7,0xbf42a9f7,0xbf26423a,0xbf563e03,0xbf0c2124,0xbf6b8a3d,0xbec8917e
.long 0xbf74fa0b,0xbe94a031,0xbf7ec46d,0xbdc8bd36,0xbf7ffcd7,0xbc20d8d2,0xbf7a9421,0x3e519f65
.long 0xbf766377,0x3e8afa3e,0xbf5f5be6,0x3efa2c90,0xbf58f3c4,0x3f07e565,0xbf2f9c32,0x3f3a4582
.long 0xbf2a0c73,0x3f3f5cb5,0xbedf7108,0x3f6655e7,0xbedae880,0x3f676bd8,0xbe164083,0x3f7d3aac
.long 0x00003000,0x00003000,0x00003000,0x00003000,0x00003000,0x2a1f2f64,0x2da82da8,0x2f642a1f
.long 0x00003000,0x2da82da8,0x30000000,0x2da8ada8,0x00003000,0x2f642a1f,0x2da8ada8,0xaa1faf64
.long 0x00003000,0x30000000,0x0000b000,0xb0000000,0x00003000,0x2f64aa1f,0xada8ada8,0xaa1f2f64
.long 0x00003000,0x2da8ada8,0xb0000000,0x2da82da8,0x00003000,0x2a1faf64,0xada82da8,0x2f64aa1f
.long 0x00003000,0x0000b000,0x00003000,0x0000b000,0x00003000,0xaa1faf64,0x2da82da8,0xaf64aa1f
.long 0x00003000,0xada8ada8,0x30000000,0xada82da8,0x00003000,0xaf64aa1f,0x2da8ada8,0x2a1f2f64
.long 0x00003000,0xb0000000,0x0000b000,0x30000000,0x00003000,0xaf642a1f,0xada8ada8,0x2a1faf64
.long 0x00003000,0xada82da8,0xb0000000,0xada8ada8,0x00003000,0xaa1f2f64,0xada82da8,0xaf642a1f
.long 0x00003000,0x00003000,0x00003000,0x00003000,0x30000000,0x2f64aa1f,0x2da8ada8,0x2a1faf64
.long 0x0000b000,0xada8ada8,0xb0000000,0xada82da8,0xb0000000,0xaa1f2f64,0x2da82da8,0x2f64aa1f
.long 0x00003000,0x30000000,0x0000b000,0xb0000000,0x30000000,0xaa1faf64,0xada82da8,0x2f642a1f
.long 0x0000b000,0xada82da8,0x30000000,0xada8ada8,0xb0000000,0x2f642a1f,0xada8ada8,0x2a1f2f64
.long 0x00003000,0x0000b000,0x00003000,0x0000b000,0x30000000,0xaf642a1f,0x2da8ada8,0xaa1f2f64
.long 0x0000b000,0x2da82da8,0xb0000000,0x2da8ada8,0xb0000000,0x2a1faf64,0x2da82da8,0xaf642a1f
.long 0x00003000,0xb0000000,0x0000b000,0x30000000,0x30000000,0x2a1f2f64,0xada82da8,0xaf64aa1f
.long 0x0000b000,0x2da8ada8,0x30000000,0x2da82da8,0xb0000000,0xaf64aa1f,0xada8ada8,0xaa1faf64
.long 0x00003000,0x00003000,0x00003000,0x00003000,0x0000b000,0xaa1faf64,0xada8ada8,0xaf64aa1f
.long 0x00003000,0x2da82da8,0x30000000,0x2da8ada8,0x0000b000,0xaf64aa1f,0xada82da8,0x2a1f2f64
.long 0x00003000,0x30000000,0x0000b000,0xb0000000,0x0000b000,0xaf642a1f,0x2da82da8,0x2a1faf64
.long 0x00003000,0x2da8ada8,0xb0000000,0x2da82da8,0x0000b000,0xaa1f2f64,0x2da8ada8,0xaf642a1f
.long 0x00003000,0x0000b000,0x00003000,0x0000b000,0x0000b000,0x2a1f2f64,0xada8ada8,0x2f642a1f
.long 0x00003000,0xada8ada8,0x30000000,0xada82da8,0x0000b000,0x2f642a1f,0xada82da8,0xaa1faf64
.long 0x00003000,0xb0000000,0x0000b000,0x30000000,0x0000b000,0x2f64aa1f,0x2da82da8,0xaa1f2f64
.long 0x00003000,0xada82da8,0xb0000000,0xada8ada8,0x0000b000,0x2a1faf64,0x2da8ada8,0x2f64aa1f
.long 0x00003000,0x00003000,0x00003000,0x00003000,0xb0000000,0xaf642a1f,0xada82da8,0xaa1f2f64
.long 0x0000b000,0xada8ada8,0xb0000000,0xada82da8,0x30000000,0x2a1faf64,0xada8ada8,0xaf642a1f
.long 0x00003000,0x30000000,0x0000b000,0xb0000000,0xb0000000,0x2a1f2f64,0x2da8ada8,0xaf64aa1f
.long 0x0000b000,0xada82da8,0x30000000,0xada8ada8,0x30000000,0xaf64aa1f,0x2da82da8,0xaa1faf64
.long 0x00003000,0x0000b000,0x00003000,0x0000b000,0xb0000000,0x2f64aa1f,0xada82da8,0x2a1faf64
.long 0x0000b000,0x2da82da8,0xb0000000,0x2da8ada8,0x30000000,0xaa1f2f64,0xada8ada8,0x2f64aa1f
.long 0x00003000,0xb0000000,0x0000b000,0x30000000,0xb0000000,0xaa1faf64,0x2da8ada8,0x2f642a1f
.long 0x0000b000,0x2da8ada8,0x30000000,0x2da82da8,0x30000000,0x2f642a1f,0x2da82da8,0x2a1f2f64
.long 0x00003000,0x00003000,0x00003000,0x00003000,0x263e2fd9,0x2c722ea7,0x2ea72c72,0x2fd9263e
.long 0x2a1f2f64,0x2f642a1f,0x2f64aa1f,0x2a1faf64,0x2c722ea7,0x2fd9a63e,0x263eafd9,0xaea7ac72
.long 0x2da82da8,0x2da8ada8,0xada8ada8,0xada82da8,0x2ea72c72,0x263eafd9,0xafd9263e,0x2c722ea7
.long 0x2f642a1f,0xaa1faf64,0xaa1f2f64,0x2f64aa1f,0x2fd9263e,0xaea7ac72,0x2c722ea7,0xa63eafd9
.long 0x30000000,0xb0000000,0x30000000,0xb0000000,0x2fd9a63e,0xaea72c72,0x2c72aea7,0xa63e2fd9
.long 0x2f64aa1f,0xaa1f2f64,0xaa1faf64,0x2f642a1f,0x2ea7ac72,0x263e2fd9,0xafd9a63e,0x2c72aea7
.long 0x2da8ada8,0x2da82da8,0xada82da8,0xada8ada8,0x2c72aea7,0x2fd9263e,0x263e2fd9,0xaea72c72
.long 0x2a1faf64,0x2f64aa1f,0x2f642a1f,0x2a1f2f64,0x263eafd9,0x2c72aea7,0x2ea7ac72,0x2fd9a63e
.long 0x00003000,0x00003000,0x00003000,0x00003000,0x2fd9a63e,0x2ea7ac72,0x2c72aea7,0x263eafd9
.long 0xaa1faf64,0xaf64aa1f,0xaf642a1f,0xaa1f2f64,0xaea72c72,0x263e2fd9,0x2fd9263e,0x2c72aea7
.long 0x2da82da8,0x2da8ada8,0xada8ada8,0xada82da8,0x2c72aea7,0xafd9a63e,0x263e2fd9,0x2ea7ac72
.long 0xaf64aa1f,0x2a1f2f64,0x2a1faf64,0xaf642a1f,0xa63e2fd9,0x2c72aea7,0xaea72c72,0x2fd9a63e
.long 0x30000000,0xb0000000,0x30000000,0xb0000000,0xa63eafd9,0x2c722ea7,0xaea7ac72,0x2fd9263e
.long 0xaf642a1f,0x2a1faf64,0x2a1f2f64,0xaf64aa1f,0x2c722ea7,0xafd9263e,0x263eafd9,0x2ea72c72
.long 0x2da8ada8,0x2da82da8,0xada82da8,0xada8ada8,0xaea7ac72,0x263eafd9,0x2fd9a63e,0x2c722ea7
.long 0xaa1f2f64,0xaf642a1f,0xaf64aa1f,0xaa1faf64,0x2fd9263e,0x2ea72c72,0x2c722ea7,0x263e2fd9
.long 0x00003000,0x00003000,0x00003000,0x00003000,0xa63eafd9,0xac72aea7,0xaea7ac72,0xafd9a63e
.long 0x2a1f2f64,0x2f642a1f,0x2f64aa1f,0x2a1faf64,0xac72aea7,0xafd9263e,0xa63e2fd9,0x2ea72c72
.long 0x2da82da8,0x2da8ada8,0xada8ada8,0xada82da8,0xaea7ac72,0xa63e2fd9,0x2fd9a63e,0xac72aea7
.long 0x2f642a1f,0xaa1faf64,0xaa1f2f64,0x2f64aa1f,0xafd9a63e,0x2ea72c72,0xac72aea7,0x263e2fd9
.long 0x30000000,0xb0000000,0x30000000,0xb0000000,0xafd9263e,0x2ea7ac72,0xac722ea7,0x263eafd9
.long 0x2f64aa1f,0xaa1f2f64,0xaa1faf64,0x2f642a1f,0xaea72c72,0xa63eafd9,0x2fd9263e,0xac722ea7
.long 0x2da8ada8,0x2da82da8,0xada82da8,0xada8ada8,0xac722ea7,0xafd9a63e,0xa63eafd9,0x2ea7ac72
.long 0x2a1faf64,0x2f64aa1f,0x2f642a1f,0x2a1f2f64,0xa63e2fd9,0xac722ea7,0xaea72c72,0xafd9263e
.long 0x00003000,0x00003000,0x00003000,0x00003000,0xafd9263e,0xaea72c72,0xac722ea7,0xa63e2fd9
.long 0xaa1faf64,0xaf64aa1f,0xaf642a1f,0xaa1f2f64,0x2ea7ac72,0xa63eafd9,0xafd9a63e,0xac722ea7
.long 0x2da82da8,0x2da8ada8,0xada8ada8,0xada82da8,0xac722ea7,0x2fd9263e,0xa63eafd9,0xaea72c72
.long 0xaf64aa1f,0x2a1f2f64,0x2a1faf64,0xaf642a1f,0x263eafd9,0xac722ea7,0x2ea7ac72,0xafd9263e
.long 0x30000000,0xb0000000,0x30000000,0xb0000000,0x263e2fd9,0xac72aea7,0x2ea72c72,0xafd9a63e
.long 0xaf642a1f,0x2a1faf64,0x2a1f2f64,0xaf64aa1f,0xac72aea7,0x2fd9a63e,0xa63e2fd9,0xaea7ac72
.long 0x2da8ada8,0x2da82da8,0xada82da8,0xada8ada8,0x2ea72c72,0xa63e2fd9,0xafd9263e,0xac72aea7
.long 0xaa1f2f64,0xaf642a1f,0xaf64aa1f,0xaa1faf64,0xafd9a63e,0xaea7ac72,0xac72aea7,0xa63eafd9
.long 0x00003000,0x00003000,0x00003000,0x00003000,0x00003000,0x2a1f2f64,0x2da82da8,0x2f642a1f
.long 0x00003000,0x2da82da8,0x30000000,0x2da8ada8,0x00003000,0x2f642a1f,0x2da8ada8,0xaa1faf64
.long 0x00003000,0x30000000,0x0000b000,0xb0000000,0x00003000,0x2f64aa1f,0xada8ada8,0xaa1f2f64
.long 0x00003000,0x2da8ada8,0xb0000000,0x2da82da8,0x00003000,0x2a1faf64,0xada82da8,0x2f64aa1f
.long 0x00003000,0x0000b000,0x00003000,0x0000b000,0x00003000,0xaa1faf64,0x2da82da8,0xaf64aa1f
.long 0x00003000,0xada8ada8,0x30000000,0xada82da8,0x00003000,0xaf64aa1f,0x2da8ada8,0x2a1f2f64
.long 0x00003000,0xb0000000,0x0000b000,0x30000000,0x00003000,0xaf642a1f,0xada8ada8,0x2a1faf64
.long 0x00003000,0xada82da8,0xb0000000,0xada8ada8,0x00003000,0xaa1f2f64,0xada82da8,0xaf642a1f
.long 0x00003000,0x00003000,0x00003000,0x00003000,0x30000000,0x2f64aa1f,0x2da8ada8,0x2a1faf64
.long 0x0000b000,0xada8ada8,0xb0000000,0xada82da8,0xb0000000,0xaa1f2f64,0x2da82da8,0x2f64aa1f
.long 0x00003000,0x30000000,0x0000b000,0xb0000000,0x30000000,0xaa1faf64,0xada82da8,0x2f642a1f
.long 0x0000b000,0xada82da8,0x30000000,0xada8ada8,0xb0000000,0x2f642a1f,0xada8ada8,0x2a1f2f64
.long 0x00003000,0x0000b000,0x00003000,0x0000b000,0x30000000,0xaf642a1f,0x2da8ada8,0xaa1f2f64
.long 0x0000b000,0x2da82da8,0xb0000000,0x2da8ada8,0xb0000000,0x2a1faf64,0x2da82da8,0xaf642a1f
.long 0x00003000,0xb0000000,0x0000b000,0x30000000,0x30000000,0x2a1f2f64,0xada82da8,0xaf64aa1f
.long 0x0000b000,0x2da8ada8,0x30000000,0x2da82da8,0xb0000000,0xaf64aa1f,0xada8ada8,0xaa1faf64
.long 0x00003000,0x00003000,0x00003000,0x00003000,0x0000b000,0xaa1faf64,0xada8ada8,0xaf64aa1f
.long 0x00003000,0x2da82da8,0x30000000,0x2da8ada8,0x0000b000,0xaf64aa1f,0xada82da8,0x2a1f2f64
.long 0x00003000,0x30000000,0x0000b000,0xb0000000,0x0000b000,0xaf642a1f,0x2da82da8,0x2a1faf64
.long 0x00003000,0x2da8ada8,0xb0000000,0x2da82da8,0x0000b000,0xaa1f2f64,0x2da8ada8,0xaf642a1f
.long 0x00003000,0x0000b000,0x00003000,0x0000b000,0x0000b000,0x2a1f2f64,0xada8ada8,0x2f642a1f
.long 0x00003000,0xada8ada8,0x30000000,0xada82da8,0x0000b000,0x2f642a1f,0xada82da8,0xaa1faf64
.long 0x00003000,0xb0000000,0x0000b000,0x30000000,0x0000b000,0x2f64aa1f,0x2da82da8,0xaa1f2f64
.long 0x00003000,0xada82da8,0xb0000000,0xada8ada8,0x0000b000,0x2a1faf64,0x2da8ada8,0x2f64aa1f
.long 0x00003000,0x00003000,0x00003000,0x00003000,0xb0000000,0xaf642a1f,0xada82da8,0xaa1f2f64
.long 0x0000b000,0xada8ada8,0xb0000000,0xada82da8,0x30000000,0x2a1faf64,0xada8ada8,0xaf642a1f
.long 0x00003000,0x30000000,0x0000b000,0xb0000000,0xb0000000,0x2a1f2f64,0x2da8ada8,0xaf64aa1f
.long 0x0000b000,0xada82da8,0x30000000,0xada8ada8,0x30000000,0xaf64aa1f,0x2da82da8,0xaa1faf64
.long 0x00003000,0x0000b000,0x00003000,0x0000b000,0xb0000000,0x2f64aa1f,0xada82da8,0x2a1faf64
.long 0x0000b000,0x2da82da8,0xb0000000,0x2da8ada8,0x30000000,0xaa1f2f64,0xada8ada8,0x2f64aa1f
.long 0x00003000,0xb0000000,0x0000b000,0x30000000,0xb0000000,0xaa1faf64,0x2da8ada8,0x2f642a1f
.long 0x0000b000,0x2da8ada8,0x30000000,0x2da82da8,0x30000000,0x2f642a1f,0x2da82da8,0x2a1f2f64
.long 0x0000b000,0x0000b000,0x0000b000,0x0000b000,0xa63eafd9,0xac72aea7,0xaea7ac72,0xafd9a63e
.long 0xaa1faf64,0xaf64aa1f,0xaf642a1f,0xaa1f2f64,0xac72aea7,0xafd9263e,0xa63e2fd9,0x2ea72c72
.long 0xada8ada8,0xada82da8,0x2da82da8,0x2da8ada8,0xaea7ac72,0xa63e2fd9,0x2fd9a63e,0xac72aea7
.long 0xaf64aa1f,0x2a1f2f64,0x2a1faf64,0xaf642a1f,0xafd9a63e,0x2ea72c72,0xac72aea7,0x263e2fd9
.long 0xb0000000,0x30000000,0xb0000000,0x30000000,0xafd9263e,0x2ea7ac72,0xac722ea7,0x263eafd9
.long 0xaf642a1f,0x2a1faf64,0x2a1f2f64,0xaf64aa1f,0xaea72c72,0xa63eafd9,0x2fd9263e,0xac722ea7
.long 0xada82da8,0xada8ada8,0x2da8ada8,0x2da82da8,0xac722ea7,0xafd9a63e,0xa63eafd9,0x2ea7ac72
.long 0xaa1f2f64,0xaf642a1f,0xaf64aa1f,0xaa1faf64,0xa63e2fd9,0xac722ea7,0xaea72c72,0xafd9263e
.long 0x0000b000,0x0000b000,0x0000b000,0x0000b000,0xafd9263e,0xaea72c72,0xac722ea7,0xa63e2fd9
.long 0x2a1f2f64,0x2f642a1f,0x2f64aa1f,0x2a1faf64,0x2ea7ac72,0xa63eafd9,0xafd9a63e,0xac722ea7
.long 0xada8ada8,0xada82da8,0x2da82da8,0x2da8ada8,0xac722ea7,0x2fd9263e,0xa63eafd9,0xaea72c72
.long 0x2f642a1f,0xaa1faf64,0xaa1f2f64,0x2f64aa1f,0x263eafd9,0xac722ea7,0x2ea7ac72,0xafd9263e
.long 0xb0000000,0x30000000,0xb0000000,0x30000000,0x263e2fd9,0xac72aea7,0x2ea72c72,0xafd9a63e
.long 0x2f64aa1f,0xaa1f2f64,0xaa1faf64,0x2f642a1f,0xac72aea7,0x2fd9a63e,0xa63e2fd9,0xaea7ac72
.long 0xada82da8,0xada8ada8,0x2da8ada8,0x2da82da8,0x2ea72c72,0xa63e2fd9,0xafd9263e,0xac72aea7
.long 0x2a1faf64,0x2f64aa1f,0x2f642a1f,0x2a1f2f64,0xafd9a63e,0xaea7ac72,0xac72aea7,0xa63eafd9
.long 0x0000b000,0x0000b000,0x0000b000,0x0000b000,0x263e2fd9,0x2c722ea7,0x2ea72c72,0x2fd9263e
.long 0xaa1faf64,0xaf64aa1f,0xaf642a1f,0xaa1f2f64,0x2c722ea7,0x2fd9a63e,0x263eafd9,0xaea7ac72
.long 0xada8ada8,0xada82da8,0x2da82da8,0x2da8ada8,0x2ea72c72,0x263eafd9,0xafd9263e,0x2c722ea7
.long 0xaf64aa1f,0x2a1f2f64,0x2a1faf64,0xaf642a1f,0x2fd9263e,0xaea7ac72,0x2c722ea7,0xa63eafd9
.long 0xb0000000,0x30000000,0xb0000000,0x30000000,0x2fd9a63e,0xaea72c72,0x2c72aea7,0xa63e2fd9
.long 0xaf642a1f,0x2a1faf64,0x2a1f2f64,0xaf64aa1f,0x2ea7ac72,0x263e2fd9,0xafd9a63e,0x2c72aea7
.long 0xada82da8,0xada8ada8,0x2da8ada8,0x2da82da8,0x2c72aea7,0x2fd9263e,0x263e2fd9,0xaea72c72
.long 0xaa1f2f64,0xaf642a1f,0xaf64aa1f,0xaa1faf64,0x263eafd9,0x2c72aea7,0x2ea7ac72,0x2fd9a63e
.long 0x0000b000,0x0000b000,0x0000b000,0x0000b000,0x2fd9a63e,0x2ea7ac72,0x2c72aea7,0x263eafd9
.long 0x2a1f2f64,0x2f642a1f,0x2f64aa1f,0x2a1faf64,0xaea72c72,0x263e2fd9,0x2fd9263e,0x2c72aea7
.long 0xada8ada8,0xada82da8,0x2da82da8,0x2da8ada8,0x2c72aea7,0xafd9a63e,0x263e2fd9,0x2ea7ac72
.long 0x2f642a1f,0xaa1faf64,0xaa1f2f64,0x2f64aa1f,0xa63e2fd9,0x2c72aea7,0xaea72c72,0x2fd9a63e
.long 0xb0000000,0x30000000,0xb0000000,0x30000000,0xa63eafd9,0x2c722ea7,0xaea7ac72,0x2fd9263e
.long 0x2f64aa1f,0xaa1f2f64,0xaa1faf64,0x2f642a1f,0x2c722ea7,0xafd9263e,0x263eafd9,0x2ea72c72
.long 0xada82da8,0xada8ada8,0x2da8ada8,0x2da82da8,0xaea7ac72,0x263eafd9,0x2fd9a63e,0x2c722ea7
.long 0x2a1faf64,0x2f64aa1f,0x2f642a1f,0x2a1f2f64,0x2fd9263e,0x2ea72c72,0x2c722ea7,0x263e2fd9
.long 0x00003000,0x00003000,0x00003000,0x00003000,0x00003000,0x22462ff6,0x263e2fd9,0x28a52fa8
.long 0x00003000,0x263e2fd9,0x2a1f2f64,0x2c722ea7,0x00003000,0x28a52fa8,0x2c722ea7,0x2e2f2d13
.long 0x00003000,0x2a1f2f64,0x2da82da8,0x2f642a1f,0x00003000,0x2b8b2f0e,0x2ea72c72,0x2ff62246
.long 0x00003000,0x2c722ea7,0x2f642a1f,0x2fd9a63e,0x00003000,0x2d132e2f,0x2fd9263e,0x2f0eab8b
.long 0x00003000,0x2da82da8,0x30000000,0x2da8ada8,0x00003000,0x2e2f2d13,0x2fd9a63e,0x2b8baf0e
.long 0x00003000,0x2ea72c72,0x2f64aa1f,0x263eafd9,0x00003000,0x2f0e2b8b,0x2ea7ac72,0xa246aff6
.long 0x00003000,0x2f642a1f,0x2da8ada8,0xaa1faf64,0x00003000,0x2fa828a5,0x2c72aea7,0xad13ae2f
.long 0x00003000,0x2fd9263e,0x2a1faf64,0xaea7ac72,0x00003000,0x2ff62246,0x263eafd9,0xafa8a8a5
.long 0x00003000,0x00003000,0x00003000,0x00003000,0x2a1f2f64,0x2b8b2f0e,0x2c722ea7,0x2d132e2f
.long 0x2da82da8,0x2ea72c72,0x2f642a1f,0x2fd9263e,0x2f642a1f,0x2ff62246,0x2fd9a63e,0x2f0eab8b
.long 0x30000000,0x2f64aa1f,0x2da8ada8,0x2a1faf64,0x2f64aa1f,0x2d13ae2f,0x263eafd9,0xa8a5afa8
.long 0x2da8ada8,0x263eafd9,0xaa1faf64,0xaea7ac72,0x2a1faf64,0xa8a5afa8,0xaea7ac72,0xaff62246
.long 0x0000b000,0xada8ada8,0xb0000000,0xada82da8,0xaa1faf64,0xafa8a8a5,0xaea72c72,0xa2462ff6
.long 0xada8ada8,0xafd9263e,0xaa1f2f64,0x2c722ea7,0xaf64aa1f,0xae2f2d13,0x263e2fd9,0x2fa828a5
.long 0xb0000000,0xaa1f2f64,0x2da82da8,0x2f64aa1f,0xaf642a1f,0x22462ff6,0x2fd9263e,0x2b8baf0e
.long 0xada82da8,0x2c722ea7,0x2f64aa1f,0xa63eafd9,0xaa1f2f64,0x2f0e2b8b,0x2c72aea7,0xae2fad13
.long 0x00003000,0x00003000,0x00003000,0x00003000,0x2da82da8,0x2e2f2d13,0x2ea72c72,0x2f0e2b8b
.long 0x30000000,0x2fd9a63e,0x2f64aa1f,0x2ea7ac72,0x2da8ada8,0x2b8baf0e,0x263eafd9,0xa246aff6
.long 0x0000b000,0xaa1faf64,0xada8ada8,0xaf64aa1f,0xada8ada8,0xafa8a8a5,0xafd9263e,0xae2f2d13
.long 0xb0000000,0xaea72c72,0xaa1f2f64,0x263e2fd9,0xada82da8,0xa2462ff6,0x2c722ea7,0x2fa828a5
.long 0x00003000,0x2da82da8,0x30000000,0x2da8ada8,0x2da82da8,0x2ff6a246,0x2c72aea7,0xa8a5afa8
.long 0x30000000,0x2c72aea7,0xaa1faf64,0xafd9a63e,0x2da8ada8,0xa8a5afa8,0xafd9a63e,0xad132e2f
.long 0x0000b000,0xaf64aa1f,0xada82da8,0x2a1f2f64,0xada8ada8,0xaf0e2b8b,0x263e2fd9,0x2ff62246
.long 0xb0000000,0xa63e2fd9,0x2f642a1f,0x2c72aea7,0xada82da8,0x2d132e2f,0x2ea7ac72,0xab8baf0e
.long 0x00003000,0x00003000,0x00003000,0x00003000,0x2f642a1f,0x2fa828a5,0x2fd9263e,0x2ff62246
.long 0x2da8ada8,0x2c72aea7,0x2a1faf64,0x263eafd9,0xaa1faf64,0xad13ae2f,0xaea7ac72,0xafa8a8a5
.long 0xb0000000,0xaf642a1f,0xada82da8,0xaa1f2f64,0xaa1f2f64,0x22462ff6,0x2c722ea7,0x2f0e2b8b
.long 0x2da82da8,0x2fd9263e,0x2f64aa1f,0x2c72aea7,0x2f64aa1f,0x2b8baf0e,0xa63eafd9,0xae2fad13
.long 0x0000b000,0xada8ada8,0xb0000000,0xada82da8,0xaf64aa1f,0xaf0e2b8b,0xa63e2fd9,0x2d132e2f
.long 0xada82da8,0x263e2fd9,0x2f642a1f,0x2ea7ac72,0x2a1f2f64,0x2ff62246,0x2c72aea7,0xab8baf0e
.long 0x30000000,0x2a1faf64,0xada8ada8,0xaf642a1f,0x2a1faf64,0xae2fad13,0xaea72c72,0x28a52fa8
.long 0xada8ada8,0xaea72c72,0x2a1f2f64,0x2fd9a63e,0xaf642a1f,0x28a52fa8,0x2fd9a63e,0xa246aff6
.long 0x00003000,0x00003000,0x00003000,0x00003000,0x30000000,0x2ff6a246,0x2fd9a63e,0x2fa8a8a5
.long 0x0000b000,0xa63eafd9,0xaa1faf64,0xac72aea7,0xb0000000,0xafa828a5,0xaea72c72,0xad132e2f
.long 0x00003000,0x2a1f2f64,0x2da82da8,0x2f642a1f,0x30000000,0x2f0eab8b,0x2c72aea7,0x2246aff6
.long 0x0000b000,0xac72aea7,0xaf64aa1f,0xafd9263e,0xb0000000,0xae2f2d13,0xa63e2fd9,0x2b8b2f0e
.long 0x00003000,0x2da82da8,0x30000000,0x2da8ada8,0x30000000,0x2d13ae2f,0xa63eafd9,0xaf0eab8b
.long 0x0000b000,0xaea7ac72,0xaf642a1f,0xa63e2fd9,0xb0000000,0xab8b2f0e,0x2c722ea7,0x2ff6a246
.long 0x00003000,0x2f642a1f,0x2da8ada8,0xaa1faf64,0x30000000,0x28a5afa8,0xaea7ac72,0xae2f2d13
.long 0x0000b000,0xafd9a63e,0xaa1f2f64,0x2ea72c72,0xb0000000,0xa2462ff6,0x2fd9263e,0x28a5afa8
.long 0x00003000,0x00003000,0x00003000,0x00003000,0x2f64aa1f,0x2f0eab8b,0x2ea7ac72,0x2e2fad13
.long 0xada8ada8,0xaea7ac72,0xaf64aa1f,0xafd9a63e,0xaa1f2f64,0xa2462ff6,0x263e2fd9,0x2b8b2f0e
.long 0x30000000,0x2f64aa1f,0x2da8ada8,0x2a1faf64,0xaa1faf64,0xae2fad13,0xafd9a63e,0xafa828a5
.long 0xada82da8,0xa63e2fd9,0x2a1f2f64,0x2ea72c72,0x2f642a1f,0x2fa8a8a5,0x2c72aea7,0xa246aff6
.long 0x0000b000,0xada8ada8,0xb0000000,0xada82da8,0xaf642a1f,0xa8a52fa8,0x2c722ea7,0x2ff62246
.long 0x2da82da8,0x2fd9a63e,0x2a1faf64,0xac72aea7,0x2a1faf64,0xad13ae2f,0xafd9263e,0xa8a52fa8
.long 0xb0000000,0xaa1f2f64,0x2da82da8,0x2f64aa1f,0x2a1f2f64,0x2ff6a246,0x263eafd9,0xaf0eab8b
.long 0x2da8ada8,0xac72aea7,0xaf642a1f,0x263e2fd9,0xaf64aa1f,0xab8b2f0e,0x2ea72c72,0x2d13ae2f
.long 0x00003000,0x00003000,0x00003000,0x00003000,0x2da8ada8,0x2d13ae2f,0x2c72aea7,0x2b8baf0e
.long 0xb0000000,0xafd9263e,0xaf642a1f,0xaea72c72,0x2da82da8,0x2f0e2b8b,0x2fd9263e,0x2ff6a246
.long 0x0000b000,0xaa1faf64,0xada8ada8,0xaf64aa1f,0xada82da8,0xa8a52fa8,0x263e2fd9,0x2d132e2f
.long 0x30000000,0x2ea7ac72,0x2a1faf64,0xa63eafd9,0xada8ada8,0xaff6a246,0xaea72c72,0xa8a52fa8
.long 0x00003000,0x2da82da8,0x30000000,0x2da8ada8,0x2da8ada8,0xa246aff6,0xaea7ac72,0xafa828a5
.long 0xb0000000,0xac722ea7,0x2a1f2f64,0x2fd9263e,0x2da82da8,0x2fa8a8a5,0x263eafd9,0xae2fad13
.long 0x0000b000,0xaf64aa1f,0xada82da8,0x2a1f2f64,0xada82da8,0x2b8b2f0e,0x2fd9a63e,0x2246aff6
.long 0x30000000,0x263eafd9,0xaf64aa1f,0xac722ea7,0xada8ada8,0xae2f2d13,0x2c722ea7,0x2f0eab8b
.long 0x00003000,0x00003000,0x00003000,0x00003000,0x2a1faf64,0x28a5afa8,0x263eafd9,0x2246aff6
.long 0xada82da8,0xac722ea7,0xaa1f2f64,0xa63e2fd9,0x2f64aa1f,0x2e2fad13,0x2c72aea7,0x28a5afa8
.long 0xb0000000,0xaf642a1f,0xada82da8,0xaa1f2f64,0x2f642a1f,0x2ff6a246,0x2ea7ac72,0x2b8baf0e
.long 0xada8ada8,0xafd9a63e,0xaf642a1f,0xac722ea7,0x2a1f2f64,0x2f0e2b8b,0x2fd9a63e,0x2d13ae2f
.long 0x0000b000,0xada8ada8,0xb0000000,0xada82da8,0xaa1f2f64,0x2b8b2f0e,0x2fd9263e,0x2e2fad13
.long 0x2da8ada8,0xa63eafd9,0xaf64aa1f,0xaea72c72,0xaf642a1f,0xa2462ff6,0x2ea72c72,0x2f0eab8b
.long 0x30000000,0x2a1faf64,0xada8ada8,0xaf642a1f,0xaf64aa1f,0xad132e2f,0x2c722ea7,0x2fa8a8a5
.long 0x2da82da8,0x2ea7ac72,0xaa1faf64,0xafd9263e,0xaa1faf64,0xafa828a5,0x263e2fd9,0x2ff6a246
.long 0x00003000,0x00003000,0x00003000,0x00003000,0x0000b000,0xa246aff6,0xa63eafd9,0xa8a5afa8
.long 0x00003000,0x263e2fd9,0x2a1f2f64,0x2c722ea7,0x0000b000,0xa8a5afa8,0xac72aea7,0xae2fad13
.long 0x00003000,0x2a1f2f64,0x2da82da8,0x2f642a1f,0x0000b000,0xab8baf0e,0xaea7ac72,0xaff6a246
.long 0x00003000,0x2c722ea7,0x2f642a1f,0x2fd9a63e,0x0000b000,0xad13ae2f,0xafd9a63e,0xaf0e2b8b
.long 0x00003000,0x2da82da8,0x30000000,0x2da8ada8,0x0000b000,0xae2fad13,0xafd9263e,0xab8b2f0e
.long 0x00003000,0x2ea72c72,0x2f64aa1f,0x263eafd9,0x0000b000,0xaf0eab8b,0xaea72c72,0x22462ff6
.long 0x00003000,0x2f642a1f,0x2da8ada8,0xaa1faf64,0x0000b000,0xafa8a8a5,0xac722ea7,0x2d132e2f
.long 0x00003000,0x2fd9263e,0x2a1faf64,0xaea7ac72,0x0000b000,0xaff6a246,0xa63e2fd9,0x2fa828a5
.long 0x00003000,0x00003000,0x00003000,0x00003000,0xaa1faf64,0xab8baf0e,0xac72aea7,0xad13ae2f
.long 0x2da82da8,0x2ea72c72,0x2f642a1f,0x2fd9263e,0xaf64aa1f,0xaff6a246,0xafd9263e,0xaf0e2b8b
.long 0x30000000,0x2f64aa1f,0x2da8ada8,0x2a1faf64,0xaf642a1f,0xad132e2f,0xa63e2fd9,0x28a52fa8
.long 0x2da8ada8,0x263eafd9,0xaa1faf64,0xaea7ac72,0xaa1f2f64,0x28a52fa8,0x2ea72c72,0x2ff6a246
.long 0x0000b000,0xada8ada8,0xb0000000,0xada82da8,0x2a1f2f64,0x2fa828a5,0x2ea7ac72,0x2246aff6
.long 0xada8ada8,0xafd9263e,0xaa1f2f64,0x2c722ea7,0x2f642a1f,0x2e2fad13,0xa63eafd9,0xafa8a8a5
.long 0xb0000000,0xaa1f2f64,0x2da82da8,0x2f64aa1f,0x2f64aa1f,0xa246aff6,0xafd9a63e,0xab8b2f0e
.long 0xada82da8,0x2c722ea7,0x2f64aa1f,0xa63eafd9,0x2a1faf64,0xaf0eab8b,0xac722ea7,0x2e2f2d13
.long 0x00003000,0x00003000,0x00003000,0x00003000,0xada8ada8,0xae2fad13,0xaea7ac72,0xaf0eab8b
.long 0x30000000,0x2fd9a63e,0x2f64aa1f,0x2ea7ac72,0xada82da8,0xab8b2f0e,0xa63e2fd9,0x22462ff6
.long 0x0000b000,0xaa1faf64,0xada8ada8,0xaf64aa1f,0x2da82da8,0x2fa828a5,0x2fd9a63e,0x2e2fad13
.long 0xb0000000,0xaea72c72,0xaa1f2f64,0x263e2fd9,0x2da8ada8,0x2246aff6,0xac72aea7,0xafa8a8a5
.long 0x00003000,0x2da82da8,0x30000000,0x2da8ada8,0xada8ada8,0xaff62246,0xac722ea7,0x28a52fa8
.long 0x30000000,0x2c72aea7,0xaa1faf64,0xafd9a63e,0xada82da8,0x28a52fa8,0x2fd9263e,0x2d13ae2f
.long 0x0000b000,0xaf64aa1f,0xada82da8,0x2a1f2f64,0x2da82da8,0x2f0eab8b,0xa63eafd9,0xaff6a246
.long 0xb0000000,0xa63e2fd9,0x2f642a1f,0x2c72aea7,0x2da8ada8,0xad13ae2f,0xaea72c72,0x2b8b2f0e
.long 0x00003000,0x00003000,0x00003000,0x00003000,0xaf64aa1f,0xafa8a8a5,0xafd9a63e,0xaff6a246
.long 0x2da8ada8,0x2c72aea7,0x2a1faf64,0x263eafd9,0x2a1f2f64,0x2d132e2f,0x2ea72c72,0x2fa828a5
.long 0xb0000000,0xaf642a1f,0xada82da8,0xaa1f2f64,0x2a1faf64,0xa246aff6,0xac72aea7,0xaf0eab8b
.long 0x2da82da8,0x2fd9263e,0x2f64aa1f,0x2c72aea7,0xaf642a1f,0xab8b2f0e,0x263e2fd9,0x2e2f2d13
.long 0x0000b000,0xada8ada8,0xb0000000,0xada82da8,0x2f642a1f,0x2f0eab8b,0x263eafd9,0xad13ae2f
.long 0xada82da8,0x263e2fd9,0x2f642a1f,0x2ea7ac72,0xaa1faf64,0xaff6a246,0xac722ea7,0x2b8b2f0e
.long 0x30000000,0x2a1faf64,0xada8ada8,0xaf642a1f,0xaa1f2f64,0x2e2f2d13,0x2ea7ac72,0xa8a5afa8
.long 0xada8ada8,0xaea72c72,0x2a1f2f64,0x2fd9a63e,0x2f64aa1f,0xa8a5afa8,0xafd9263e,0x22462ff6
.long 0x00003000,0x00003000,0x00003000,0x00003000,0xb0000000,0xaff62246,0xafd9263e,0xafa828a5
.long 0x0000b000,0xa63eafd9,0xaa1faf64,0xac72aea7,0x30000000,0x2fa8a8a5,0x2ea7ac72,0x2d13ae2f
.long 0x00003000,0x2a1f2f64,0x2da82da8,0x2f642a1f,0xb0000000,0xaf0e2b8b,0xac722ea7,0xa2462ff6
.long 0x0000b000,0xac72aea7,0xaf64aa1f,0xafd9263e,0x30000000,0x2e2fad13,0x263eafd9,0xab8baf0e
.long 0x00003000,0x2da82da8,0x30000000,0x2da8ada8,0xb0000000,0xad132e2f,0x263e2fd9,0x2f0e2b8b
.long 0x0000b000,0xaea7ac72,0xaf642a1f,0xa63e2fd9,0x30000000,0x2b8baf0e,0xac72aea7,0xaff62246
.long 0x00003000,0x2f642a1f,0x2da8ada8,0xaa1faf64,0xb0000000,0xa8a52fa8,0x2ea72c72,0x2e2fad13
.long 0x0000b000,0xafd9a63e,0xaa1f2f64,0x2ea72c72,0x30000000,0x2246aff6,0xafd9a63e,0xa8a52fa8
.long 0x00003000,0x00003000,0x00003000,0x00003000,0xaf642a1f,0xaf0e2b8b,0xaea72c72,0xae2f2d13
.long 0xada8ada8,0xaea7ac72,0xaf64aa1f,0xafd9a63e,0x2a1faf64,0x2246aff6,0xa63eafd9,0xab8baf0e
.long 0x30000000,0x2f64aa1f,0x2da8ada8,0x2a1faf64,0x2a1f2f64,0x2e2f2d13,0x2fd9263e,0x2fa8a8a5
.long 0xada82da8,0xa63e2fd9,0x2a1f2f64,0x2ea72c72,0xaf64aa1f,0xafa828a5,0xac722ea7,0x22462ff6
.long 0x0000b000,0xada8ada8,0xb0000000,0xada82da8,0x2f64aa1f,0x28a5afa8,0xac72aea7,0xaff6a246
.long 0x2da82da8,0x2fd9a63e,0x2a1faf64,0xac72aea7,0xaa1f2f64,0x2d132e2f,0x2fd9a63e,0x28a5afa8
.long 0xb0000000,0xaa1f2f64,0x2da82da8,0x2f64aa1f,0xaa1faf64,0xaff62246,0xa63e2fd9,0x2f0e2b8b
.long 0x2da8ada8,0xac72aea7,0xaf642a1f,0x263e2fd9,0x2f642a1f,0x2b8baf0e,0xaea7ac72,0xad132e2f
.long 0x00003000,0x00003000,0x00003000,0x00003000,0xada82da8,0xad132e2f,0xac722ea7,0xab8b2f0e
.long 0xb0000000,0xafd9263e,0xaf642a1f,0xaea72c72,0xada8ada8,0xaf0eab8b,0xafd9a63e,0xaff62246
.long 0x0000b000,0xaa1faf64,0xada8ada8,0xaf64aa1f,0x2da8ada8,0x28a5afa8,0xa63eafd9,0xad13ae2f
.long 0x30000000,0x2ea7ac72,0x2a1faf64,0xa63eafd9,0x2da82da8,0x2ff62246,0x2ea7ac72,0x28a5afa8
.long 0x00003000,0x2da82da8,0x30000000,0x2da8ada8,0xada82da8,0x22462ff6,0x2ea72c72,0x2fa8a8a5
.long 0xb0000000,0xac722ea7,0x2a1f2f64,0x2fd9263e,0xada8ada8,0xafa828a5,0xa63e2fd9,0x2e2f2d13
.long 0x0000b000,0xaf64aa1f,0xada82da8,0x2a1f2f64,0x2da8ada8,0xab8baf0e,0xafd9263e,0xa2462ff6
.long 0x30000000,0x263eafd9,0xaf64aa1f,0xac722ea7,0x2da82da8,0x2e2fad13,0xac72aea7,0xaf0e2b8b
.long 0x00003000,0x00003000,0x00003000,0x00003000,0xaa1f2f64,0xa8a52fa8,0xa63e2fd9,0xa2462ff6
.long 0xada82da8,0xac722ea7,0xaa1f2f64,0xa63e2fd9,0xaf642a1f,0xae2f2d13,0xac722ea7,0xa8a52fa8
.long 0xb0000000,0xaf642a1f,0xada82da8,0xaa1f2f64,0xaf64aa1f,0xaff62246,0xaea72c72,0xab8b2f0e
.long 0xada8ada8,0xafd9a63e,0xaf642a1f,0xac722ea7,0xaa1faf64,0xaf0eab8b,0xafd9263e,0xad132e2f
.long 0x0000b000,0xada8ada8,0xb0000000,0xada82da8,0x2a1faf64,0xab8baf0e,0xafd9a63e,0xae2f2d13
.long 0x2da8ada8,0xa63eafd9,0xaf64aa1f,0xaea72c72,0x2f64aa1f,0x2246aff6,0xaea7ac72,0xaf0e2b8b
.long 0x30000000,0x2a1faf64,0xada8ada8,0xaf642a1f,0x2f642a1f,0x2d13ae2f,0xac72aea7,0xafa828a5
.long 0x2da82da8,0x2ea7ac72,0xaa1faf64,0xafd9263e,0x2a1f2f64,0x2fa8a8a5,0xa63eafd9,0xaff62246
.long 0x00003000,0x30000000,0x0000b000,0xb0000000,0x00003000,0x2ff6a246,0xa63eafd9,0xafa828a5
.long 0x00003000,0x2fd9a63e,0xaa1faf64,0xaea72c72,0x00003000,0x2fa8a8a5,0xac72aea7,0xad132e2f
.long 0x00003000,0x2f64aa1f,0xada8ada8,0xaa1f2f64,0x00003000,0x2f0eab8b,0xaea7ac72,0xa2462ff6
.long 0x00003000,0x2ea7ac72,0xaf64aa1f,0x263e2fd9,0x00003000,0x2e2fad13,0xafd9a63e,0x2b8b2f0e
.long 0x00003000,0x2da8ada8,0xb0000000,0x2da82da8,0x00003000,0x2d13ae2f,0xafd9263e,0x2f0e2b8b
.long 0x00003000,0x2c72aea7,0xaf642a1f,0x2fd9263e,0x00003000,0x2b8baf0e,0xaea72c72,0x2ff6a246
.long 0x00003000,0x2a1faf64,0xada82da8,0x2f64aa1f,0x00003000,0x28a5afa8,0xac722ea7,0x2e2fad13
.long 0x00003000,0x263eafd9,0xaa1f2f64,0x2c72aea7,0x00003000,0x2246aff6,0xa63e2fd9,0x28a5afa8
.long 0x00003000,0x30000000,0x0000b000,0xb0000000,0x2a1f2f64,0x2f0eab8b,0xac72aea7,0xae2f2d13
.long 0x2da82da8,0x2c72aea7,0xaf64aa1f,0xa63e2fd9,0x2f642a1f,0x2246aff6,0xafd9263e,0x2b8b2f0e
.long 0x30000000,0xaa1faf64,0xada82da8,0x2f642a1f,0x2f64aa1f,0xae2fad13,0xa63e2fd9,0x2fa8a8a5
.long 0x2da8ada8,0xafd9a63e,0x2a1f2f64,0x2c72aea7,0x2a1faf64,0xafa828a5,0x2ea72c72,0xa246aff6
.long 0x0000b000,0xada82da8,0x30000000,0xada8ada8,0xaa1faf64,0xa8a52fa8,0x2ea7ac72,0xaff6a246
.long 0xada8ada8,0x263e2fd9,0x2a1faf64,0xaea72c72,0xaf64aa1f,0x2d132e2f,0xa63eafd9,0xa8a52fa8
.long 0xb0000000,0x2f642a1f,0xada8ada8,0x2a1f2f64,0xaf642a1f,0x2ff6a246,0xafd9a63e,0x2f0e2b8b
.long 0xada82da8,0x2ea7ac72,0xaf642a1f,0x2fd9a63e,0xaa1f2f64,0x2b8baf0e,0xac722ea7,0x2d13ae2f
.long 0x00003000,0x30000000,0x0000b000,0xb0000000,0x2da82da8,0x2d13ae2f,0xaea7ac72,0xab8b2f0e
.long 0x30000000,0xa63eafd9,0xaf642a1f,0x2c722ea7,0x2da8ada8,0xaf0eab8b,0xa63e2fd9,0x2ff6a246
.long 0x0000b000,0xaf642a1f,0x2da82da8,0x2a1faf64,0xada8ada8,0xa8a52fa8,0x2fd9a63e,0xad13ae2f
.long 0xb0000000,0x2c722ea7,0x2a1faf64,0xafd9263e,0xada82da8,0x2ff62246,0xac72aea7,0xa8a52fa8
.long 0x00003000,0x2da8ada8,0xb0000000,0x2da82da8,0x2da82da8,0xa246aff6,0xac722ea7,0x2fa8a8a5
.long 0x30000000,0xaea7ac72,0x2a1f2f64,0x263eafd9,0x2da8ada8,0xafa828a5,0x2fd9263e,0xae2fad13
.long 0x0000b000,0xaa1f2f64,0x2da8ada8,0xaf642a1f,0xada8ada8,0x2b8b2f0e,0xa63eafd9,0xa2462ff6
.long 0xb0000000,0x2fd9263e,0xaf64aa1f,0x2ea72c72,0xada82da8,0x2e2fad13,0xaea72c72,0x2f0eab8b
.long 0x00003000,0x30000000,0x0000b000,0xb0000000,0x2f642a1f,0x28a5afa8,0xafd9a63e,0xa2462ff6
.long 0x2da8ada8,0xaea7ac72,0xaa1f2f64,0x2fd9263e,0xaa1faf64,0xae2f2d13,0x2ea72c72,0x28a5afa8
.long 0xb0000000,0x2a1f2f64,0x2da8ada8,0xaf64aa1f,0xaa1f2f64,0x2ff6a246,0xac72aea7,0xab8b2f0e
.long 0x2da82da8,0x263eafd9,0xaf642a1f,0x2ea72c72,0x2f64aa1f,0xaf0eab8b,0x263e2fd9,0x2d13ae2f
.long 0x0000b000,0xada82da8,0x30000000,0xada8ada8,0xaf64aa1f,0x2b8b2f0e,0x263eafd9,0xae2f2d13
.long 0xada82da8,0x2fd9a63e,0xaf64aa1f,0x2c722ea7,0x2a1f2f64,0x2246aff6,0xac722ea7,0x2f0eab8b
.long 0x30000000,0xaf64aa1f,0x2da82da8,0xaa1faf64,0x2a1faf64,0xad132e2f,0x2ea7ac72,0xafa828a5
.long 0xada8ada8,0x2c722ea7,0xaa1faf64,0x263e2fd9,0xaf642a1f,0x2fa8a8a5,0xafd9263e,0x2ff6a246
.long 0x00003000,0x30000000,0x0000b000,0xb0000000,0x30000000,0xa246aff6,0xafd9263e,0x28a52fa8
.long 0x0000b000,0xafd9263e,0x2a1f2f64,0x2ea7ac72,0xb0000000,0x28a52fa8,0x2ea7ac72,0xae2fad13
.long 0x00003000,0x2f64aa1f,0xada8ada8,0xaa1f2f64,0x30000000,0xab8baf0e,0xac722ea7,0x2ff62246
.long 0x0000b000,0xaea72c72,0x2f642a1f,0xa63eafd9,0xb0000000,0x2d132e2f,0x263eafd9,0xaf0e2b8b
.long 0x00003000,0x2da8ada8,0xb0000000,0x2da82da8,0x30000000,0xae2fad13,0x263e2fd9,0x2b8baf0e
.long 0x0000b000,0xac722ea7,0x2f64aa1f,0xafd9a63e,0xb0000000,0x2f0e2b8b,0xac72aea7,0x22462ff6
.long 0x00003000,0x2a1faf64,0xada82da8,0x2f64aa1f,0x30000000,0xafa8a8a5,0x2ea72c72,0xad13ae2f
.long 0x0000b000,0xa63e2fd9,0x2a1faf64,0xac722ea7,0xb0000000,0x2ff62246,0xafd9a63e,0x2fa828a5
.long 0x00003000,0x30000000,0x0000b000,0xb0000000,0x2f64aa1f,0xab8baf0e,0xaea72c72,0x2d132e2f
.long 0xada8ada8,0xac722ea7,0x2f642a1f,0x263eafd9,0xaa1f2f64,0x2ff62246,0xa63eafd9,0xaf0e2b8b
.long 0x30000000,0xaa1faf64,0xada82da8,0x2f642a1f,0xaa1faf64,0xad132e2f,0x2fd9263e,0xa8a5afa8
.long 0xada82da8,0x2fd9263e,0xaa1faf64,0xac722ea7,0x2f642a1f,0xa8a5afa8,0xac722ea7,0x2ff6a246
.long 0x0000b000,0xada82da8,0x30000000,0xada8ada8,0xaf642a1f,0x2fa828a5,0xac72aea7,0xa2462ff6
.long 0x2da82da8,0xa63eafd9,0xaa1f2f64,0x2ea7ac72,0x2a1faf64,0xae2f2d13,0x2fd9a63e,0xafa8a8a5
.long 0xb0000000,0x2f642a1f,0xada8ada8,0x2a1f2f64,0x2a1f2f64,0xa246aff6,0xa63e2fd9,0x2b8baf0e
.long 0x2da8ada8,0xaea72c72,0x2f64aa1f,0xafd9263e,0xaf64aa1f,0x2f0e2b8b,0xaea7ac72,0x2e2f2d13
.long 0x00003000,0x30000000,0x0000b000,0xb0000000,0x2da8ada8,0xae2fad13,0xac722ea7,0x2f0e2b8b
.long 0xb0000000,0x263e2fd9,0x2f64aa1f,0xac72aea7,0x2da82da8,0x2b8baf0e,0xafd9a63e,0x22462ff6
.long 0x0000b000,0xaf642a1f,0x2da82da8,0x2a1faf64,0xada82da8,0x2fa828a5,0xa63eafd9,0xae2f2d13
.long 0x30000000,0xac72aea7,0xaa1f2f64,0x2fd9a63e,0xada8ada8,0xa2462ff6,0x2ea7ac72,0xafa8a8a5
.long 0x00003000,0x2da8ada8,0xb0000000,0x2da82da8,0x2da8ada8,0xaff62246,0x2ea72c72,0xa8a5afa8
.long 0xb0000000,0x2ea72c72,0xaa1faf64,0xa63e2fd9,0x2da82da8,0xa8a5afa8,0xa63e2fd9,0x2d13ae2f
.long 0x0000b000,0xaa1f2f64,0x2da8ada8,0xaf642a1f,0xada82da8,0x2f0eab8b,0xafd9263e,0x2ff62246
.long 0x30000000,0xafd9a63e,0x2f642a1f,0xaea7ac72,0xada8ada8,0x2d132e2f,0xac72aea7,0x2b8b2f0e
.long 0x00003000,0x30000000,0x0000b000,0xb0000000,0x2a1faf64,0xafa8a8a5,0xa63e2fd9,0x2ff62246
.long 0xada82da8,0x2ea72c72,0x2a1faf64,0xafd9a63e,0x2f64aa1f,0xad13ae2f,0xac722ea7,0x2fa828a5
.long 0xb0000000,0x2a1f2f64,0x2da8ada8,0xaf64aa1f,0x2f642a1f,0xa246aff6,0xaea72c72,0x2f0e2b8b
.long 0xada8ada8,0xa63e2fd9,0x2f64aa1f,0xaea7ac72,0x2a1f2f64,0x2b8baf0e,0xafd9263e,0x2e2f2d13
.long 0x0000b000,0xada82da8,0x30000000,0xada8ada8,0xaa1f2f64,0x2f0eab8b,0xafd9a63e,0x2d132e2f
.long 0x2da8ada8,0xafd9263e,0x2f642a1f,0xac72aea7,0xaf642a1f,0x2ff62246,0xaea7ac72,0x2b8b2f0e
.long 0x30000000,0xaf64aa1f,0x2da82da8,0xaa1faf64,0xaf64aa1f,0x2e2f2d13,0xac72aea7,0x28a52fa8
.long 0x2da82da8,0xac72aea7,0x2a1f2f64,0xa63eafd9,0xaa1faf64,0x28a52fa8,0xa63eafd9,0x22462ff6
.long 0x00003000,0x30000000,0x0000b000,0xb0000000,0x0000b000,0xaff62246,0x263e2fd9,0x2fa8a8a5
.long 0x00003000,0x2fd9a63e,0xaa1faf64,0xaea72c72,0x0000b000,0xafa828a5,0x2c722ea7,0x2d13ae2f
.long 0x00003000,0x2f64aa1f,0xada8ada8,0xaa1f2f64,0x0000b000,0xaf0e2b8b,0x2ea72c72,0x2246aff6
.long 0x00003000,0x2ea7ac72,0xaf64aa1f,0x263e2fd9,0x0000b000,0xae2f2d13,0x2fd9263e,0xab8baf0e
.long 0x00003000,0x2da8ada8,0xb0000000,0x2da82da8,0x0000b000,0xad132e2f,0x2fd9a63e,0xaf0eab8b
.long 0x00003000,0x2c72aea7,0xaf642a1f,0x2fd9263e,0x0000b000,0xab8b2f0e,0x2ea7ac72,0xaff62246
.long 0x00003000,0x2a1faf64,0xada82da8,0x2f64aa1f,0x0000b000,0xa8a52fa8,0x2c72aea7,0xae2f2d13
.long 0x00003000,0x263eafd9,0xaa1f2f64,0x2c72aea7,0x0000b000,0xa2462ff6,0x263eafd9,0xa8a52fa8
.long 0x00003000,0x30000000,0x0000b000,0xb0000000,0xaa1faf64,0xaf0e2b8b,0x2c722ea7,0x2e2fad13
.long 0x2da82da8,0x2c72aea7,0xaf64aa1f,0xa63e2fd9,0xaf64aa1f,0xa2462ff6,0x2fd9a63e,0xab8baf0e
.long 0x30000000,0xaa1faf64,0xada82da8,0x2f642a1f,0xaf642a1f,0x2e2f2d13,0x263eafd9,0xafa828a5
.long 0x2da8ada8,0xafd9a63e,0x2a1f2f64,0x2c72aea7,0xaa1f2f64,0x2fa8a8a5,0xaea7ac72,0x22462ff6
.long 0x0000b000,0xada82da8,0x30000000,0xada8ada8,0x2a1f2f64,0x28a5afa8,0xaea72c72,0x2ff62246
.long 0xada8ada8,0x263e2fd9,0x2a1faf64,0xaea72c72,0x2f642a1f,0xad13ae2f,0x263e2fd9,0x28a5afa8
.long 0xb0000000,0x2f642a1f,0xada8ada8,0x2a1f2f64,0x2f64aa1f,0xaff62246,0x2fd9263e,0xaf0eab8b
.long 0xada82da8,0x2ea7ac72,0xaf642a1f,0x2fd9a63e,0x2a1faf64,0xab8b2f0e,0x2c72aea7,0xad132e2f
.long 0x00003000,0x30000000,0x0000b000,0xb0000000,0xada8ada8,0xad132e2f,0x2ea72c72,0x2b8baf0e
.long 0x30000000,0xa63eafd9,0xaf642a1f,0x2c722ea7,0xada82da8,0x2f0e2b8b,0x263eafd9,0xaff62246
.long 0x0000b000,0xaf642a1f,0x2da82da8,0x2a1faf64,0x2da82da8,0x28a5afa8,0xafd9263e,0x2d132e2f
.long 0xb0000000,0x2c722ea7,0x2a1faf64,0xafd9263e,0x2da8ada8,0xaff6a246,0x2c722ea7,0x28a5afa8
.long 0x00003000,0x2da8ada8,0xb0000000,0x2da82da8,0xada8ada8,0x22462ff6,0x2c72aea7,0xafa828a5
.long 0x30000000,0xaea7ac72,0x2a1f2f64,0x263eafd9,0xada82da8,0x2fa8a8a5,0xafd9a63e,0x2e2f2d13
.long 0x0000b000,0xaa1f2f64,0x2da8ada8,0xaf642a1f,0x2da82da8,0xab8baf0e,0x263e2fd9,0x2246aff6
.long 0xb0000000,0x2fd9263e,0xaf64aa1f,0x2ea72c72,0x2da8ada8,0xae2f2d13,0x2ea7ac72,0xaf0e2b8b
.long 0x00003000,0x30000000,0x0000b000,0xb0000000,0xaf64aa1f,0xa8a52fa8,0x2fd9263e,0x2246aff6
.long 0x2da8ada8,0xaea7ac72,0xaa1f2f64,0x2fd9263e,0x2a1f2f64,0x2e2fad13,0xaea7ac72,0xa8a52fa8
.long 0xb0000000,0x2a1f2f64,0x2da8ada8,0xaf64aa1f,0x2a1faf64,0xaff62246,0x2c722ea7,0x2b8baf0e
.long 0x2da82da8,0x263eafd9,0xaf642a1f,0x2ea72c72,0xaf642a1f,0x2f0e2b8b,0xa63eafd9,0xad132e2f
.long 0x0000b000,0xada82da8,0x30000000,0xada8ada8,0x2f642a1f,0xab8baf0e,0xa63e2fd9,0x2e2fad13
.long 0xada82da8,0x2fd9a63e,0xaf64aa1f,0x2c722ea7,0xaa1faf64,0xa2462ff6,0x2c72aea7,0xaf0e2b8b
.long 0x30000000,0xaf64aa1f,0x2da82da8,0xaa1faf64,0xaa1f2f64,0x2d13ae2f,0xaea72c72,0x2fa8a8a5
.long 0xada8ada8,0x2c722ea7,0xaa1faf64,0x263e2fd9,0x2f64aa1f,0xafa828a5,0x2fd9a63e,0xaff62246
.long 0x00003000,0x30000000,0x0000b000,0xb0000000,0xb0000000,0x22462ff6,0x2fd9a63e,0xa8a5afa8
.long 0x0000b000,0xafd9263e,0x2a1f2f64,0x2ea7ac72,0x30000000,0xa8a5afa8,0xaea72c72,0x2e2f2d13
.long 0x00003000,0x2f64aa1f,0xada8ada8,0xaa1f2f64,0xb0000000,0x2b8b2f0e,0x2c72aea7,0xaff6a246
.long 0x0000b000,0xaea72c72,0x2f642a1f,0xa63eafd9,0x30000000,0xad13ae2f,0xa63e2fd9,0x2f0eab8b
.long 0x00003000,0x2da8ada8,0xb0000000,0x2da82da8,0xb0000000,0x2e2f2d13,0xa63eafd9,0xab8b2f0e
.long 0x0000b000,0xac722ea7,0x2f64aa1f,0xafd9a63e,0x30000000,0xaf0eab8b,0x2c722ea7,0xa246aff6
.long 0x00003000,0x2a1faf64,0xada82da8,0x2f64aa1f,0xb0000000,0x2fa828a5,0xaea7ac72,0x2d132e2f
.long 0x0000b000,0xa63e2fd9,0x2a1faf64,0xac722ea7,0x30000000,0xaff6a246,0x2fd9263e,0xafa8a8a5
.long 0x00003000,0x30000000,0x0000b000,0xb0000000,0xaf642a1f,0x2b8b2f0e,0x2ea7ac72,0xad13ae2f
.long 0xada8ada8,0xac722ea7,0x2f642a1f,0x263eafd9,0x2a1faf64,0xaff6a246,0x263e2fd9,0x2f0eab8b
.long 0x30000000,0xaa1faf64,0xada82da8,0x2f642a1f,0x2a1f2f64,0x2d13ae2f,0xafd9a63e,0x28a52fa8
.long 0xada82da8,0x2fd9263e,0xaa1faf64,0xac722ea7,0xaf64aa1f,0x28a52fa8,0x2c72aea7,0xaff62246
.long 0x0000b000,0xada82da8,0x30000000,0xada8ada8,0x2f64aa1f,0xafa8a8a5,0x2c722ea7,0x2246aff6
.long 0x2da82da8,0xa63eafd9,0xaa1f2f64,0x2ea7ac72,0xaa1f2f64,0x2e2fad13,0xafd9263e,0x2fa828a5
.long 0xb0000000,0x2f642a1f,0xada8ada8,0x2a1f2f64,0xaa1faf64,0x22462ff6,0x263eafd9,0xab8b2f0e
.long 0x2da8ada8,0xaea72c72,0x2f64aa1f,0xafd9263e,0x2f642a1f,0xaf0eab8b,0x2ea72c72,0xae2fad13
.long 0x00003000,0x30000000,0x0000b000,0xb0000000,0xada82da8,0x2e2f2d13,0x2c72aea7,0xaf0eab8b
.long 0xb0000000,0x263e2fd9,0x2f64aa1f,0xac72aea7,0xada8ada8,0xab8b2f0e,0x2fd9263e,0xa246aff6
.long 0x0000b000,0xaf642a1f,0x2da82da8,0x2a1faf64,0x2da8ada8,0xafa8a8a5,0x263e2fd9,0x2e2fad13
.long 0x30000000,0xac72aea7,0xaa1f2f64,0x2fd9a63e,0x2da82da8,0x2246aff6,0xaea72c72,0x2fa828a5
.long 0x00003000,0x2da8ada8,0xb0000000,0x2da82da8,0xada82da8,0x2ff6a246,0xaea7ac72,0x28a52fa8
.long 0xb0000000,0x2ea72c72,0xaa1faf64,0xa63e2fd9,0xada8ada8,0x28a52fa8,0x263eafd9,0xad132e2f
.long 0x0000b000,0xaa1f2f64,0x2da8ada8,0xaf642a1f,0x2da8ada8,0xaf0e2b8b,0x2fd9a63e,0xaff6a246
.long 0x30000000,0xafd9a63e,0x2f642a1f,0xaea7ac72,0x2da82da8,0xad13ae2f,0x2c722ea7,0xab8baf0e
.long 0x00003000,0x30000000,0x0000b000,0xb0000000,0xaa1f2f64,0x2fa828a5,0x263eafd9,0xaff6a246
.long 0xada82da8,0x2ea72c72,0x2a1faf64,0xafd9a63e,0xaf642a1f,0x2d132e2f,0x2c72aea7,0xafa8a8a5
.long 0xb0000000,0x2a1f2f64,0x2da8ada8,0xaf64aa1f,0xaf64aa1f,0x22462ff6,0x2ea7ac72,0xaf0eab8b
.long 0xada8ada8,0xa63e2fd9,0x2f64aa1f,0xaea7ac72,0xaa1faf64,0xab8b2f0e,0x2fd9a63e,0xae2fad13
.long 0x0000b000,0xada82da8,0x30000000,0xada8ada8,0x2a1faf64,0xaf0e2b8b,0x2fd9263e,0xad13ae2f
.long 0x2da8ada8,0xafd9263e,0x2f642a1f,0xac72aea7,0x2f64aa1f,0xaff6a246,0x2ea72c72,0xab8baf0e
.long 0x30000000,0xaf64aa1f,0x2da82da8,0xaa1faf64,0x2f642a1f,0xae2fad13,0x2c722ea7,0xa8a5afa8
.long 0x2da82da8,0xac72aea7,0x2a1f2f64,0xa63eafd9,0x2a1f2f64,0xa8a5afa8,0x263e2fd9,0xa246aff6
.long 0x00003000,0x0000b000,0x00003000,0x0000b000,0x00003000,0xa246aff6,0x263e2fd9,0xa8a5afa8
.long 0x00003000,0xa63eafd9,0x2a1f2f64,0xac72aea7,0x00003000,0xa8a5afa8,0x2c722ea7,0xae2fad13
.long 0x00003000,0xaa1faf64,0x2da82da8,0xaf64aa1f,0x00003000,0xab8baf0e,0x2ea72c72,0xaff6a246
.long 0x00003000,0xac72aea7,0x2f642a1f,0xafd9263e,0x00003000,0xad13ae2f,0x2fd9263e,0xaf0e2b8b
.long 0x00003000,0xada8ada8,0x30000000,0xada82da8,0x00003000,0xae2fad13,0x2fd9a63e,0xab8b2f0e
.long 0x00003000,0xaea7ac72,0x2f64aa1f,0xa63e2fd9,0x00003000,0xaf0eab8b,0x2ea7ac72,0x22462ff6
.long 0x00003000,0xaf64aa1f,0x2da8ada8,0x2a1f2f64,0x00003000,0xafa8a8a5,0x2c72aea7,0x2d132e2f
.long 0x00003000,0xafd9a63e,0x2a1faf64,0x2ea72c72,0x00003000,0xaff6a246,0x263eafd9,0x2fa828a5
.long 0x00003000,0x0000b000,0x00003000,0x0000b000,0x2a1f2f64,0xab8baf0e,0x2c722ea7,0xad13ae2f
.long 0x2da82da8,0xaea7ac72,0x2f642a1f,0xafd9a63e,0x2f642a1f,0xaff6a246,0x2fd9a63e,0xaf0e2b8b
.long 0x30000000,0xaf642a1f,0x2da8ada8,0xaa1f2f64,0x2f64aa1f,0xad132e2f,0x263eafd9,0x28a52fa8
.long 0x2da8ada8,0xa63e2fd9,0xaa1faf64,0x2ea72c72,0x2a1faf64,0x28a52fa8,0xaea7ac72,0x2ff6a246
.long 0x0000b000,0x2da82da8,0xb0000000,0x2da8ada8,0xaa1faf64,0x2fa828a5,0xaea72c72,0x2246aff6
.long 0xada8ada8,0x2fd9a63e,0xaa1f2f64,0xac72aea7,0xaf64aa1f,0x2e2fad13,0x263e2fd9,0xafa8a8a5
.long 0xb0000000,0x2a1faf64,0x2da82da8,0xaf642a1f,0xaf642a1f,0xa246aff6,0x2fd9263e,0xab8b2f0e
.long 0xada82da8,0xac72aea7,0x2f64aa1f,0x263e2fd9,0xaa1f2f64,0xaf0eab8b,0x2c72aea7,0x2e2f2d13
.long 0x00003000,0x0000b000,0x00003000,0x0000b000,0x2da82da8,0xae2fad13,0x2ea72c72,0xaf0eab8b
.long 0x30000000,0xafd9263e,0x2f64aa1f,0xaea72c72,0x2da8ada8,0xab8b2f0e,0x263eafd9,0x22462ff6
.long 0x0000b000,0x2a1f2f64,0xada8ada8,0x2f642a1f,0xada8ada8,0x2fa828a5,0xafd9263e,0x2e2fad13
.long 0xb0000000,0x2ea7ac72,0xaa1f2f64,0xa63eafd9,0xada82da8,0x2246aff6,0x2c722ea7,0xafa8a8a5
.long 0x00003000,0xada8ada8,0x30000000,0xada82da8,0x2da82da8,0xaff62246,0x2c72aea7,0x28a52fa8
.long 0x30000000,0xac722ea7,0xaa1faf64,0x2fd9263e,0x2da8ada8,0x28a52fa8,0xafd9a63e,0x2d13ae2f
.long 0x0000b000,0x2f642a1f,0xada82da8,0xaa1faf64,0xada8ada8,0x2f0eab8b,0x263e2fd9,0xaff6a246
.long 0xb0000000,0x263eafd9,0x2f642a1f,0xac722ea7,0xada82da8,0xad13ae2f,0x2ea7ac72,0x2b8b2f0e
.long 0x00003000,0x0000b000,0x00003000,0x0000b000,0x2f642a1f,0xafa8a8a5,0x2fd9263e,0xaff6a246
.long 0x2da8ada8,0xac722ea7,0x2a1faf64,0xa63e2fd9,0xaa1faf64,0x2d132e2f,0xaea7ac72,0x2fa828a5
.long 0xb0000000,0x2f64aa1f,0xada82da8,0x2a1faf64,0xaa1f2f64,0xa246aff6,0x2c722ea7,0xaf0eab8b
.long 0x2da82da8,0xafd9a63e,0x2f64aa1f,0xac722ea7,0x2f64aa1f,0xab8b2f0e,0xa63eafd9,0x2e2f2d13
.long 0x0000b000,0x2da82da8,0xb0000000,0x2da8ada8,0xaf64aa1f,0x2f0eab8b,0xa63e2fd9,0xad13ae2f
.long 0xada82da8,0xa63eafd9,0x2f642a1f,0xaea72c72,0x2a1f2f64,0xaff6a246,0x2c72aea7,0x2b8b2f0e
.long 0x30000000,0xaa1f2f64,0xada8ada8,0x2f64aa1f,0x2a1faf64,0x2e2f2d13,0xaea72c72,0xa8a5afa8
.long 0xada8ada8,0x2ea7ac72,0x2a1f2f64,0xafd9263e,0xaf642a1f,0xa8a5afa8,0x2fd9a63e,0x22462ff6
.long 0x00003000,0x0000b000,0x00003000,0x0000b000,0x30000000,0xaff62246,0x2fd9a63e,0xafa828a5
.long 0x0000b000,0x263e2fd9,0xaa1faf64,0x2c722ea7,0xb0000000,0x2fa8a8a5,0xaea72c72,0x2d13ae2f
.long 0x00003000,0xaa1faf64,0x2da82da8,0xaf64aa1f,0x30000000,0xaf0e2b8b,0x2c72aea7,0xa2462ff6
.long 0x0000b000,0x2c722ea7,0xaf64aa1f,0x2fd9a63e,0xb0000000,0x2e2fad13,0xa63e2fd9,0xab8baf0e
.long 0x00003000,0xada8ada8,0x30000000,0xada82da8,0x30000000,0xad132e2f,0xa63eafd9,0x2f0e2b8b
.long 0x0000b000,0x2ea72c72,0xaf642a1f,0x263eafd9,0xb0000000,0x2b8baf0e,0x2c722ea7,0xaff62246
.long 0x00003000,0xaf64aa1f,0x2da8ada8,0x2a1f2f64,0x30000000,0xa8a52fa8,0xaea7ac72,0x2e2fad13
.long 0x0000b000,0x2fd9263e,0xaa1f2f64,0xaea7ac72,0xb0000000,0x2246aff6,0x2fd9263e,0xa8a52fa8
.long 0x00003000,0x0000b000,0x00003000,0x0000b000,0x2f64aa1f,0xaf0e2b8b,0x2ea7ac72,0xae2f2d13
.long 0xada8ada8,0x2ea72c72,0xaf64aa1f,0x2fd9263e,0xaa1f2f64,0x2246aff6,0x263e2fd9,0xab8baf0e
.long 0x30000000,0xaf642a1f,0x2da8ada8,0xaa1f2f64,0xaa1faf64,0x2e2f2d13,0xafd9a63e,0x2fa8a8a5
.long 0xada82da8,0x263eafd9,0x2a1f2f64,0xaea7ac72,0x2f642a1f,0xafa828a5,0x2c72aea7,0x22462ff6
.long 0x0000b000,0x2da82da8,0xb0000000,0x2da8ada8,0xaf642a1f,0x28a5afa8,0x2c722ea7,0xaff6a246
.long 0x2da82da8,0xafd9263e,0x2a1faf64,0x2c722ea7,0x2a1faf64,0x2d132e2f,0xafd9263e,0x28a5afa8
.long 0xb0000000,0x2a1faf64,0x2da82da8,0xaf642a1f,0x2a1f2f64,0xaff62246,0x263eafd9,0x2f0e2b8b
.long 0x2da8ada8,0x2c722ea7,0xaf642a1f,0xa63eafd9,0xaf64aa1f,0x2b8baf0e,0x2ea72c72,0xad132e2f
.long 0x00003000,0x0000b000,0x00003000,0x0000b000,0x2da8ada8,0xad132e2f,0x2c72aea7,0xab8b2f0e
.long 0xb0000000,0x2fd9a63e,0xaf642a1f,0x2ea7ac72,0x2da82da8,0xaf0eab8b,0x2fd9263e,0xaff62246
.long 0x0000b000,0x2a1f2f64,0xada8ada8,0x2f642a1f,0xada82da8,0x28a5afa8,0x263e2fd9,0xad13ae2f
.long 0x30000000,0xaea72c72,0x2a1faf64,0x263e2fd9,0xada8ada8,0x2ff62246,0xaea72c72,0x28a5afa8
.long 0x00003000,0xada8ada8,0x30000000,0xada82da8,0x2da8ada8,0x22462ff6,0xaea7ac72,0x2fa8a8a5
.long 0xb0000000,0x2c72aea7,0x2a1f2f64,0xafd9a63e,0x2da82da8,0xafa828a5,0x263eafd9,0x2e2f2d13
.long 0x0000b000,0x2f642a1f,0xada82da8,0xaa1faf64,0xada82da8,0xab8baf0e,0x2fd9a63e,0xa2462ff6
.long 0x30000000,0xa63e2fd9,0xaf64aa1f,0x2c72aea7,0xada8ada8,0x2e2fad13,0x2c722ea7,0xaf0e2b8b
.long 0x00003000,0x0000b000,0x00003000,0x0000b000,0x2a1faf64,0xa8a52fa8,0x263eafd9,0xa2462ff6
.long 0xada82da8,0x2c72aea7,0xaa1f2f64,0x263eafd9,0x2f64aa1f,0xae2f2d13,0x2c72aea7,0xa8a52fa8
.long 0xb0000000,0x2f64aa1f,0xada82da8,0x2a1faf64,0x2f642a1f,0xaff62246,0x2ea7ac72,0xab8b2f0e
.long 0xada8ada8,0x2fd9263e,0xaf642a1f,0x2c72aea7,0x2a1f2f64,0xaf0eab8b,0x2fd9a63e,0xad132e2f
.long 0x0000b000,0x2da82da8,0xb0000000,0x2da8ada8,0xaa1f2f64,0xab8baf0e,0x2fd9263e,0xae2f2d13
.long 0x2da8ada8,0x263e2fd9,0xaf64aa1f,0x2ea7ac72,0xaf642a1f,0x2246aff6,0x2ea72c72,0xaf0e2b8b
.long 0x30000000,0xaa1f2f64,0xada8ada8,0x2f64aa1f,0xaf64aa1f,0x2d13ae2f,0x2c722ea7,0xafa828a5
.long 0x2da82da8,0xaea72c72,0xaa1faf64,0x2fd9a63e,0xaa1faf64,0x2fa8a8a5,0x263e2fd9,0xaff62246
.long 0x00003000,0x0000b000,0x00003000,0x0000b000,0x0000b000,0x22462ff6,0xa63eafd9,0x28a52fa8
.long 0x00003000,0xa63eafd9,0x2a1f2f64,0xac72aea7,0x0000b000,0x28a52fa8,0xac72aea7,0x2e2f2d13
.long 0x00003000,0xaa1faf64,0x2da82da8,0xaf64aa1f,0x0000b000,0x2b8b2f0e,0xaea7ac72,0x2ff62246
.long 0x00003000,0xac72aea7,0x2f642a1f,0xafd9263e,0x0000b000,0x2d132e2f,0xafd9a63e,0x2f0eab8b
.long 0x00003000,0xada8ada8,0x30000000,0xada82da8,0x0000b000,0x2e2f2d13,0xafd9263e,0x2b8baf0e
.long 0x00003000,0xaea7ac72,0x2f64aa1f,0xa63e2fd9,0x0000b000,0x2f0e2b8b,0xaea72c72,0xa246aff6
.long 0x00003000,0xaf64aa1f,0x2da8ada8,0x2a1f2f64,0x0000b000,0x2fa828a5,0xac722ea7,0xad13ae2f
.long 0x00003000,0xafd9a63e,0x2a1faf64,0x2ea72c72,0x0000b000,0x2ff62246,0xa63e2fd9,0xafa8a8a5
.long 0x00003000,0x0000b000,0x00003000,0x0000b000,0xaa1faf64,0x2b8b2f0e,0xac72aea7,0x2d132e2f
.long 0x2da82da8,0xaea7ac72,0x2f642a1f,0xafd9a63e,0xaf64aa1f,0x2ff62246,0xafd9263e,0x2f0eab8b
.long 0x30000000,0xaf642a1f,0x2da8ada8,0xaa1f2f64,0xaf642a1f,0x2d13ae2f,0xa63e2fd9,0xa8a5afa8
.long 0x2da8ada8,0xa63e2fd9,0xaa1faf64,0x2ea72c72,0xaa1f2f64,0xa8a5afa8,0x2ea72c72,0xaff62246
.long 0x0000b000,0x2da82da8,0xb0000000,0x2da8ada8,0x2a1f2f64,0xafa8a8a5,0x2ea7ac72,0xa2462ff6
.long 0xada8ada8,0x2fd9a63e,0xaa1f2f64,0xac72aea7,0x2f642a1f,0xae2f2d13,0xa63eafd9,0x2fa828a5
.long 0xb0000000,0x2a1faf64,0x2da82da8,0xaf642a1f,0x2f64aa1f,0x22462ff6,0xafd9a63e,0x2b8baf0e
.long 0xada82da8,0xac72aea7,0x2f64aa1f,0x263e2fd9,0x2a1faf64,0x2f0e2b8b,0xac722ea7,0xae2fad13
.long 0x00003000,0x0000b000,0x00003000,0x0000b000,0xada8ada8,0x2e2f2d13,0xaea7ac72,0x2f0e2b8b
.long 0x30000000,0xafd9263e,0x2f64aa1f,0xaea72c72,0xada82da8,0x2b8baf0e,0xa63e2fd9,0xa246aff6
.long 0x0000b000,0x2a1f2f64,0xada8ada8,0x2f642a1f,0x2da82da8,0xafa8a8a5,0x2fd9a63e,0xae2f2d13
.long 0xb0000000,0x2ea7ac72,0xaa1f2f64,0xa63eafd9,0x2da8ada8,0xa2462ff6,0xac72aea7,0x2fa828a5
.long 0x00003000,0xada8ada8,0x30000000,0xada82da8,0xada8ada8,0x2ff6a246,0xac722ea7,0xa8a5afa8
.long 0x30000000,0xac722ea7,0xaa1faf64,0x2fd9263e,0xada82da8,0xa8a5afa8,0x2fd9263e,0xad132e2f
.long 0x0000b000,0x2f642a1f,0xada82da8,0xaa1faf64,0x2da82da8,0xaf0e2b8b,0xa63eafd9,0x2ff62246
.long 0xb0000000,0x263eafd9,0x2f642a1f,0xac722ea7,0x2da8ada8,0x2d132e2f,0xaea72c72,0xab8baf0e
.long 0x00003000,0x0000b000,0x00003000,0x0000b000,0xaf64aa1f,0x2fa828a5,0xafd9a63e,0x2ff62246
.long 0x2da8ada8,0xac722ea7,0x2a1faf64,0xa63e2fd9,0x2a1f2f64,0xad13ae2f,0x2ea72c72,0xafa8a8a5
.long 0xb0000000,0x2f64aa1f,0xada82da8,0x2a1faf64,0x2a1faf64,0x22462ff6,0xac72aea7,0x2f0e2b8b
.long 0x2da82da8,0xafd9a63e,0x2f64aa1f,0xac722ea7,0xaf642a1f,0x2b8baf0e,0x263e2fd9,0xae2fad13
.long 0x0000b000,0x2da82da8,0xb0000000,0x2da8ada8,0x2f642a1f,0xaf0e2b8b,0x263eafd9,0x2d132e2f
.long 0xada82da8,0xa63eafd9,0x2f642a1f,0xaea72c72,0xaa1faf64,0x2ff62246,0xac722ea7,0xab8baf0e
.long 0x30000000,0xaa1f2f64,0xada8ada8,0x2f64aa1f,0xaa1f2f64,0xae2fad13,0x2ea7ac72,0x28a52fa8
.long 0xada8ada8,0x2ea7ac72,0x2a1f2f64,0xafd9263e,0x2f64aa1f,0x28a52fa8,0xafd9263e,0xa246aff6
.long 0x00003000,0x0000b000,0x00003000,0x0000b000,0xb0000000,0x2ff6a246,0xafd9263e,0x2fa8a8a5
.long 0x0000b000,0x263e2fd9,0xaa1faf64,0x2c722ea7,0x30000000,0xafa828a5,0x2ea7ac72,0xad132e2f
.long 0x00003000,0xaa1faf64,0x2da82da8,0xaf64aa1f,0xb0000000,0x2f0eab8b,0xac722ea7,0x2246aff6
.long 0x0000b000,0x2c722ea7,0xaf64aa1f,0x2fd9a63e,0x30000000,0xae2f2d13,0x263eafd9,0x2b8b2f0e
.long 0x00003000,0xada8ada8,0x30000000,0xada82da8,0xb0000000,0x2d13ae2f,0x263e2fd9,0xaf0eab8b
.long 0x0000b000,0x2ea72c72,0xaf642a1f,0x263eafd9,0x30000000,0xab8b2f0e,0xac72aea7,0x2ff6a246
.long 0x00003000,0xaf64aa1f,0x2da8ada8,0x2a1f2f64,0xb0000000,0x28a5afa8,0x2ea72c72,0xae2f2d13
.long 0x0000b000,0x2fd9263e,0xaa1f2f64,0xaea7ac72,0x30000000,0xa2462ff6,0xafd9a63e,0x28a5afa8
.long 0x00003000,0x0000b000,0x00003000,0x0000b000,0xaf642a1f,0x2f0eab8b,0xaea72c72,0x2e2fad13
.long 0xada8ada8,0x2ea72c72,0xaf64aa1f,0x2fd9263e,0x2a1faf64,0xa2462ff6,0xa63eafd9,0x2b8b2f0e
.long 0x30000000,0xaf642a1f,0x2da8ada8,0xaa1f2f64,0x2a1f2f64,0xae2fad13,0x2fd9263e,0xafa828a5
.long 0xada82da8,0x263eafd9,0x2a1f2f64,0xaea7ac72,0xaf64aa1f,0x2fa8a8a5,0xac722ea7,0xa246aff6
.long 0x0000b000,0x2da82da8,0xb0000000,0x2da8ada8,0x2f64aa1f,0xa8a52fa8,0xac72aea7,0x2ff62246
.long 0x2da82da8,0xafd9263e,0x2a1faf64,0x2c722ea7,0xaa1f2f64,0xad13ae2f,0x2fd9a63e,0xa8a52fa8
.long 0xb0000000,0x2a1faf64,0x2da82da8,0xaf642a1f,0xaa1faf64,0x2ff6a246,0xa63e2fd9,0xaf0eab8b
.long 0x2da8ada8,0x2c722ea7,0xaf642a1f,0xa63eafd9,0x2f642a1f,0xab8b2f0e,0xaea7ac72,0x2d13ae2f
.long 0x00003000,0x0000b000,0x00003000,0x0000b000,0xada82da8,0x2d13ae2f,0xac722ea7,0x2b8baf0e
.long 0xb0000000,0x2fd9a63e,0xaf642a1f,0x2ea7ac72,0xada8ada8,0x2f0e2b8b,0xafd9a63e,0x2ff6a246
.long 0x0000b000,0x2a1f2f64,0xada8ada8,0x2f642a1f,0x2da8ada8,0xa8a52fa8,0xa63eafd9,0x2d132e2f
.long 0x30000000,0xaea72c72,0x2a1faf64,0x263e2fd9,0x2da82da8,0xaff6a246,0x2ea7ac72,0xa8a52fa8
.long 0x00003000,0xada8ada8,0x30000000,0xada82da8,0xada82da8,0xa246aff6,0x2ea72c72,0xafa828a5
.long 0xb0000000,0x2c72aea7,0x2a1f2f64,0xafd9a63e,0xada8ada8,0x2fa8a8a5,0xa63e2fd9,0xae2fad13
.long 0x0000b000,0x2f642a1f,0xada82da8,0xaa1faf64,0x2da8ada8,0x2b8b2f0e,0xafd9263e,0x2246aff6
.long 0x30000000,0xa63e2fd9,0xaf64aa1f,0x2c72aea7,0x2da82da8,0xae2f2d13,0xac72aea7,0x2f0eab8b
.long 0x00003000,0x0000b000,0x00003000,0x0000b000,0xaa1f2f64,0x28a5afa8,0xa63e2fd9,0x2246aff6
.long 0xada82da8,0x2c72aea7,0xaa1f2f64,0x263eafd9,0xaf642a1f,0x2e2fad13,0xac722ea7,0x28a5afa8
.long 0xb0000000,0x2f64aa1f,0xada82da8,0x2a1faf64,0xaf64aa1f,0x2ff6a246,0xaea72c72,0x2b8baf0e
.long 0xada8ada8,0x2fd9263e,0xaf642a1f,0x2c72aea7,0xaa1faf64,0x2f0e2b8b,0xafd9263e,0x2d13ae2f
.long 0x0000b000,0x2da82da8,0xb0000000,0x2da8ada8,0x2a1faf64,0x2b8b2f0e,0xafd9a63e,0x2e2fad13
.long 0x2da8ada8,0x263e2fd9,0xaf64aa1f,0x2ea7ac72,0x2f64aa1f,0xa2462ff6,0xaea7ac72,0x2f0eab8b
.long 0x30000000,0xaa1f2f64,0xada8ada8,0x2f64aa1f,0x2f642a1f,0xad132e2f,0xac72aea7,0x2fa8a8a5
.long 0x2da82da8,0xaea72c72,0xaa1faf64,0x2fd9a63e,0x2a1f2f64,0xafa828a5,0xa63eafd9,0x2ff6a246
.long 0x00003000,0xb0000000,0x0000b000,0x30000000,0x00003000,0xaff62246,0xa63eafd9,0x2fa8a8a5
.long 0x00003000,0xafd9263e,0xaa1faf64,0x2ea7ac72,0x00003000,0xafa828a5,0xac72aea7,0x2d13ae2f
.long 0x00003000,0xaf642a1f,0xada8ada8,0x2a1faf64,0x00003000,0xaf0e2b8b,0xaea7ac72,0x2246aff6
.long 0x00003000,0xaea72c72,0xaf64aa1f,0xa63eafd9,0x00003000,0xae2f2d13,0xafd9a63e,0xab8baf0e
.long 0x00003000,0xada82da8,0xb0000000,0xada8ada8,0x00003000,0xad132e2f,0xafd9263e,0xaf0eab8b
.long 0x00003000,0xac722ea7,0xaf642a1f,0xafd9a63e,0x00003000,0xab8b2f0e,0xaea72c72,0xaff62246
.long 0x00003000,0xaa1f2f64,0xada82da8,0xaf642a1f,0x00003000,0xa8a52fa8,0xac722ea7,0xae2f2d13
.long 0x00003000,0xa63e2fd9,0xaa1f2f64,0xac722ea7,0x00003000,0xa2462ff6,0xa63e2fd9,0xa8a52fa8
.long 0x00003000,0xb0000000,0x0000b000,0x30000000,0x2a1f2f64,0xaf0e2b8b,0xac72aea7,0x2e2fad13
.long 0x2da82da8,0xac722ea7,0xaf64aa1f,0x263eafd9,0x2f642a1f,0xa2462ff6,0xafd9263e,0xab8baf0e
.long 0x30000000,0x2a1f2f64,0xada82da8,0xaf64aa1f,0x2f64aa1f,0x2e2f2d13,0xa63e2fd9,0xafa828a5
.long 0x2da8ada8,0x2fd9263e,0x2a1f2f64,0xac722ea7,0x2a1faf64,0x2fa8a8a5,0x2ea72c72,0x22462ff6
.long 0x0000b000,0x2da8ada8,0x30000000,0x2da82da8,0xaa1faf64,0x28a5afa8,0x2ea7ac72,0x2ff62246
.long 0xada8ada8,0xa63eafd9,0x2a1faf64,0x2ea7ac72,0xaf64aa1f,0xad13ae2f,0xa63eafd9,0x28a5afa8
.long 0xb0000000,0xaf64aa1f,0xada8ada8,0xaa1faf64,0xaf642a1f,0xaff62246,0xafd9a63e,0xaf0eab8b
.long 0xada82da8,0xaea72c72,0xaf642a1f,0xafd9263e,0xaa1f2f64,0xab8b2f0e,0xac722ea7,0xad132e2f
.long 0x00003000,0xb0000000,0x0000b000,0x30000000,0x2da82da8,0xad132e2f,0xaea7ac72,0x2b8baf0e
.long 0x30000000,0x263e2fd9,0xaf642a1f,0xac72aea7,0x2da8ada8,0x2f0e2b8b,0xa63e2fd9,0xaff62246
.long 0x0000b000,0x2f64aa1f,0x2da82da8,0xaa1f2f64,0xada8ada8,0x28a5afa8,0x2fd9a63e,0x2d132e2f
.long 0xb0000000,0xac72aea7,0x2a1faf64,0x2fd9a63e,0xada82da8,0xaff6a246,0xac72aea7,0x28a5afa8
.long 0x00003000,0xada82da8,0xb0000000,0xada8ada8,0x2da82da8,0x22462ff6,0xac722ea7,0xafa828a5
.long 0x30000000,0x2ea72c72,0x2a1f2f64,0xa63e2fd9,0x2da8ada8,0x2fa8a8a5,0x2fd9263e,0x2e2f2d13
.long 0x0000b000,0x2a1faf64,0x2da8ada8,0x2f64aa1f,0xada8ada8,0xab8baf0e,0xa63eafd9,0x2246aff6
.long 0xb0000000,0xafd9a63e,0xaf64aa1f,0xaea7ac72,0xada82da8,0xae2f2d13,0xaea72c72,0xaf0e2b8b
.long 0x00003000,0xb0000000,0x0000b000,0x30000000,0x2f642a1f,0xa8a52fa8,0xafd9a63e,0x2246aff6
.long 0x2da8ada8,0x2ea72c72,0xaa1f2f64,0xafd9a63e,0xaa1faf64,0x2e2fad13,0x2ea72c72,0xa8a52fa8
.long 0xb0000000,0xaa1faf64,0x2da8ada8,0x2f642a1f,0xaa1f2f64,0xaff62246,0xac72aea7,0x2b8baf0e
.long 0x2da82da8,0xa63e2fd9,0xaf642a1f,0xaea7ac72,0x2f64aa1f,0x2f0e2b8b,0x263e2fd9,0xad132e2f
.long 0x0000b000,0x2da8ada8,0x30000000,0x2da82da8,0xaf64aa1f,0xab8baf0e,0x263eafd9,0x2e2fad13
.long 0xada82da8,0xafd9263e,0xaf64aa1f,0xac72aea7,0x2a1f2f64,0xa2462ff6,0xac722ea7,0xaf0e2b8b
.long 0x30000000,0x2f642a1f,0x2da82da8,0x2a1f2f64,0x2a1faf64,0x2d13ae2f,0x2ea7ac72,0x2fa8a8a5
.long 0xada8ada8,0xac72aea7,0xaa1faf64,0xa63eafd9,0xaf642a1f,0xafa828a5,0xafd9263e,0xaff62246
.long 0x00003000,0xb0000000,0x0000b000,0x30000000,0x30000000,0x22462ff6,0xafd9263e,0xa8a5afa8
.long 0x0000b000,0x2fd9a63e,0x2a1f2f64,0xaea72c72,0xb0000000,0xa8a5afa8,0x2ea7ac72,0x2e2f2d13
.long 0x00003000,0xaf642a1f,0xada8ada8,0x2a1faf64,0x30000000,0x2b8b2f0e,0xac722ea7,0xaff6a246
.long 0x0000b000,0x2ea7ac72,0x2f642a1f,0x263e2fd9,0xb0000000,0xad13ae2f,0x263eafd9,0x2f0eab8b
.long 0x00003000,0xada82da8,0xb0000000,0xada8ada8,0x30000000,0x2e2f2d13,0x263e2fd9,0xab8b2f0e
.long 0x0000b000,0x2c72aea7,0x2f64aa1f,0x2fd9263e,0xb0000000,0xaf0eab8b,0xac72aea7,0xa246aff6
.long 0x00003000,0xaa1f2f64,0xada82da8,0xaf642a1f,0x30000000,0x2fa828a5,0x2ea72c72,0x2d132e2f
.long 0x0000b000,0x263eafd9,0x2a1faf64,0x2c72aea7,0xb0000000,0xaff6a246,0xafd9a63e,0xafa8a8a5
.long 0x00003000,0xb0000000,0x0000b000,0x30000000,0x2f64aa1f,0x2b8b2f0e,0xaea72c72,0xad13ae2f
.long 0xada8ada8,0x2c72aea7,0x2f642a1f,0xa63e2fd9,0xaa1f2f64,0xaff6a246,0xa63eafd9,0x2f0eab8b
.long 0x30000000,0x2a1f2f64,0xada82da8,0xaf64aa1f,0xaa1faf64,0x2d13ae2f,0x2fd9263e,0x28a52fa8
.long 0xada82da8,0xafd9a63e,0xaa1faf64,0x2c72aea7,0x2f642a1f,0x28a52fa8,0xac722ea7,0xaff62246
.long 0x0000b000,0x2da8ada8,0x30000000,0x2da82da8,0xaf642a1f,0xafa8a8a5,0xac72aea7,0x2246aff6
.long 0x2da82da8,0x263e2fd9,0xaa1f2f64,0xaea72c72,0x2a1faf64,0x2e2fad13,0x2fd9a63e,0x2fa828a5
.long 0xb0000000,0xaf64aa1f,0xada8ada8,0xaa1faf64,0x2a1f2f64,0x22462ff6,0xa63e2fd9,0xab8b2f0e
.long 0x2da8ada8,0x2ea7ac72,0x2f64aa1f,0x2fd9a63e,0xaf64aa1f,0xaf0eab8b,0xaea7ac72,0xae2fad13
.long 0x00003000,0xb0000000,0x0000b000,0x30000000,0x2da8ada8,0x2e2f2d13,0xac722ea7,0xaf0eab8b
.long 0xb0000000,0xa63eafd9,0x2f64aa1f,0x2c722ea7,0x2da82da8,0xab8b2f0e,0xafd9a63e,0xa246aff6
.long 0x0000b000,0x2f64aa1f,0x2da82da8,0xaa1f2f64,0xada82da8,0xafa8a8a5,0xa63eafd9,0x2e2fad13
.long 0x30000000,0x2c722ea7,0xaa1f2f64,0xafd9263e,0xada8ada8,0x2246aff6,0x2ea7ac72,0x2fa828a5
.long 0x00003000,0xada82da8,0xb0000000,0xada8ada8,0x2da8ada8,0x2ff6a246,0x2ea72c72,0x28a52fa8
.long 0xb0000000,0xaea7ac72,0xaa1faf64,0x263eafd9,0x2da82da8,0x28a52fa8,0xa63e2fd9,0xad132e2f
.long 0x0000b000,0x2a1faf64,0x2da8ada8,0x2f64aa1f,0xada82da8,0xaf0e2b8b,0xafd9263e,0xaff6a246
.long 0x30000000,0x2fd9263e,0x2f642a1f,0x2ea72c72,0xada8ada8,0xad13ae2f,0xac72aea7,0xab8baf0e
.long 0x00003000,0xb0000000,0x0000b000,0x30000000,0x2a1faf64,0x2fa828a5,0xa63e2fd9,0xaff6a246
.long 0xada82da8,0xaea7ac72,0x2a1faf64,0x2fd9263e,0x2f64aa1f,0x2d132e2f,0xac722ea7,0xafa8a8a5
.long 0xb0000000,0xaa1faf64,0x2da8ada8,0x2f642a1f,0x2f642a1f,0x22462ff6,0xaea72c72,0xaf0eab8b
.long 0xada8ada8,0x263eafd9,0x2f64aa1f,0x2ea72c72,0x2a1f2f64,0xab8b2f0e,0xafd9263e,0xae2fad13
.long 0x0000b000,0x2da8ada8,0x30000000,0x2da82da8,0xaa1f2f64,0xaf0e2b8b,0xafd9a63e,0xad13ae2f
.long 0x2da8ada8,0x2fd9a63e,0x2f642a1f,0x2c722ea7,0xaf642a1f,0xaff6a246,0xaea7ac72,0xab8baf0e
.long 0x30000000,0x2f642a1f,0x2da82da8,0x2a1f2f64,0xaf64aa1f,0xae2fad13,0xac72aea7,0xa8a5afa8
.long 0x2da82da8,0x2c722ea7,0x2a1f2f64,0x263e2fd9,0xaa1faf64,0xa8a5afa8,0xa63eafd9,0xa246aff6
.long 0x00003000,0xb0000000,0x0000b000,0x30000000,0x0000b000,0x2ff6a246,0x263e2fd9,0xafa828a5
.long 0x00003000,0xafd9263e,0xaa1faf64,0x2ea7ac72,0x0000b000,0x2fa8a8a5,0x2c722ea7,0xad132e2f
.long 0x00003000,0xaf642a1f,0xada8ada8,0x2a1faf64,0x0000b000,0x2f0eab8b,0x2ea72c72,0xa2462ff6
.long 0x00003000,0xaea72c72,0xaf64aa1f,0xa63eafd9,0x0000b000,0x2e2fad13,0x2fd9263e,0x2b8b2f0e
.long 0x00003000,0xada82da8,0xb0000000,0xada8ada8,0x0000b000,0x2d13ae2f,0x2fd9a63e,0x2f0e2b8b
.long 0x00003000,0xac722ea7,0xaf642a1f,0xafd9a63e,0x0000b000,0x2b8baf0e,0x2ea7ac72,0x2ff6a246
.long 0x00003000,0xaa1f2f64,0xada82da8,0xaf642a1f,0x0000b000,0x28a5afa8,0x2c72aea7,0x2e2fad13
.long 0x00003000,0xa63e2fd9,0xaa1f2f64,0xac722ea7,0x0000b000,0x2246aff6,0x263eafd9,0x28a5afa8
.long 0x00003000,0xb0000000,0x0000b000,0x30000000,0xaa1faf64,0x2f0eab8b,0x2c722ea7,0xae2f2d13
.long 0x2da82da8,0xac722ea7,0xaf64aa1f,0x263eafd9,0xaf64aa1f,0x2246aff6,0x2fd9a63e,0x2b8b2f0e
.long 0x30000000,0x2a1f2f64,0xada82da8,0xaf64aa1f,0xaf642a1f,0xae2fad13,0x263eafd9,0x2fa8a8a5
.long 0x2da8ada8,0x2fd9263e,0x2a1f2f64,0xac722ea7,0xaa1f2f64,0xafa828a5,0xaea7ac72,0xa246aff6
.long 0x0000b000,0x2da8ada8,0x30000000,0x2da82da8,0x2a1f2f64,0xa8a52fa8,0xaea72c72,0xaff6a246
.long 0xada8ada8,0xa63eafd9,0x2a1faf64,0x2ea7ac72,0x2f642a1f,0x2d132e2f,0x263e2fd9,0xa8a52fa8
.long 0xb0000000,0xaf64aa1f,0xada8ada8,0xaa1faf64,0x2f64aa1f,0x2ff6a246,0x2fd9263e,0x2f0e2b8b
.long 0xada82da8,0xaea72c72,0xaf642a1f,0xafd9263e,0x2a1faf64,0x2b8baf0e,0x2c72aea7,0x2d13ae2f
.long 0x00003000,0xb0000000,0x0000b000,0x30000000,0xada8ada8,0x2d13ae2f,0x2ea72c72,0xab8b2f0e
.long 0x30000000,0x263e2fd9,0xaf642a1f,0xac72aea7,0xada82da8,0xaf0eab8b,0x263eafd9,0x2ff6a246
.long 0x0000b000,0x2f64aa1f,0x2da82da8,0xaa1f2f64,0x2da82da8,0xa8a52fa8,0xafd9263e,0xad13ae2f
.long 0xb0000000,0xac72aea7,0x2a1faf64,0x2fd9a63e,0x2da8ada8,0x2ff62246,0x2c722ea7,0xa8a52fa8
.long 0x00003000,0xada82da8,0xb0000000,0xada8ada8,0xada8ada8,0xa246aff6,0x2c72aea7,0x2fa8a8a5
.long 0x30000000,0x2ea72c72,0x2a1f2f64,0xa63e2fd9,0xada82da8,0xafa828a5,0xafd9a63e,0xae2fad13
.long 0x0000b000,0x2a1faf64,0x2da8ada8,0x2f64aa1f,0x2da82da8,0x2b8b2f0e,0x263e2fd9,0xa2462ff6
.long 0xb0000000,0xafd9a63e,0xaf64aa1f,0xaea7ac72,0x2da8ada8,0x2e2fad13,0x2ea7ac72,0x2f0eab8b
.long 0x00003000,0xb0000000,0x0000b000,0x30000000,0xaf64aa1f,0x28a5afa8,0x2fd9263e,0xa2462ff6
.long 0x2da8ada8,0x2ea72c72,0xaa1f2f64,0xafd9a63e,0x2a1f2f64,0xae2f2d13,0xaea7ac72,0x28a5afa8
.long 0xb0000000,0xaa1faf64,0x2da8ada8,0x2f642a1f,0x2a1faf64,0x2ff6a246,0x2c722ea7,0xab8b2f0e
.long 0x2da82da8,0xa63e2fd9,0xaf642a1f,0xaea7ac72,0xaf642a1f,0xaf0eab8b,0xa63eafd9,0x2d13ae2f
.long 0x0000b000,0x2da8ada8,0x30000000,0x2da82da8,0x2f642a1f,0x2b8b2f0e,0xa63e2fd9,0xae2f2d13
.long 0xada82da8,0xafd9263e,0xaf64aa1f,0xac72aea7,0xaa1faf64,0x2246aff6,0x2c72aea7,0x2f0eab8b
.long 0x30000000,0x2f642a1f,0x2da82da8,0x2a1f2f64,0xaa1f2f64,0xad132e2f,0xaea72c72,0xafa828a5
.long 0xada8ada8,0xac72aea7,0xaa1faf64,0xa63eafd9,0x2f64aa1f,0x2fa8a8a5,0x2fd9a63e,0x2ff6a246
.long 0x00003000,0xb0000000,0x0000b000,0x30000000,0xb0000000,0xa246aff6,0x2fd9a63e,0x28a52fa8
.long 0x0000b000,0x2fd9a63e,0x2a1f2f64,0xaea72c72,0x30000000,0x28a52fa8,0xaea72c72,0xae2fad13
.long 0x00003000,0xaf642a1f,0xada8ada8,0x2a1faf64,0xb0000000,0xab8baf0e,0x2c72aea7,0x2ff62246
.long 0x0000b000,0x2ea7ac72,0x2f642a1f,0x263e2fd9,0x30000000,0x2d132e2f,0xa63e2fd9,0xaf0e2b8b
.long 0x00003000,0xada82da8,0xb0000000,0xada8ada8,0xb0000000,0xae2fad13,0xa63eafd9,0x2b8baf0e
.long 0x0000b000,0x2c72aea7,0x2f64aa1f,0x2fd9263e,0x30000000,0x2f0e2b8b,0x2c722ea7,0x22462ff6
.long 0x00003000,0xaa1f2f64,0xada82da8,0xaf642a1f,0xb0000000,0xafa8a8a5,0xaea7ac72,0xad13ae2f
.long 0x0000b000,0x263eafd9,0x2a1faf64,0x2c72aea7,0x30000000,0x2ff62246,0x2fd9263e,0x2fa828a5
.long 0x00003000,0xb0000000,0x0000b000,0x30000000,0xaf642a1f,0xab8baf0e,0x2ea7ac72,0x2d132e2f
.long 0xada8ada8,0x2c72aea7,0x2f642a1f,0xa63e2fd9,0x2a1faf64,0x2ff62246,0x263e2fd9,0xaf0e2b8b
.long 0x30000000,0x2a1f2f64,0xada82da8,0xaf64aa1f,0x2a1f2f64,0xad132e2f,0xafd9a63e,0xa8a5afa8
.long 0xada82da8,0xafd9a63e,0xaa1faf64,0x2c72aea7,0xaf64aa1f,0xa8a5afa8,0x2c72aea7,0x2ff6a246
.long 0x0000b000,0x2da8ada8,0x30000000,0x2da82da8,0x2f64aa1f,0x2fa828a5,0x2c722ea7,0xa2462ff6
.long 0x2da82da8,0x263e2fd9,0xaa1f2f64,0xaea72c72,0xaa1f2f64,0xae2f2d13,0xafd9263e,0xafa8a8a5
.long 0xb0000000,0xaf64aa1f,0xada8ada8,0xaa1faf64,0xaa1faf64,0xa246aff6,0x263eafd9,0x2b8baf0e
.long 0x2da8ada8,0x2ea7ac72,0x2f64aa1f,0x2fd9a63e,0x2f642a1f,0x2f0e2b8b,0x2ea72c72,0x2e2f2d13
.long 0x00003000,0xb0000000,0x0000b000,0x30000000,0xada82da8,0xae2fad13,0x2c72aea7,0x2f0e2b8b
.long 0xb0000000,0xa63eafd9,0x2f64aa1f,0x2c722ea7,0xada8ada8,0x2b8baf0e,0x2fd9263e,0x22462ff6
.long 0x0000b000,0x2f64aa1f,0x2da82da8,0xaa1f2f64,0x2da8ada8,0x2fa828a5,0x263e2fd9,0xae2f2d13
.long 0x30000000,0x2c722ea7,0xaa1f2f64,0xafd9263e,0x2da82da8,0xa2462ff6,0xaea72c72,0xafa8a8a5
.long 0x00003000,0xada82da8,0xb0000000,0xada8ada8,0xada82da8,0xaff62246,0xaea7ac72,0xa8a5afa8
.long 0xb0000000,0xaea7ac72,0xaa1faf64,0x263eafd9,0xada8ada8,0xa8a5afa8,0x263eafd9,0x2d13ae2f
.long 0x0000b000,0x2a1faf64,0x2da8ada8,0x2f64aa1f,0x2da8ada8,0x2f0eab8b,0x2fd9a63e,0x2ff62246
.long 0x30000000,0x2fd9263e,0x2f642a1f,0x2ea72c72,0x2da82da8,0x2d132e2f,0x2c722ea7,0x2b8b2f0e
.long 0x00003000,0xb0000000,0x0000b000,0x30000000,0xaa1f2f64,0xafa8a8a5,0x263eafd9,0x2ff62246
.long 0xada82da8,0xaea7ac72,0x2a1faf64,0x2fd9263e,0xaf642a1f,0xad13ae2f,0x2c72aea7,0x2fa828a5
.long 0xb0000000,0xaa1faf64,0x2da8ada8,0x2f642a1f,0xaf64aa1f,0xa246aff6,0x2ea7ac72,0x2f0e2b8b
.long 0xada8ada8,0x263eafd9,0x2f64aa1f,0x2ea72c72,0xaa1faf64,0x2b8baf0e,0x2fd9a63e,0x2e2f2d13
.long 0x0000b000,0x2da8ada8,0x30000000,0x2da82da8,0x2a1faf64,0x2f0eab8b,0x2fd9263e,0x2d132e2f
.long 0x2da8ada8,0x2fd9a63e,0x2f642a1f,0x2c722ea7,0x2f64aa1f,0x2ff62246,0x2ea72c72,0x2b8b2f0e
.long 0x30000000,0x2f642a1f,0x2da82da8,0x2a1f2f64,0x2f642a1f,0x2e2f2d13,0x2c722ea7,0x28a52fa8
.long 0x2da82da8,0x2c722ea7,0x2a1f2f64,0x263e2fd9,0x2a1f2f64,0x28a52fa8,0x263e2fd9,0x22462ff6
.long 0x00003400,0x00003400,0x00003400,0x00003400,0x00003400,0x2a3e33d9,0x2e1f3364,0x307232a7
.long 0x00003400,0x2e1f3364,0x31a831a8,0x33642e1f,0x00003400,0x307232a7,0x33642e1f,0x33d9aa3e
.long 0x00003400,0x31a831a8,0x34000000,0x31a8b1a8,0x00003400,0x32a73072,0x3364ae1f,0x2a3eb3d9
.long 0x00003400,0x33642e1f,0x31a8b1a8,0xae1fb364,0x00003400,0x33d92a3e,0x2e1fb364,0xb2a7b072
.long 0x00003400,0x34000000,0x0000b400,0xb4000000,0x00003400,0x33d9aa3e,0xae1fb364,0xb2a73072
.long 0x00003400,0x3364ae1f,0xb1a8b1a8,0xae1f3364,0x00003400,0x32a7b072,0xb364ae1f,0x2a3e33d9
.long 0x00003400,0x31a8b1a8,0xb4000000,0x31a831a8,0x00003400,0x3072b2a7,0xb3642e1f,0x33d92a3e
.long 0x00003400,0x2e1fb364,0xb1a831a8,0x3364ae1f,0x00003400,0x2a3eb3d9,0xae1f3364,0x3072b2a7
.long 0x00003400,0x00003400,0x00003400,0x00003400,0x31a831a8,0x32a73072,0x33642e1f,0x33d92a3e
.long 0x34000000,0x3364ae1f,0x31a8b1a8,0x2e1fb364,0x31a8b1a8,0x2a3eb3d9,0xae1fb364,0xb2a7b072
.long 0x0000b400,0xb1a8b1a8,0xb4000000,0xb1a831a8,0xb1a8b1a8,0xb3d92a3e,0xae1f3364,0x307232a7
.long 0xb4000000,0xae1f3364,0x31a831a8,0x3364ae1f,0xb1a831a8,0x307232a7,0x3364ae1f,0xaa3eb3d9
.long 0x00003400,0x34000000,0x0000b400,0xb4000000,0x31a831a8,0x3072b2a7,0xb364ae1f,0xaa3e33d9
.long 0x34000000,0xae1fb364,0xb1a831a8,0x33642e1f,0x31a8b1a8,0xb3d9aa3e,0x2e1f3364,0x3072b2a7
.long 0x0000b400,0xb1a831a8,0x34000000,0xb1a8b1a8,0xb1a8b1a8,0x2a3e33d9,0x2e1fb364,0xb2a73072
.long 0xb4000000,0x33642e1f,0xb1a8b1a8,0x2e1f3364,0xb1a831a8,0x32a7b072,0xb3642e1f,0x33d9aa3e
.long 0x00003400,0x00003400,0x00003400,0x00003400,0x34000000,0x33d9aa3e,0x3364ae1f,0x32a7b072
.long 0x0000b400,0xae1fb364,0xb1a8b1a8,0xb364ae1f,0xb4000000,0xb2a73072,0xae1f3364,0x2a3e33d9
.long 0x00003400,0x31a831a8,0x34000000,0x31a8b1a8,0x34000000,0x3072b2a7,0xae1fb364,0xb3d9aa3e
.long 0x0000b400,0xb364ae1f,0xb1a831a8,0x2e1f3364,0xb4000000,0xaa3e33d9,0x33642e1f,0x3072b2a7
.long 0x00003400,0x34000000,0x0000b400,0xb4000000,0x34000000,0xaa3eb3d9,0xb3642e1f,0x307232a7
.long 0x0000b400,0xb3642e1f,0x31a831a8,0x2e1fb364,0xb4000000,0x307232a7,0x2e1fb364,0xb3d92a3e
.long 0x00003400,0x31a8b1a8,0xb4000000,0x31a831a8,0x34000000,0xb2a7b072,0x2e1f3364,0x2a3eb3d9
.long 0x0000b400,0xae1f3364,0x31a8b1a8,0xb3642e1f,0xb4000000,0x33d92a3e,0xb364ae1f,0x32a73072
.long 0x00003400,0x00003400,0x00003400,0x00003400,0x31a8b1a8,0x3072b2a7,0x2e1fb364,0x2a3eb3d9
.long 0xb4000000,0xb3642e1f,0xb1a831a8,0xae1f3364,0x31a831a8,0x33d92a3e,0x3364ae1f,0x3072b2a7
.long 0x0000b400,0xb1a8b1a8,0xb4000000,0xb1a831a8,0xb1a831a8,0x2a3e33d9,0x33642e1f,0x32a7b072
.long 0x34000000,0x2e1fb364,0xb1a8b1a8,0xb3642e1f,0xb1a8b1a8,0xb2a73072,0x2e1f3364,0x33d9aa3e
.long 0x00003400,0x34000000,0x0000b400,0xb4000000,0x31a8b1a8,0xb2a7b072,0xae1f3364,0x33d92a3e
.long 0xb4000000,0x2e1f3364,0x31a8b1a8,0xb364ae1f,0x31a831a8,0x2a3eb3d9,0xb3642e1f,0x32a73072
.long 0x0000b400,0xb1a831a8,0x34000000,0xb1a8b1a8,0xb1a831a8,0x33d9aa3e,0xb364ae1f,0x307232a7
.long 0x34000000,0xb364ae1f,0x31a831a8,0xae1fb364,0xb1a8b1a8,0x307232a7,0xae1fb364,0x2a3e33d9
.long 0x00003400,0x00003400,0x00003400,0x00003400,0x0000b400,0xaa3eb3d9,0xae1fb364,0xb072b2a7
.long 0x00003400,0x2e1f3364,0x31a831a8,0x33642e1f,0x0000b400,0xb072b2a7,0xb364ae1f,0xb3d92a3e
.long 0x00003400,0x31a831a8,0x34000000,0x31a8b1a8,0x0000b400,0xb2a7b072,0xb3642e1f,0xaa3e33d9
.long 0x00003400,0x33642e1f,0x31a8b1a8,0xae1fb364,0x0000b400,0xb3d9aa3e,0xae1f3364,0x32a73072
.long 0x00003400,0x34000000,0x0000b400,0xb4000000,0x0000b400,0xb3d92a3e,0x2e1f3364,0x32a7b072
.long 0x00003400,0x3364ae1f,0xb1a8b1a8,0xae1f3364,0x0000b400,0xb2a73072,0x33642e1f,0xaa3eb3d9
.long 0x00003400,0x31a8b1a8,0xb4000000,0x31a831a8,0x0000b400,0xb07232a7,0x3364ae1f,0xb3d9aa3e
.long 0x00003400,0x2e1fb364,0xb1a831a8,0x3364ae1f,0x0000b400,0xaa3e33d9,0x2e1fb364,0xb07232a7
.long 0x00003400,0x00003400,0x00003400,0x00003400,0xb1a8b1a8,0xb2a7b072,0xb364ae1f,0xb3d9aa3e
.long 0x34000000,0x3364ae1f,0x31a8b1a8,0x2e1fb364,0xb1a831a8,0xaa3e33d9,0x2e1f3364,0x32a73072
.long 0x0000b400,0xb1a8b1a8,0xb4000000,0xb1a831a8,0x31a831a8,0x33d9aa3e,0x2e1fb364,0xb072b2a7
.long 0xb4000000,0xae1f3364,0x31a831a8,0x3364ae1f,0x31a8b1a8,0xb072b2a7,0xb3642e1f,0x2a3e33d9
.long 0x00003400,0x34000000,0x0000b400,0xb4000000,0xb1a8b1a8,0xb07232a7,0x33642e1f,0x2a3eb3d9
.long 0x34000000,0xae1fb364,0xb1a831a8,0x33642e1f,0xb1a831a8,0x33d92a3e,0xae1fb364,0xb07232a7
.long 0x0000b400,0xb1a831a8,0x34000000,0xb1a8b1a8,0x31a831a8,0xaa3eb3d9,0xae1f3364,0x32a7b072
.long 0xb4000000,0x33642e1f,0xb1a8b1a8,0x2e1f3364,0x31a8b1a8,0xb2a73072,0x3364ae1f,0xb3d92a3e
.long 0x00003400,0x00003400,0x00003400,0x00003400,0xb4000000,0xb3d92a3e,0xb3642e1f,0xb2a73072
.long 0x0000b400,0xae1fb364,0xb1a8b1a8,0xb364ae1f,0x34000000,0x32a7b072,0x2e1fb364,0xaa3eb3d9
.long 0x00003400,0x31a831a8,0x34000000,0x31a8b1a8,0xb4000000,0xb07232a7,0x2e1f3364,0x33d92a3e
.long 0x0000b400,0xb364ae1f,0xb1a831a8,0x2e1f3364,0x34000000,0x2a3eb3d9,0xb364ae1f,0xb07232a7
.long 0x00003400,0x34000000,0x0000b400,0xb4000000,0xb4000000,0x2a3e33d9,0x3364ae1f,0xb072b2a7
.long 0x0000b400,0xb3642e1f,0x31a831a8,0x2e1fb364,0x34000000,0xb072b2a7,0xae1f3364,0x33d9aa3e
.long 0x00003400,0x31a8b1a8,0xb4000000,0x31a831a8,0xb4000000,0x32a73072,0xae1fb364,0xaa3e33d9
.long 0x0000b400,0xae1f3364,0x31a8b1a8,0xb3642e1f,0x34000000,0xb3d9aa3e,0x33642e1f,0xb2a7b072
.long 0x00003400,0x00003400,0x00003400,0x00003400,0xb1a831a8,0xb07232a7,0xae1f3364,0xaa3e33d9
.long 0xb4000000,0xb3642e1f,0xb1a831a8,0xae1f3364,0xb1a8b1a8,0xb3d9aa3e,0xb3642e1f,0xb07232a7
.long 0x0000b400,0xb1a8b1a8,0xb4000000,0xb1a831a8,0x31a8b1a8,0xaa3eb3d9,0xb364ae1f,0xb2a73072
.long 0x34000000,0x2e1fb364,0xb1a8b1a8,0xb3642e1f,0x31a831a8,0x32a7b072,0xae1fb364,0xb3d92a3e
.long 0x00003400,0x34000000,0x0000b400,0xb4000000,0xb1a831a8,0x32a73072,0x2e1fb364,0xb3d9aa3e
.long 0xb4000000,0x2e1f3364,0x31a8b1a8,0xb364ae1f,0xb1a8b1a8,0xaa3e33d9,0x3364ae1f,0xb2a7b072
.long 0x0000b400,0xb1a831a8,0x34000000,0xb1a8b1a8,0x31a8b1a8,0xb3d92a3e,0x33642e1f,0xb072b2a7
.long 0x34000000,0xb364ae1f,0x31a831a8,0xae1fb364,0x31a831a8,0xb072b2a7,0x2e1f3364,0xaa3eb3d9
.long 0x00003400,0x0000b400,0x00003400,0x0000b400,0x00003400,0xaa3eb3d9,0x2e1f3364,0xb072b2a7
.long 0x00003400,0xae1fb364,0x31a831a8,0xb364ae1f,0x00003400,0xb072b2a7,0x33642e1f,0xb3d92a3e
.long 0x00003400,0xb1a8b1a8,0x34000000,0xb1a831a8,0x00003400,0xb2a7b072,0x3364ae1f,0xaa3e33d9
.long 0x00003400,0xb364ae1f,0x31a8b1a8,0x2e1f3364,0x00003400,0xb3d9aa3e,0x2e1fb364,0x32a73072
.long 0x00003400,0xb4000000,0x0000b400,0x34000000,0x00003400,0xb3d92a3e,0xae1fb364,0x32a7b072
.long 0x00003400,0xb3642e1f,0xb1a8b1a8,0x2e1fb364,0x00003400,0xb2a73072,0xb364ae1f,0xaa3eb3d9
.long 0x00003400,0xb1a831a8,0xb4000000,0xb1a8b1a8,0x00003400,0xb07232a7,0xb3642e1f,0xb3d9aa3e
.long 0x00003400,0xae1f3364,0xb1a831a8,0xb3642e1f,0x00003400,0xaa3e33d9,0xae1f3364,0xb07232a7
.long 0x00003400,0x0000b400,0x00003400,0x0000b400,0x31a831a8,0xb2a7b072,0x33642e1f,0xb3d9aa3e
.long 0x34000000,0xb3642e1f,0x31a8b1a8,0xae1f3364,0x31a8b1a8,0xaa3e33d9,0xae1fb364,0x32a73072
.long 0x0000b400,0x31a831a8,0xb4000000,0x31a8b1a8,0xb1a8b1a8,0x33d9aa3e,0xae1f3364,0xb072b2a7
.long 0xb4000000,0x2e1fb364,0x31a831a8,0xb3642e1f,0xb1a831a8,0xb072b2a7,0x3364ae1f,0x2a3e33d9
.long 0x00003400,0xb4000000,0x0000b400,0x34000000,0x31a831a8,0xb07232a7,0xb364ae1f,0x2a3eb3d9
.long 0x34000000,0x2e1f3364,0xb1a831a8,0xb364ae1f,0x31a8b1a8,0x33d92a3e,0x2e1f3364,0xb07232a7
.long 0x0000b400,0x31a8b1a8,0x34000000,0x31a831a8,0xb1a8b1a8,0xaa3eb3d9,0x2e1fb364,0x32a7b072
.long 0xb4000000,0xb364ae1f,0xb1a8b1a8,0xae1fb364,0xb1a831a8,0xb2a73072,0xb3642e1f,0xb3d92a3e
.long 0x00003400,0x0000b400,0x00003400,0x0000b400,0x34000000,0xb3d92a3e,0x3364ae1f,0xb2a73072
.long 0x0000b400,0x2e1f3364,0xb1a8b1a8,0x33642e1f,0xb4000000,0x32a7b072,0xae1f3364,0xaa3eb3d9
.long 0x00003400,0xb1a8b1a8,0x34000000,0xb1a831a8,0x34000000,0xb07232a7,0xae1fb364,0x33d92a3e
.long 0x0000b400,0x33642e1f,0xb1a831a8,0xae1fb364,0xb4000000,0x2a3eb3d9,0x33642e1f,0xb07232a7
.long 0x00003400,0xb4000000,0x0000b400,0x34000000,0x34000000,0x2a3e33d9,0xb3642e1f,0xb072b2a7
.long 0x0000b400,0x3364ae1f,0x31a831a8,0xae1f3364,0xb4000000,0xb072b2a7,0x2e1fb364,0x33d9aa3e
.long 0x00003400,0xb1a831a8,0xb4000000,0xb1a8b1a8,0x34000000,0x32a73072,0x2e1f3364,0xaa3e33d9
.long 0x0000b400,0x2e1fb364,0x31a8b1a8,0x3364ae1f,0xb4000000,0xb3d9aa3e,0xb364ae1f,0xb2a7b072
.long 0x00003400,0x0000b400,0x00003400,0x0000b400,0x31a8b1a8,0xb07232a7,0x2e1fb364,0xaa3e33d9
.long 0xb4000000,0x3364ae1f,0xb1a831a8,0x2e1fb364,0x31a831a8,0xb3d9aa3e,0x3364ae1f,0xb07232a7
.long 0x0000b400,0x31a831a8,0xb4000000,0x31a8b1a8,0xb1a831a8,0xaa3eb3d9,0x33642e1f,0xb2a73072
.long 0x34000000,0xae1f3364,0xb1a8b1a8,0x3364ae1f,0xb1a8b1a8,0x32a7b072,0x2e1f3364,0xb3d92a3e
.long 0x00003400,0xb4000000,0x0000b400,0x34000000,0x31a8b1a8,0x32a73072,0xae1f3364,0xb3d9aa3e
.long 0xb4000000,0xae1fb364,0x31a8b1a8,0x33642e1f,0x31a831a8,0xaa3e33d9,0xb3642e1f,0xb2a7b072
.long 0x0000b400,0x31a8b1a8,0x34000000,0x31a831a8,0xb1a831a8,0xb3d92a3e,0xb364ae1f,0xb072b2a7
.long 0x34000000,0x33642e1f,0x31a831a8,0x2e1f3364,0xb1a8b1a8,0xb072b2a7,0xae1fb364,0xaa3eb3d9
.long 0x00003400,0x0000b400,0x00003400,0x0000b400,0x0000b400,0x2a3e33d9,0xae1fb364,0x307232a7
.long 0x00003400,0xae1fb364,0x31a831a8,0xb364ae1f,0x0000b400,0x307232a7,0xb364ae1f,0x33d9aa3e
.long 0x00003400,0xb1a8b1a8,0x34000000,0xb1a831a8,0x0000b400,0x32a73072,0xb3642e1f,0x2a3eb3d9
.long 0x00003400,0xb364ae1f,0x31a8b1a8,0x2e1f3364,0x0000b400,0x33d92a3e,0xae1f3364,0xb2a7b072
.long 0x00003400,0xb4000000,0x0000b400,0x34000000,0x0000b400,0x33d9aa3e,0x2e1f3364,0xb2a73072
.long 0x00003400,0xb3642e1f,0xb1a8b1a8,0x2e1fb364,0x0000b400,0x32a7b072,0x33642e1f,0x2a3e33d9
.long 0x00003400,0xb1a831a8,0xb4000000,0xb1a8b1a8,0x0000b400,0x3072b2a7,0x3364ae1f,0x33d92a3e
.long 0x00003400,0xae1f3364,0xb1a831a8,0xb3642e1f,0x0000b400,0x2a3eb3d9,0x2e1fb364,0x3072b2a7
.long 0x00003400,0x0000b400,0x00003400,0x0000b400,0xb1a8b1a8,0x32a73072,0xb364ae1f,0x33d92a3e
.long 0x34000000,0xb3642e1f,0x31a8b1a8,0xae1f3364,0xb1a831a8,0x2a3eb3d9,0x2e1f3364,0xb2a7b072
.long 0x0000b400,0x31a831a8,0xb4000000,0x31a8b1a8,0x31a831a8,0xb3d92a3e,0x2e1fb364,0x307232a7
.long 0xb4000000,0x2e1fb364,0x31a831a8,0xb3642e1f,0x31a8b1a8,0x307232a7,0xb3642e1f,0xaa3eb3d9
.long 0x00003400,0xb4000000,0x0000b400,0x34000000,0xb1a8b1a8,0x3072b2a7,0x33642e1f,0xaa3e33d9
.long 0x34000000,0x2e1f3364,0xb1a831a8,0xb364ae1f,0xb1a831a8,0xb3d9aa3e,0xae1fb364,0x3072b2a7
.long 0x0000b400,0x31a8b1a8,0x34000000,0x31a831a8,0x31a831a8,0x2a3e33d9,0xae1f3364,0xb2a73072
.long 0xb4000000,0xb364ae1f,0xb1a8b1a8,0xae1fb364,0x31a8b1a8,0x32a7b072,0x3364ae1f,0x33d9aa3e
.long 0x00003400,0x0000b400,0x00003400,0x0000b400,0xb4000000,0x33d9aa3e,0xb3642e1f,0x32a7b072
.long 0x0000b400,0x2e1f3364,0xb1a8b1a8,0x33642e1f,0x34000000,0xb2a73072,0x2e1fb364,0x2a3e33d9
.long 0x00003400,0xb1a8b1a8,0x34000000,0xb1a831a8,0xb4000000,0x3072b2a7,0x2e1f3364,0xb3d9aa3e
.long 0x0000b400,0x33642e1f,0xb1a831a8,0xae1fb364,0x34000000,0xaa3e33d9,0xb364ae1f,0x3072b2a7
.long 0x00003400,0xb4000000,0x0000b400,0x34000000,0xb4000000,0xaa3eb3d9,0x3364ae1f,0x307232a7
.long 0x0000b400,0x3364ae1f,0x31a831a8,0xae1f3364,0x34000000,0x307232a7,0xae1f3364,0xb3d92a3e
.long 0x00003400,0xb1a831a8,0xb4000000,0xb1a8b1a8,0xb4000000,0xb2a7b072,0xae1fb364,0x2a3eb3d9
.long 0x0000b400,0x2e1fb364,0x31a8b1a8,0x3364ae1f,0x34000000,0x33d92a3e,0x33642e1f,0x32a73072
.long 0x00003400,0x0000b400,0x00003400,0x0000b400,0xb1a831a8,0x3072b2a7,0xae1f3364,0x2a3eb3d9
.long 0xb4000000,0x3364ae1f,0xb1a831a8,0x2e1fb364,0xb1a8b1a8,0x33d92a3e,0xb3642e1f,0x3072b2a7
.long 0x0000b400,0x31a831a8,0xb4000000,0x31a8b1a8,0x31a8b1a8,0x2a3e33d9,0xb364ae1f,0x32a7b072
.long 0x34000000,0xae1f3364,0xb1a8b1a8,0x3364ae1f,0x31a831a8,0xb2a73072,0xae1fb364,0x33d9aa3e
.long 0x00003400,0xb4000000,0x0000b400,0x34000000,0xb1a831a8,0xb2a7b072,0x2e1fb364,0x33d92a3e
.long 0xb4000000,0xae1fb364,0x31a8b1a8,0x33642e1f,0xb1a8b1a8,0x2a3eb3d9,0x3364ae1f,0x32a73072
.long 0x0000b400,0x31a8b1a8,0x34000000,0x31a831a8,0x31a8b1a8,0x33d9aa3e,0x33642e1f,0x307232a7
.long 0x34000000,0x33642e1f,0x31a831a8,0x2e1f3364,0x31a831a8,0x307232a7,0x2e1f3364,0x2a3e33d9
.long 0x80003000,0x80003000,0x80003000,0x80003000,0x80003000,0xaa1f2f64,0xada82da8,0xaf642a1f
.long 0x80003000,0xada82da8,0xb0000000,0xada8ada8,0x80003000,0xaf642a1f,0xada8ada8,0x2a1faf64
.long 0x80003000,0xb0000000,0x8000b000,0x30000000,0x80003000,0xaf64aa1f,0x2da8ada8,0x2a1f2f64
.long 0x80003000,0xada8ada8,0x30000000,0xada82da8,0x80003000,0xaa1faf64,0x2da82da8,0xaf64aa1f
.long 0x80003000,0x8000b000,0x80003000,0x8000b000,0x80003000,0x2a1faf64,0xada82da8,0x2f64aa1f
.long 0x80003000,0x2da8ada8,0xb0000000,0x2da82da8,0x80003000,0x2f64aa1f,0xada8ada8,0xaa1f2f64
.long 0x80003000,0x30000000,0x8000b000,0xb0000000,0x80003000,0x2f642a1f,0x2da8ada8,0xaa1faf64
.long 0x80003000,0x2da82da8,0x30000000,0x2da8ada8,0x80003000,0x2a1f2f64,0x2da82da8,0x2f642a1f
.long 0x80003000,0x80003000,0x80003000,0x80003000,0xb0000000,0xaf64aa1f,0xada8ada8,0xaa1faf64
.long 0x8000b000,0x2da8ada8,0x30000000,0x2da82da8,0x30000000,0x2a1f2f64,0xada82da8,0xaf64aa1f
.long 0x80003000,0xb0000000,0x8000b000,0x30000000,0xb0000000,0x2a1faf64,0x2da82da8,0xaf642a1f
.long 0x8000b000,0x2da82da8,0xb0000000,0x2da8ada8,0x30000000,0xaf642a1f,0x2da8ada8,0xaa1f2f64
.long 0x80003000,0x8000b000,0x80003000,0x8000b000,0xb0000000,0x2f642a1f,0xada8ada8,0x2a1f2f64
.long 0x8000b000,0xada82da8,0x30000000,0xada8ada8,0x30000000,0xaa1faf64,0xada82da8,0x2f642a1f
.long 0x80003000,0x30000000,0x8000b000,0xb0000000,0xb0000000,0xaa1f2f64,0x2da82da8,0x2f64aa1f
.long 0x8000b000,0xada8ada8,0xb0000000,0xada82da8,0x30000000,0x2f64aa1f,0x2da8ada8,0x2a1faf64
.long 0x80003000,0x80003000,0x80003000,0x80003000,0x8000b000,0x2a1faf64,0x2da8ada8,0x2f64aa1f
.long 0x80003000,0xada82da8,0xb0000000,0xada8ada8,0x8000b000,0x2f64aa1f,0x2da82da8,0xaa1f2f64
.long 0x80003000,0xb0000000,0x8000b000,0x30000000,0x8000b000,0x2f642a1f,0xada82da8,0xaa1faf64
.long 0x80003000,0xada8ada8,0x30000000,0xada82da8,0x8000b000,0x2a1f2f64,0xada8ada8,0x2f642a1f
.long 0x80003000,0x8000b000,0x80003000,0x8000b000,0x8000b000,0xaa1f2f64,0x2da8ada8,0xaf642a1f
.long 0x80003000,0x2da8ada8,0xb0000000,0x2da82da8,0x8000b000,0xaf642a1f,0x2da82da8,0x2a1faf64
.long 0x80003000,0x30000000,0x8000b000,0xb0000000,0x8000b000,0xaf64aa1f,0xada82da8,0x2a1f2f64
.long 0x80003000,0x2da82da8,0x30000000,0x2da8ada8,0x8000b000,0xaa1faf64,0xada8ada8,0xaf64aa1f
.long 0x80003000,0x80003000,0x80003000,0x80003000,0x30000000,0x2f642a1f,0x2da82da8,0x2a1f2f64
.long 0x8000b000,0x2da8ada8,0x30000000,0x2da82da8,0xb0000000,0xaa1faf64,0x2da8ada8,0x2f642a1f
.long 0x80003000,0xb0000000,0x8000b000,0x30000000,0x30000000,0xaa1f2f64,0xada8ada8,0x2f64aa1f
.long 0x8000b000,0x2da82da8,0xb0000000,0x2da8ada8,0xb0000000,0x2f64aa1f,0xada82da8,0x2a1faf64
.long 0x80003000,0x8000b000,0x80003000,0x8000b000,0x30000000,0xaf64aa1f,0x2da82da8,0xaa1faf64
.long 0x8000b000,0xada82da8,0x30000000,0xada8ada8,0xb0000000,0x2a1f2f64,0x2da8ada8,0xaf64aa1f
.long 0x80003000,0x30000000,0x8000b000,0xb0000000,0x30000000,0x2a1faf64,0xada8ada8,0xaf642a1f
.long 0x8000b000,0xada8ada8,0xb0000000,0xada82da8,0xb0000000,0xaf642a1f,0xada82da8,0xaa1f2f64
.long 0x80003000,0x80003000,0x80003000,0x80003000,0x80003000,0xaa1f2f64,0xada82da8,0xaf642a1f
.long 0x80003000,0xada82da8,0xb0000000,0xada8ada8,0x80003000,0xaf642a1f,0xada8ada8,0x2a1faf64
.long 0x80003000,0xb0000000,0x8000b000,0x30000000,0x80003000,0xaf64aa1f,0x2da8ada8,0x2a1f2f64
.long 0x80003000,0xada8ada8,0x30000000,0xada82da8,0x80003000,0xaa1faf64,0x2da82da8,0xaf64aa1f
.long 0x80003000,0x8000b000,0x80003000,0x8000b000,0x80003000,0x2a1faf64,0xada82da8,0x2f64aa1f
.long 0x80003000,0x2da8ada8,0xb0000000,0x2da82da8,0x80003000,0x2f64aa1f,0xada8ada8,0xaa1f2f64
.long 0x80003000,0x30000000,0x8000b000,0xb0000000,0x80003000,0x2f642a1f,0x2da8ada8,0xaa1faf64
.long 0x80003000,0x2da82da8,0x30000000,0x2da8ada8,0x80003000,0x2a1f2f64,0x2da82da8,0x2f642a1f
.long 0x80003000,0x80003000,0x80003000,0x80003000,0xb0000000,0xaf64aa1f,0xada8ada8,0xaa1faf64
.long 0x8000b000,0x2da8ada8,0x30000000,0x2da82da8,0x30000000,0x2a1f2f64,0xada82da8,0xaf64aa1f
.long 0x80003000,0xb0000000,0x8000b000,0x30000000,0xb0000000,0x2a1faf64,0x2da82da8,0xaf642a1f
.long 0x8000b000,0x2da82da8,0xb0000000,0x2da8ada8,0x30000000,0xaf642a1f,0x2da8ada8,0xaa1f2f64
.long 0x80003000,0x8000b000,0x80003000,0x8000b000,0xb0000000,0x2f642a1f,0xada8ada8,0x2a1f2f64
.long 0x8000b000,0xada82da8,0x30000000,0xada8ada8,0x30000000,0xaa1faf64,0xada82da8,0x2f642a1f
.long 0x80003000,0x30000000,0x8000b000,0xb0000000,0xb0000000,0xaa1f2f64,0x2da82da8,0x2f64aa1f
.long 0x8000b000,0xada8ada8,0xb0000000,0xada82da8,0x30000000,0x2f64aa1f,0x2da8ada8,0x2a1faf64
.long 0x80003000,0x80003000,0x80003000,0x80003000,0x8000b000,0x2a1faf64,0x2da8ada8,0x2f64aa1f
.long 0x80003000,0xada82da8,0xb0000000,0xada8ada8,0x8000b000,0x2f64aa1f,0x2da82da8,0xaa1f2f64
.long 0x80003000,0xb0000000,0x8000b000,0x30000000,0x8000b000,0x2f642a1f,0xada82da8,0xaa1faf64
.long 0x80003000,0xada8ada8,0x30000000,0xada82da8,0x8000b000,0x2a1f2f64,0xada8ada8,0x2f642a1f
.long 0x80003000,0x8000b000,0x80003000,0x8000b000,0x8000b000,0xaa1f2f64,0x2da8ada8,0xaf642a1f
.long 0x80003000,0x2da8ada8,0xb0000000,0x2da82da8,0x8000b000,0xaf642a1f,0x2da82da8,0x2a1faf64
.long 0x80003000,0x30000000,0x8000b000,0xb0000000,0x8000b000,0xaf64aa1f,0xada82da8,0x2a1f2f64
.long 0x80003000,0x2da82da8,0x30000000,0x2da8ada8,0x8000b000,0xaa1faf64,0xada8ada8,0xaf64aa1f
.long 0x80003000,0x80003000,0x80003000,0x80003000,0x30000000,0x2f642a1f,0x2da82da8,0x2a1f2f64
.long 0x8000b000,0x2da8ada8,0x30000000,0x2da82da8,0xb0000000,0xaa1faf64,0x2da8ada8,0x2f642a1f
.long 0x80003000,0xb0000000,0x8000b000,0x30000000,0x30000000,0xaa1f2f64,0xada8ada8,0x2f64aa1f
.long 0x8000b000,0x2da82da8,0xb0000000,0x2da8ada8,0xb0000000,0x2f64aa1f,0xada82da8,0x2a1faf64
.long 0x80003000,0x8000b000,0x80003000,0x8000b000,0x30000000,0xaf64aa1f,0x2da82da8,0xaa1faf64
.long 0x8000b000,0xada82da8,0x30000000,0xada8ada8,0xb0000000,0x2a1f2f64,0x2da8ada8,0xaf64aa1f
.long 0x80003000,0x30000000,0x8000b000,0xb0000000,0x30000000,0x2a1faf64,0xada8ada8,0xaf642a1f
.long 0x8000b000,0xada8ada8,0xb0000000,0xada82da8,0xb0000000,0xaf642a1f,0xada82da8,0xaa1f2f64
.long 0x80003000,0xa63e2fd9,0xaa1f2f64,0xac722ea7,0x80003000,0xac722ea7,0xaf642a1f,0xafd9a63e
.long 0x80003000,0xaea72c72,0xaf64aa1f,0xa63eafd9,0x80003000,0xafd9263e,0xaa1faf64,0x2ea7ac72
.long 0x80003000,0xafd9a63e,0x2a1faf64,0x2ea72c72,0x80003000,0xaea7ac72,0x2f64aa1f,0xa63e2fd9
.long 0x80003000,0xac72aea7,0x2f642a1f,0xafd9263e,0x80003000,0xa63eafd9,0x2a1f2f64,0xac72aea7
.long 0x80003000,0x263eafd9,0xaa1f2f64,0x2c72aea7,0x80003000,0x2c72aea7,0xaf642a1f,0x2fd9263e
.long 0x80003000,0x2ea7ac72,0xaf64aa1f,0x263e2fd9,0x80003000,0x2fd9a63e,0xaa1faf64,0xaea72c72
.long 0x80003000,0x2fd9263e,0x2a1faf64,0xaea7ac72,0x80003000,0x2ea72c72,0x2f64aa1f,0x263eafd9
.long 0x80003000,0x2c722ea7,0x2f642a1f,0x2fd9a63e,0x80003000,0x263e2fd9,0x2a1f2f64,0x2c722ea7
.long 0xada82da8,0xaea72c72,0xaf642a1f,0xafd9263e,0xada8ada8,0xa63eafd9,0x2a1faf64,0x2ea7ac72
.long 0x2da8ada8,0x2fd9263e,0x2a1f2f64,0xac722ea7,0x2da82da8,0xac722ea7,0xaf64aa1f,0x263eafd9
.long 0xada82da8,0xac72aea7,0x2f64aa1f,0x263e2fd9,0xada8ada8,0x2fd9a63e,0xaa1f2f64,0xac72aea7
.long 0x2da8ada8,0xa63e2fd9,0xaa1faf64,0x2ea72c72,0x2da82da8,0xaea7ac72,0x2f642a1f,0xafd9a63e
.long 0xada82da8,0x2ea7ac72,0xaf642a1f,0x2fd9a63e,0xada8ada8,0x263e2fd9,0x2a1faf64,0xaea72c72
.long 0x2da8ada8,0xafd9a63e,0x2a1f2f64,0x2c72aea7,0x2da82da8,0x2c72aea7,0xaf64aa1f,0xa63e2fd9
.long 0xada82da8,0x2c722ea7,0x2f64aa1f,0xa63eafd9,0xada8ada8,0xafd9263e,0xaa1f2f64,0x2c722ea7
.long 0x2da8ada8,0x263eafd9,0xaa1faf64,0xaea7ac72,0x2da82da8,0x2ea72c72,0x2f642a1f,0x2fd9263e
.long 0xb0000000,0xafd9a63e,0xaf64aa1f,0xaea7ac72,0x30000000,0x2ea72c72,0x2a1f2f64,0xa63e2fd9
.long 0xb0000000,0xac72aea7,0x2a1faf64,0x2fd9a63e,0x30000000,0x263e2fd9,0xaf642a1f,0xac72aea7
.long 0xb0000000,0x263eafd9,0x2f642a1f,0xac722ea7,0x30000000,0xac722ea7,0xaa1faf64,0x2fd9263e
.long 0xb0000000,0x2ea7ac72,0xaa1f2f64,0xa63eafd9,0x30000000,0xafd9263e,0x2f64aa1f,0xaea72c72
.long 0xb0000000,0x2fd9263e,0xaf64aa1f,0x2ea72c72,0x30000000,0xaea7ac72,0x2a1f2f64,0x263eafd9
.long 0xb0000000,0x2c722ea7,0x2a1faf64,0xafd9263e,0x30000000,0xa63eafd9,0xaf642a1f,0x2c722ea7
.long 0xb0000000,0xa63e2fd9,0x2f642a1f,0x2c72aea7,0x30000000,0x2c72aea7,0xaa1faf64,0xafd9a63e
.long 0xb0000000,0xaea72c72,0xaa1f2f64,0x263e2fd9,0x30000000,0x2fd9a63e,0x2f64aa1f,0x2ea7ac72
.long 0xada8ada8,0xac72aea7,0xaa1faf64,0xa63eafd9,0xada82da8,0xafd9263e,0xaf64aa1f,0xac72aea7
.long 0x2da82da8,0xa63e2fd9,0xaf642a1f,0xaea7ac72,0x2da8ada8,0x2ea72c72,0xaa1f2f64,0xafd9a63e
.long 0xada8ada8,0x2ea7ac72,0x2a1f2f64,0xafd9263e,0xada82da8,0xa63eafd9,0x2f642a1f,0xaea72c72
.long 0x2da82da8,0xafd9a63e,0x2f64aa1f,0xac722ea7,0x2da8ada8,0xac722ea7,0x2a1faf64,0xa63e2fd9
.long 0xada8ada8,0x2c722ea7,0xaa1faf64,0x263e2fd9,0xada82da8,0x2fd9a63e,0xaf64aa1f,0x2c722ea7
.long 0x2da82da8,0x263eafd9,0xaf642a1f,0x2ea72c72,0x2da8ada8,0xaea7ac72,0xaa1f2f64,0x2fd9263e
.long 0xada8ada8,0xaea72c72,0x2a1f2f64,0x2fd9a63e,0xada82da8,0x263e2fd9,0x2f642a1f,0x2ea7ac72
.long 0x2da82da8,0x2fd9263e,0x2f64aa1f,0x2c72aea7,0x2da8ada8,0x2c72aea7,0x2a1faf64,0x263eafd9
.long 0x8000b000,0x263eafd9,0x2a1faf64,0x2c72aea7,0x8000b000,0x2c72aea7,0x2f64aa1f,0x2fd9263e
.long 0x8000b000,0x2ea7ac72,0x2f642a1f,0x263e2fd9,0x8000b000,0x2fd9a63e,0x2a1f2f64,0xaea72c72
.long 0x8000b000,0x2fd9263e,0xaa1f2f64,0xaea7ac72,0x8000b000,0x2ea72c72,0xaf642a1f,0x263eafd9
.long 0x8000b000,0x2c722ea7,0xaf64aa1f,0x2fd9a63e,0x8000b000,0x263e2fd9,0xaa1faf64,0x2c722ea7
.long 0x8000b000,0xa63e2fd9,0x2a1faf64,0xac722ea7,0x8000b000,0xac722ea7,0x2f64aa1f,0xafd9a63e
.long 0x8000b000,0xaea72c72,0x2f642a1f,0xa63eafd9,0x8000b000,0xafd9263e,0x2a1f2f64,0x2ea7ac72
.long 0x8000b000,0xafd9a63e,0xaa1f2f64,0x2ea72c72,0x8000b000,0xaea7ac72,0xaf642a1f,0xa63e2fd9
.long 0x8000b000,0xac72aea7,0xaf64aa1f,0xafd9263e,0x8000b000,0xa63eafd9,0xaa1faf64,0xac72aea7
.long 0x2da8ada8,0x2ea7ac72,0x2f64aa1f,0x2fd9a63e,0x2da82da8,0x263e2fd9,0xaa1f2f64,0xaea72c72
.long 0xada82da8,0xafd9a63e,0xaa1faf64,0x2c72aea7,0xada8ada8,0x2c72aea7,0x2f642a1f,0xa63e2fd9
.long 0x2da8ada8,0x2c722ea7,0xaf642a1f,0xa63eafd9,0x2da82da8,0xafd9263e,0x2a1faf64,0x2c722ea7
.long 0xada82da8,0x263eafd9,0x2a1f2f64,0xaea7ac72,0xada8ada8,0x2ea72c72,0xaf64aa1f,0x2fd9263e
.long 0x2da8ada8,0xaea72c72,0x2f64aa1f,0xafd9263e,0x2da82da8,0xa63eafd9,0xaa1f2f64,0x2ea7ac72
.long 0xada82da8,0x2fd9263e,0xaa1faf64,0xac722ea7,0xada8ada8,0xac722ea7,0x2f642a1f,0x263eafd9
.long 0x2da8ada8,0xac72aea7,0xaf642a1f,0x263e2fd9,0x2da82da8,0x2fd9a63e,0x2a1faf64,0xac72aea7
.long 0xada82da8,0xa63e2fd9,0x2a1f2f64,0x2ea72c72,0xada8ada8,0xaea7ac72,0xaf64aa1f,0xafd9a63e
.long 0x30000000,0x2fd9263e,0x2f642a1f,0x2ea72c72,0xb0000000,0xaea7ac72,0xaa1faf64,0x263eafd9
.long 0x30000000,0x2c722ea7,0xaa1f2f64,0xafd9263e,0xb0000000,0xa63eafd9,0x2f64aa1f,0x2c722ea7
.long 0x30000000,0xa63e2fd9,0xaf64aa1f,0x2c72aea7,0xb0000000,0x2c72aea7,0x2a1f2f64,0xafd9a63e
.long 0x30000000,0xaea72c72,0x2a1faf64,0x263e2fd9,0xb0000000,0x2fd9a63e,0xaf642a1f,0x2ea7ac72
.long 0x30000000,0xafd9a63e,0x2f642a1f,0xaea7ac72,0xb0000000,0x2ea72c72,0xaa1faf64,0xa63e2fd9
.long 0x30000000,0xac72aea7,0xaa1f2f64,0x2fd9a63e,0xb0000000,0x263e2fd9,0x2f64aa1f,0xac72aea7
.long 0x30000000,0x263eafd9,0xaf64aa1f,0xac722ea7,0xb0000000,0xac722ea7,0x2a1f2f64,0x2fd9263e
.long 0x30000000,0x2ea7ac72,0x2a1faf64,0xa63eafd9,0xb0000000,0xafd9263e,0xaf642a1f,0xaea72c72
.long 0x2da82da8,0x2c722ea7,0x2a1f2f64,0x263e2fd9,0x2da8ada8,0x2fd9a63e,0x2f642a1f,0x2c722ea7
.long 0xada8ada8,0x263eafd9,0x2f64aa1f,0x2ea72c72,0xada82da8,0xaea7ac72,0x2a1faf64,0x2fd9263e
.long 0x2da82da8,0xaea72c72,0xaa1faf64,0x2fd9a63e,0x2da8ada8,0x263e2fd9,0xaf64aa1f,0x2ea7ac72
.long 0xada8ada8,0x2fd9263e,0xaf642a1f,0x2c72aea7,0xada82da8,0x2c72aea7,0xaa1f2f64,0x263eafd9
.long 0x2da82da8,0xac72aea7,0x2a1f2f64,0xa63eafd9,0x2da8ada8,0xafd9263e,0x2f642a1f,0xac72aea7
.long 0xada8ada8,0xa63e2fd9,0x2f64aa1f,0xaea7ac72,0xada82da8,0x2ea72c72,0x2a1faf64,0xafd9a63e
.long 0x2da82da8,0x2ea7ac72,0xaa1faf64,0xafd9263e,0x2da8ada8,0xa63eafd9,0xaf64aa1f,0xaea72c72
.long 0xada8ada8,0xafd9a63e,0xaf642a1f,0xac722ea7,0xada82da8,0xac722ea7,0xaa1f2f64,0xa63e2fd9
.long 0x3f800000,0x00000000,0x3f800000,0x00000000,0x3f800000,0x00000000,0x3f7ff35e,0x3ca0d6d6
.long 0x3f800000,0x00000000,0x3f7fcd79,0x3d20cee7,0x3f800000,0x00000000,0x3f7f8e56,0x3d712283
.long 0x3f800000,0x00000000,0x3f7f35f9,0x3da0af2a,0x3f800000,0x00000000,0x3f7ec46d,0x3dc8bd36
.long 0x3f800000,0x00000000,0x3f7e39bc,0x3df0b772,0x3f800000,0x00000000,0x3f7d95f4,0x3e0c4cf7
.long 0x3f800000,0x00000000,0x3f7cd925,0x3e20305b,0x3f800000,0x00000000,0x3f7c0361,0x3e3403f1
.long 0x3f800000,0x00000000,0x3f7b14be,0x3e47c5c2,0x3f800000,0x00000000,0x3f7a0d54,0x3e5b73dc
.long 0x3f800000,0x00000000,0x3f78ed3c,0x3e6f0c4d,0x3f800000,0x00000000,0x3f77b493,0x3e814693
.long 0x3f800000,0x00000000,0x3f766377,0x3e8afa3e,0x3f800000,0x00000000,0x3f74fa0b,0x3e94a031
.long 0x3f800000,0x00000000,0x3f800000,0x00000000,0x3f7f35f9,0x3da0af2a,0x3f7ec46d,0x3dc8bd36
.long 0x3f7cd925,0x3e20305b,0x3f7b14be,0x3e47c5c2,0x3f78ed3c,0x3e6f0c4d,0x3f74fa0b,0x3e94a031
.long 0x3f737871,0x3e9e377a,0x3f6c835e,0x3ec3ef15,0x3f6c835e,0x3ec3ef15,0x3f61c598,0x3ef15aea
.long 0x3f641901,0x3ee87171,0x3f54db31,0x3f0e39da,0x3f5a46a0,0x3f05c277,0x3f45e403,0x3f226799
.long 0x3f4f1bbd,0x3f167918,0x3f3504f3,0x3f3504f3,0x3f42a9f7,0x3f26423a,0x3f226799,0x3f45e403
.long 0x3f3504f3,0x3f3504f3,0x3f0e39da,0x3f54db31,0x3f26423a,0x3f42a9f7,0x3ef15aea,0x3f61c598
.long 0x3f167918,0x3f4f1bbd,0x3ec3ef15,0x3f6c835e,0x3f05c277,0x3f5a46a0,0x3e94a031,0x3f74fa0b
.long 0x3ee87171,0x3f641901,0x3e47c5c2,0x3f7b14be,0x3ec3ef15,0x3f6c835e,0x3dc8bd36,0x3f7ec46d
.long 0x3f800000,0x00000000,0x3f800000,0x00000000,0x3f7cd925,0x3e20305b,0x3f7c0361,0x3e3403f1
.long 0x3f737871,0x3e9e377a,0x3f702d4f,0x3eb13641,0x3f641901,0x3ee87171,0x3f5cdc29,0x3f0172c3
.long 0x3f4f1bbd,0x3f167918,0x3f42a9f7,0x3f26423a,0x3f3504f3,0x3f3504f3,0x3f226799,0x3f45e403
.long 0x3f167918,0x3f4f1bbd,0x3efa2c90,0x3f5f5be6,0x3ee87171,0x3f641901,0x3ea7bf25,0x3f71decf
.long 0x3e9e377a,0x3f737871,0x3e20305b,0x3f7cd925,0x3e20305b,0x3f7cd925,0xbca0d6d6,0x3f7ff35e
.long 0x00000000,0x3f800000,0xbe47c5c2,0x3f7b14be,0xbe20305b,0x3f7cd925,0xbeba9be1,0x3f6e641a
.long 0xbe9e377a,0x3f737871,0xbf05c277,0x3f5a46a0,0xbee87171,0x3f641901,0xbf2a0c73,0x3f3f5cb5
.long 0xbf167918,0x3f4f1bbd,0xbf490a88,0x3f1e7cf1,0xbf3504f3,0x3f3504f3,0xbf61c598,0x3ef15aea
.long 0x3f800000,0x00000000,0x3f800000,0x00000000,0x3f78ed3c,0x3e6f0c4d,0x3f77b493,0x3e814693
.long 0x3f641901,0x3ee87171,0x3f5f5be6,0x3efa2c90,0x3f42a9f7,0x3f26423a,0x3f3889dc,0x3f316e2c
.long 0x3f167918,0x3f4f1bbd,0x3f05c277,0x3f5a46a0,0x3ec3ef15,0x3f6c835e,0x3e94a031,0x3f74fa0b
.long 0x3e20305b,0x3f7cd925,0x3d20cee7,0x3f7fcd79,0xbda0af2a,0x3f7f35f9,0xbe5b73dc,0x3f7a0d54
.long 0xbe9e377a,0x3f737871,0xbee87171,0x3f641901,0xbf05c277,0x3f5a46a0,0xbf2a0c73,0x3f3f5cb5
.long 0xbf3504f3,0x3f3504f3,0xbf54db31,0x3f0e39da,0xbf5a46a0,0x3f05c277,0xbf71decf,0x3ea7bf25
.long 0xbf737871,0x3e9e377a,0xbf7f35f9,0x3da0af2a,0xbf7f35f9,0x3da0af2a,0xbf7c0361,0xbe3403f1
.long 0xbf7cd925,0xbe20305b,0xbf687c12,0xbed65a92,0xbf6c835e,0xbec3ef15,0xbf45e403,0xbf226799
.long 0x3f800000,0x00000000,0x3f800000,0x00000000,0x3f7fcd79,0x3d20cee7,0x3f7f8e56,0x3d712283
.long 0x3f7f35f9,0x3da0af2a,0x3f7e39bc,0x3df0b772,0x3f7e39bc,0x3df0b772,0x3f7c0361,0x3e3403f1
.long 0x3f7cd925,0x3e20305b,0x3f78ed3c,0x3e6f0c4d,0x3f7b14be,0x3e47c5c2,0x3f74fa0b,0x3e94a031
.long 0x3f78ed3c,0x3e6f0c4d,0x3f702d4f,0x3eb13641,0x3f766377,0x3e8afa3e,0x3f6a8b4b,0x3ecd2ef3
.long 0x3f737871,0x3e9e377a,0x3f641901,0x3ee87171,0x3f702d4f,0x3eb13641,0x3f5cdc29,0x3f0172c3
.long 0x3f6c835e,0x3ec3ef15,0x3f54db31,0x3f0e39da,0x3f687c12,0x3ed65a92,0x3f4c1d35,0x3f1a82a4
.long 0x3f641901,0x3ee87171,0x3f42a9f7,0x3f26423a,0x3f5f5be6,0x3efa2c90,0x3f3889dc,0x3f316e2c
.long 0x3f5a46a0,0x3f05c277,0x3f2dc5e3,0x3f3bfc8f,0x3f54db31,0x3f0e39da,0x3f226799,0x3f45e403
.long 0x3f800000,0x00000000,0x3f800000,0x00000000,0x3f7e39bc,0x3df0b772,0x3f7d95f4,0x3e0c4cf7
.long 0x3f78ed3c,0x3e6f0c4d,0x3f766377,0x3e8afa3e,0x3f702d4f,0x3eb13641,0x3f6a8b4b,0x3ecd2ef3
.long 0x3f641901,0x3ee87171,0x3f5a46a0,0x3f05c277,0x3f54db31,0x3f0e39da,0x3f45e403,0x3f226799
.long 0x3f42a9f7,0x3f26423a,0x3f2dc5e3,0x3f3bfc8f,0x3f2dc5e3,0x3f3bfc8f,0x3f1260b2,0x3f5205d4
.long 0x3f167918,0x3f4f1bbd,0x3ee87171,0x3f641901,0x3efa2c90,0x3f5f5be6,0x3ea7bf25,0x3f71decf
.long 0x3ec3ef15,0x3f6c835e,0x3e47c5c2,0x3f7b14be,0x3e8afa3e,0x3f766377,0x3d712283,0x3f7f8e56
.long 0x3e20305b,0x3f7cd925,0xbda0af2a,0x3f7f35f9,0x3d20cee7,0x3f7fcd79,0xbe5b73dc,0x3f7a0d54
.long 0xbda0af2a,0x3f7f35f9,0xbeb13641,0x3f702d4f,0xbe47c5c2,0x3f7b14be,0xbef15aea,0x3f61c598
.long 0x3f800000,0x00000000,0x3f800000,0x00000000,0x3f7b14be,0x3e47c5c2,0x3f7a0d54,0x3e5b73dc
.long 0x3f6c835e,0x3ec3ef15,0x3f687c12,0x3ed65a92,0x3f54db31,0x3f0e39da,0x3f4c1d35,0x3f1a82a4
.long 0x3f3504f3,0x3f3504f3,0x3f26423a,0x3f42a9f7,0x3f0e39da,0x3f54db31,0x3ef15aea,0x3f61c598
.long 0x3ec3ef15,0x3f6c835e,0x3e8afa3e,0x3f766377,0x3e47c5c2,0x3f7b14be,0x3d712283,0x3f7f8e56
.long 0x00000000,0x3f800000,0xbe20305b,0x3f7cd925,0xbe47c5c2,0x3f7b14be,0xbeba9be1,0x3f6e641a
.long 0xbec3ef15,0x3f6c835e,0xbf0e39da,0x3f54db31,0xbf0e39da,0x3f54db31,0xbf3889dc,0x3f316e2c
.long 0xbf3504f3,0x3f3504f3,0xbf5a46a0,0x3f05c277,0xbf54db31,0x3f0e39da,0xbf71decf,0x3ea7bf25
.long 0xbf6c835e,0x3ec3ef15,0xbf7e39bc,0x3df0b772,0xbf7b14be,0x3e47c5c2,0xbf7ec46d,0xbdc8bd36
.long 0x3f800000,0x00000000,0x3f800000,0x00000000,0x3f766377,0x3e8afa3e,0x3f74fa0b,0x3e94a031
.long 0x3f5a46a0,0x3f05c277,0x3f54db31,0x3f0e39da,0x3f2dc5e3,0x3f3bfc8f,0x3f226799,0x3f45e403
.long 0x3ee87171,0x3f641901,0x3ec3ef15,0x3f6c835e,0x3e47c5c2,0x3f7b14be,0x3dc8bd36,0x3f7ec46d
.long 0xbda0af2a,0x3f7f35f9,0xbe47c5c2,0x3f7b14be,0xbeb13641,0x3f702d4f,0xbef15aea,0x3f61c598
.long 0xbf167918,0x3f4f1bbd,0xbf3504f3,0x3f3504f3,0xbf490a88,0x3f1e7cf1,0xbf61c598,0x3ef15aea
.long 0xbf6c835e,0x3ec3ef15,0xbf7b14be,0x3e47c5c2,0xbf7e39bc,0x3df0b772,0xbf7ec46d,0xbdc8bd36
.long 0xbf7cd925,0xbe20305b,0xbf6c835e,0xbec3ef15,0xbf687c12,0xbed65a92,0xbf45e403,0xbf226799
.long 0xbf42a9f7,0xbf26423a,0xbf0e39da,0xbf54db31,0xbf0e39da,0xbf54db31,0xbe94a031,0xbf74fa0b
.long 0x3f800000,0x00000000,0x3f7ffcd7,0x3c20d8d2,0x3f800000,0x00000000,0x3f7fe394,0x3cf13d4c
.long 0x3f800000,0x00000000,0x3f7fb10f,0x3d48fb30,0x3f800000,0x00000000,0x3f7f654e,0x3d8ca1f2
.long 0x3f800000,0x00000000,0x3f7f0059,0x3db4b86a,0x3f800000,0x00000000,0x3f7e8238,0x3ddcbd0d
.long 0x3f800000,0x00000000,0x3f7deafa,0x3e0255f4,0x3f800000,0x00000000,0x3f7d3aac,0x3e164083
.long 0x3f800000,0x00000000,0x3f7c7160,0x3e2a1c3f,0x3f800000,0x00000000,0x3f7b8f2a,0x3e3de731
.long 0x3f800000,0x00000000,0x3f7a9421,0x3e519f65,0x3f800000,0x00000000,0x3f79805c,0x3e6542e9
.long 0x3f800000,0x00000000,0x3f7853f8,0x3e78cfcc,0x3f800000,0x00000000,0x3f770f11,0x3e862210
.long 0x3f800000,0x00000000,0x3f75b1c9,0x3e8fcefe,0x3f800000,0x00000000,0x3f743c41,0x3e996dba
.long 0x3f7fcd79,0x3d20cee7,0x3f7fb10f,0x3d48fb30,0x3f7e39bc,0x3df0b772,0x3f7d3aac,0x3e164083
.long 0x3f7b14be,0x3e47c5c2,0x3f7853f8,0x3e78cfcc,0x3f766377,0x3e8afa3e,0x3f710908,0x3eac7cd4
.long 0x3f702d4f,0x3eb13641,0x3f676bd8,0x3edae880,0x3f687c12,0x3ed65a92,0x3f5b941a,0x3f039c3d
.long 0x3f5f5be6,0x3efa2c90,0x3f4d9f02,0x3f187fc0,0x3f54db31,0x3f0e39da,0x3f3daef9,0x3f2beb4a
.long 0x3f490a88,0x3f1e7cf1,0x3f2beb4a,0x3f3daef9,0x3f3bfc8f,0x3f2dc5e3,0x3f187fc0,0x3f4d9f02
.long 0x3f2dc5e3,0x3f3bfc8f,0x3f039c3d,0x3f5b941a,0x3f1e7cf1,0x3f490a88,0x3edae880,0x3f676bd8
.long 0x3f0e39da,0x3f54db31,0x3eac7cd4,0x3f710908,0x3efa2c90,0x3f5f5be6,0x3e78cfcc,0x3f7853f8
.long 0x3ed65a92,0x3f687c12,0x3e164083,0x3f7d3aac,0x3eb13641,0x3f702d4f,0x3d48fb30,0x3f7fb10f
.long 0x3f7f35f9,0x3da0af2a,0x3f7f0059,0x3db4b86a,0x3f78ed3c,0x3e6f0c4d,0x3f770f11,0x3e862210
.long 0x3f6c835e,0x3ec3ef15,0x3f676bd8,0x3edae880,0x3f5a46a0,0x3f05c277,0x3f50935b,0x3f146eba
.long 0x3f42a9f7,0x3f26423a,0x3f333bc6,0x3f36c9a9,0x3f26423a,0x3f42a9f7,0x3f104f0e,0x3f53731f
.long 0x3f05c277,0x3f5a46a0,0x3ed1c759,0x3f698690,0x3ec3ef15,0x3f6c835e,0x3e78cfcc,0x3f7853f8
.long 0x3e6f0c4d,0x3f78ed3c,0x3d8ca1f2,0x3f7f654e,0x3da0af2a,0x3f7f35f9,0xbddcbd0d,0x3f7e8238
.long 0xbda0af2a,0x3f7f35f9,0xbe8fcefe,0x3f75b1c9,0xbe6f0c4d,0x3f78ed3c,0xbee3f40d,0x3f653a48
.long 0xbec3ef15,0x3f6c835e,0xbf187fc0,0x3f4d9f02,0xbf05c277,0x3f5a46a0,0xbf3a4582,0x3f2f9c32
.long 0xbf26423a,0x3f42a9f7,0xbf563e03,0x3f0c2124,0xbf42a9f7,0x3f26423a,0xbf6b8a3d,0x3ec8917e
.long 0x3f7e39bc,0x3df0b772,0x3f7deafa,0x3e0255f4,0x3f702d4f,0x3eb13641,0x3f6d76aa,0x3ebf47d7
.long 0x3f54db31,0x3f0e39da,0x3f4d9f02,0x3f187fc0,0x3f2dc5e3,0x3f3bfc8f,0x3f207440,0x3f4779bc
.long 0x3efa2c90,0x3f5f5be6,0x3ed1c759,0x3f698690,0x3e8afa3e,0x3f766377,0x3e2a1c3f,0x3f7c7160
.long 0x3d20cee7,0x3f7fcd79,0xbdb4b86a,0x3f7f0059,0xbe47c5c2,0x3f7b14be,0xbeac7cd4,0x3f710908
.long 0xbed65a92,0x3f687c12,0xbf104f0e,0x3f53731f,0xbf1e7cf1,0x3f490a88,0xbf4105b8,0x3f28296a
.long 0xbf490a88,0x3f1e7cf1,0xbf653a48,0x3ee3f40d,0xbf687c12,0x3ed65a92,0xbf7a9421,0x3e519f65
.long 0xbf7b14be,0x3e47c5c2,0xbf7fb10f,0xbd48fb30,0xbf7fcd79,0xbd20cee7,0xbf743c41,0xbe996dba
.long 0xbf766377,0xbe8afa3e,0xbf58f3c4,0xbf07e565,0xbf5f5be6,0xbefa2c90,0xbf2f9c32,0xbf3a4582
.long 0x3f7ff35e,0x3ca0d6d6,0x3f7fe394,0x3cf13d4c,0x3f7f8e56,0x3d712283,0x3f7f0059,0x3db4b86a
.long 0x3f7ec46d,0x3dc8bd36,0x3f7d3aac,0x3e164083,0x3f7d95f4,0x3e0c4cf7,0x3f7a9421,0x3e519f65
.long 0x3f7c0361,0x3e3403f1,0x3f770f11,0x3e862210,0x3f7a0d54,0x3e5b73dc,0x3f72ae9e,0x3ea2fd52
.long 0x3f77b493,0x3e814693,0x3f6d76aa,0x3ebf47d7,0x3f74fa0b,0x3e94a031,0x3f676bd8,0x3edae880
.long 0x3f71decf,0x3ea7bf25,0x3f609384,0x3ef5c6c5,0x3f6e641a,0x3eba9be1,0x3f58f3c4,0x3f07e565
.long 0x3f6a8b4b,0x3ecd2ef3,0x3f50935b,0x3f146eba,0x3f6655e7,0x3edf7108,0x3f4779bc,0x3f207440
.long 0x3f61c598,0x3ef15aea,0x3f3daef9,0x3f2beb4a,0x3f5cdc29,0x3f0172c3,0x3f333bc6,0x3f36c9a9
.long 0x3f579b8c,0x3f0a04f8,0x3f28296a,0x3f4105b8,0x3f5205d4,0x3f1260b2,0x3f1c81b9,0x3f4a965e
.long 0x3f7f8e56,0x3d712283,0x3f7f654e,0x3d8ca1f2,0x3f7c0361,0x3e3403f1,0x3f7a9421,0x3e519f65
.long 0x3f74fa0b,0x3e94a031,0x3f710908,0x3eac7cd4,0x3f6a8b4b,0x3ecd2ef3,0x3f62f219,0x3eece91a
.long 0x3f5cdc29,0x3f0172c3,0x3f50935b,0x3f146eba,0x3f4c1d35,0x3f1a82a4,0x3f3a4582,0x3f2f9c32
.long 0x3f3889dc,0x3f316e2c,0x3f207440,0x3f4779bc,0x3f226799,0x3f45e403,0x3f039c3d,0x3f5b941a
.long 0x3f0a04f8,0x3f579b8c,0x3ec8917e,0x3f6b8a3d,0x3edf7108,0x3f6655e7,0x3e862210,0x3f770f11
.long 0x3ea7bf25,0x3f71decf,0x3e0255f4,0x3f7deafa,0x3e5b73dc,0x3f7a0d54,0xbc20d8d2,0x3f7ffcd7
.long 0x3dc8bd36,0x3f7ec46d,0xbe164083,0x3f7d3aac,0xbca0d6d6,0x3f7ff35e,0xbe8fcefe,0x3f75b1c9
.long 0xbe0c4cf7,0x3f7d95f4,0xbed1c759,0x3f698690,0xbe814693,0x3f77b493,0xbf07e565,0x3f58f3c4
.long 0x3f7ec46d,0x3dc8bd36,0x3f7e8238,0x3ddcbd0d,0x3f74fa0b,0x3e94a031,0x3f72ae9e,0x3ea2fd52
.long 0x3f61c598,0x3ef15aea,0x3f5b941a,0x3f039c3d,0x3f45e403,0x3f226799,0x3f3a4582,0x3f2f9c32
.long 0x3f226799,0x3f45e403,0x3f104f0e,0x3f53731f,0x3ef15aea,0x3f61c598,0x3ebf47d7,0x3f6d76aa
.long 0x3e94a031,0x3f74fa0b,0x3e2a1c3f,0x3f7c7160,0x3dc8bd36,0x3f7ec46d,0xbd48fb30,0x3f7fb10f
.long 0xbdc8bd36,0x3f7ec46d,0xbe862210,0x3f770f11,0xbe94a031,0x3f74fa0b,0xbeece91a,0x3f62f219
.long 0xbef15aea,0x3f61c598,0xbf2456f1,0x3f444969,0xbf226799,0x3f45e403,0xbf4a965e,0x3f1c81b9
.long 0xbf45e403,0x3f226799,0xbf676bd8,0x3edae880,0xbf61c598,0x3ef15aea,0xbf79805c,0x3e6542e9
.long 0xbf74fa0b,0x3e94a031,0xbf7ffcd7,0x3c20d8d2,0xbf7ec46d,0x3dc8bd36,0xbf7a9421,0xbe519f65
.long 0x3f7d95f4,0x3e0c4cf7,0x3f7d3aac,0x3e164083,0x3f6a8b4b,0x3ecd2ef3,0x3f676bd8,0x3edae880
.long 0x3f45e403,0x3f226799,0x3f3daef9,0x3f2beb4a,0x3f1260b2,0x3f5205d4,0x3f039c3d,0x3f5b941a
.long 0x3ea7bf25,0x3f71decf,0x3e78cfcc,0x3f7853f8,0x3d712283,0x3f7f8e56,0xbd48fb30,0x3f7fb10f
.long 0xbe5b73dc,0x3f7a0d54,0xbeac7cd4,0x3f710908,0xbef15aea,0x3f61c598,0xbf187fc0,0x3f4d9f02
.long 0xbf316e2c,0x3f3889dc,0xbf4d9f02,0x3f187fc0,0xbf5cdc29,0x3f0172c3,0xbf710908,0x3eac7cd4
.long 0xbf77b493,0x3e814693,0xbf7fb10f,0x3d48fb30,0xbf7ff35e,0xbca0d6d6,0xbf7853f8,0xbe78cfcc
.long 0xbf74fa0b,0xbe94a031,0xbf5b941a,0xbf039c3d,0xbf579b8c,0xbf0a04f8,0xbf2beb4a,0xbf3daef9
.long 0xbf2a0c73,0xbf3f5cb5,0xbedae880,0xbf676bd8,0xbedf7108,0xbf6655e7,0xbe164083,0xbf7d3aac
.long 0x80003c00,0x80004000,0x80004000,0x80004000,0x80003c00,0xb8f23f9c,0xbcb43e79,0xbe793cb4
.long 0x80003c00,0xbcb43e79,0xbf9c38f2,0xbf9cb8f2,0x80003c00,0xbe793cb4,0xbf9cb8f2,0xb8f2bf9c
.long 0x80003c00,0xc0000000,0x8000c000,0x40000000,0x80003c00,0xbf9cb8f2,0x3cb4be79,0x3cb43e79
.long 0x80003c00,0xbe79bcb4,0x3f9cb8f2,0xb8f23f9c,0x80003c00,0xbcb4be79,0x3f9c38f2,0xbf9c38f2
.long 0x80003c00,0x8000c000,0x80004000,0x8000c000,0x80003c00,0x38f2bf9c,0xbcb43e79,0x3e79bcb4
.long 0x80003c00,0x3cb4be79,0xbf9c38f2,0x3f9c38f2,0x80003c00,0x3e79bcb4,0xbf9cb8f2,0x38f23f9c
.long 0x80003c00,0x40000000,0x8000c000,0xc0000000,0x80003c00,0x3f9c38f2,0x3cb4be79,0xbcb4be79
.long 0x80003c00,0x3e793cb4,0x3f9cb8f2,0x38f2bf9c,0x80003c00,0x3cb43e79,0x3f9c38f2,0x3f9cb8f2
.long 0x80004000,0x80004000,0x80004000,0x80004000,0xbf9c38f2,0xc0000000,0xbf9cb8f2,0xbe79bcb4
.long 0xbcb4be79,0x8000c000,0x3cb4be79,0x3f9cb8f2,0x3cb4be79,0x40000000,0x3cb43e79,0xb8f23f9c
.long 0x80004000,0xc0000000,0x8000c000,0x40000000,0xbf9c38f2,0x8000c000,0x3f9c38f2,0xbcb43e79
.long 0xbcb4be79,0x40000000,0xbcb43e79,0xb8f2bf9c,0x3cb4be79,0x80004000,0xbcb4be79,0x3f9c38f2
.long 0x80004000,0x8000c000,0x80004000,0x8000c000,0xbf9c38f2,0x40000000,0xbf9cb8f2,0x3e793cb4
.long 0xbcb4be79,0x80004000,0x3cb4be79,0xbf9c38f2,0x3cb4be79,0xc0000000,0x3cb43e79,0x38f2bf9c
.long 0x80004000,0x40000000,0x8000c000,0xc0000000,0xbf9c38f2,0x80004000,0x3f9c38f2,0x3cb4be79
.long 0xbcb4be79,0xc0000000,0xbcb43e79,0x38f23f9c,0x3cb4be79,0x8000c000,0xbcb4be79,0xbf9cb8f2
.long 0x80004000,0x80004000,0x80003c00,0x00000000,0xbcb4be79,0xb8f2bf9c,0x8000bc00,0x00000000
.long 0x3f9c38f2,0x3cb43e79,0x80003c00,0x00000000,0xbf9c38f2,0xbe79bcb4,0x8000bc00,0x00000000
.long 0x80004000,0xc0000000,0x8000bc00,0x00000000,0xbcb4be79,0x3f9cb8f2,0x80003c00,0x00000000
.long 0x3f9c38f2,0xbe793cb4,0x8000bc00,0x00000000,0xbf9c38f2,0x3cb4be79,0x80003c00,0x00000000
.long 0x80004000,0x8000c000,0x80003c00,0x00000000,0xbcb4be79,0x38f23f9c,0x8000bc00,0x00000000
.long 0x3f9c38f2,0xbcb4be79,0x80003c00,0x00000000,0xbf9c38f2,0x3e793cb4,0x8000bc00,0x00000000
.long 0x80004000,0x40000000,0x8000bc00,0x00000000,0xbcb4be79,0xbf9c38f2,0x80003c00,0x00000000
.long 0x3f9c38f2,0x3e79bcb4,0x8000bc00,0x00000000,0xbf9c38f2,0xbcb43e79,0x80003c00,0x00000000
.long 0x00000000,0x00000000,0x00000000,0x00000000,0x00000000,0x00000000,0x00000000,0x00000000
.long 0x00000000,0x00000000,0x00000000,0x00000000,0x00000000,0x00000000,0x00000000,0x00000000
.long 0x00000000,0x00000000,0x00000000,0x00000000,0x00000000,0x00000000,0x00000000,0x00000000
.long 0x00000000,0x00000000,0x00000000,0x00000000,0x00000000,0x00000000,0x00000000,0x00000000
.long 0x00000000,0x00000000,0x00000000,0x00000000,0x00000000,0x00000000,0x00000000,0x00000000
.long 0x00000000,0x00000000,0x00000000,0x00000000,0x00000000,0x00000000,0x00000000,0x00000000
.long 0x00000000,0x00000000,0x00000000,0x00000000,0x00000000,0x00000000,0x00000000,0x00000000
.long 0x00000000,0x00000000,0x00000000,0x00000000,0x00000000,0x00000000,0x00000000,0x00000000
.long 0x80003c00,0xbf9c38f2,0xbcb4be79,0x3cb4be79,0x00000000,0x00000000,0x00000000,0x00000000
.long 0x00000000,0x00000000,0x00000000,0x00000000,0x00000000,0x00000000,0x00000000,0x00000000
.long 0x80003c00,0xb8f2bf9c,0x3cb43e79,0xbe79bcb4,0x00000000,0x00000000,0x00000000,0x00000000
.long 0x00000000,0x00000000,0x00000000,0x00000000,0x00000000,0x00000000,0x00000000,0x00000000
.long 0x80003c00,0x3f9cb8f2,0xbcb4be79,0xbcb43e79,0x00000000,0x00000000,0x00000000,0x00000000
.long 0x00000000,0x00000000,0x00000000,0x00000000,0x00000000,0x00000000,0x00000000,0x00000000
.long 0x80003c00,0x38f23f9c,0x3cb43e79,0x3e793cb4,0x00000000,0x00000000,0x00000000,0x00000000
.long 0x00000000,0x00000000,0x00000000,0x00000000,0x00000000,0x00000000,0x00000000,0x00000000
.long 0x3f9c38f2,0x80004000,0xbf9c38f2,0xbcb4be79,0x00000000,0x00000000,0x00000000,0x00000000
.long 0x00000000,0x00000000,0x00000000,0x00000000,0x00000000,0x00000000,0x00000000,0x00000000
.long 0x3f9c38f2,0xc0000000,0x3f9cb8f2,0xbe793cb4,0x00000000,0x00000000,0x00000000,0x00000000
.long 0x00000000,0x00000000,0x00000000,0x00000000,0x00000000,0x00000000,0x00000000,0x00000000
.long 0x3f9c38f2,0x8000c000,0xbf9c38f2,0x3cb43e79,0x00000000,0x00000000,0x00000000,0x00000000
.long 0x00000000,0x00000000,0x00000000,0x00000000,0x00000000,0x00000000,0x00000000,0x00000000
.long 0x3f9c38f2,0x40000000,0x3f9cb8f2,0x3e79bcb4,0x00000000,0x00000000,0x00000000,0x00000000
.long 0x00000000,0x00000000,0x00000000,0x00000000,0x00000000,0x00000000,0x00000000,0x00000000
.long 0x3cb4be79,0x3f9c38f2,0x80003c00,0x00000000,0x00000000,0x00000000,0x00000000,0x00000000
.long 0x00000000,0x00000000,0x00000000,0x00000000,0x00000000,0x00000000,0x00000000,0x00000000
.long 0x3cb4be79,0xb8f23f9c,0x8000bc00,0x00000000,0x00000000,0x00000000,0x00000000,0x00000000
.long 0x00000000,0x00000000,0x00000000,0x00000000,0x00000000,0x00000000,0x00000000,0x00000000
.long 0x3cb4be79,0xbf9cb8f2,0x80003c00,0x00000000,0x00000000,0x00000000,0x00000000,0x00000000
.long 0x00000000,0x00000000,0x00000000,0x00000000,0x00000000,0x00000000,0x00000000,0x00000000
.long 0x3cb4be79,0x38f2bf9c,0x8000bc00,0x00000000,0x00000000,0x00000000,0x00000000,0x00000000
.long 0x00000000,0x00000000,0x00000000,0x00000000,0x00000000,0x00000000,0x00000000,0x00000000
.long 0x00000000,0x00000000,0x00000000,0x00000000,0x00000000,0x00000000,0x00000000,0x00000000
.long 0x00000000,0x00000000,0x00000000,0x00000000,0x00000000,0x00000000,0x00000000,0x00000000
.long 0x00000000,0x00000000,0x00000000,0x00000000,0x00000000,0x00000000,0x00000000,0x00000000
.long 0x00000000,0x00000000,0x00000000,0x00000000,0x00000000,0x00000000,0x00000000,0x00000000
.long 0x00000000,0x00000000,0x00000000,0x00000000,0x00000000,0x00000000,0x00000000,0x00000000
.long 0x00000000,0x00000000,0x00000000,0x00000000,0x00000000,0x00000000,0x00000000,0x00000000
.long 0x00000000,0x00000000,0x00000000,0x00000000,0x00000000,0x00000000,0x00000000,0x00000000
.long 0x00000000,0x00000000,0x00000000,0x00000000,0x00000000,0x00000000,0x00000000,0x00000000
.size cdna_tbl, 40960
cdna_tbl_end:
.section .rodata,"a"
.p2align 6
.amdhsa_kernel a1_kernel
  .amdhsa_next_free_vgpr 128
  .amdhsa_next_free_sgpr 96
  .amdhsa_accum_offset 128
  .amdhsa_group_segment_fixed_size 0
  .amdhsa_kernarg_size 72
  .amdhsa_user_sgpr_count 2
  .amdhsa_user_sgpr_kernarg_segment_ptr 1
  .amdhsa_system_sgpr_workgroup_id_x 1
  .amdhsa_float_denorm_mode_32 3
  .amdhsa_float_denorm_mode_16_64 3
.end_amdhsa_kernel
.p2align 6
.amdhsa_kernel a2_kernel
  .amdhsa_next_free_vgpr 128
  .amdhsa_next_free_sgpr 96
  .amdhsa_accum_offset 128
  .amdhsa_group_segment_fixed_size 0
  .amdhsa_kernarg_size 72
  .amdhsa_user_sgpr_count 2
  .amdhsa_user_sgpr_kernarg_segment_ptr 1
  .amdhsa_system_sgpr_workgroup_id_x 1
  .amdhsa_float_denorm_mode_32 3
  .amdhsa_float_denorm_mode_16_64 3
.end_amdhsa_kernel
.p2align 6
.amdhsa_kernel b_kernel
  .amdhsa_next_free_vgpr 168
  .amdhsa_next_free_sgpr 96
  .amdhsa_accum_offset 168
  .amdhsa_group_segment_fixed_size 0
  .amdhsa_kernarg_size 72
  .amdhsa_user_sgpr_count 2
  .amdhsa_user_sgpr_kernarg_segment_ptr 1
  .amdhsa_system_sgpr_workgroup_id_x 1
  .amdhsa_float_denorm_mode_32 3
  .amdhsa_float_denorm_mode_16_64 3
.end_amdhsa_kernel
.p2align 6
.amdhsa_kernel f1_kernel
  .amdhsa_next_free_vgpr 496
  .amdhsa_next_free_sgpr 96
  .amdhsa_accum_offset 256
  .amdhsa_group_segment_fixed_size 0
  .amdhsa_kernarg_size 72
  .amdhsa_user_sgpr_count 2
  .amdhsa_user_sgpr_kernarg_segment_ptr 1
  .amdhsa_system_sgpr_workgroup_id_x 1
  .amdhsa_float_denorm_mode_32 3
  .amdhsa_float_denorm_mode_16_64 3
.end_amdhsa_kernel
.p2align 6
.amdhsa_kernel f2_kernel
  .amdhsa_next_free_vgpr 496
  .amdhsa_next_free_sgpr 96
  .amdhsa_accum_offset 256
  .amdhsa_group_segment_fixed_size 0
  .amdhsa_kernarg_size 72
  .amdhsa_user_sgpr_count 2
  .amdhsa_user_sgpr_kernarg_segment_ptr 1
  .amdhsa_system_sgpr_workgroup_id_x 1
  .amdhsa_float_denorm_mode_32 3
  .amdhsa_float_denorm_mode_16_64 3
.end_amdhsa_kernel
```
